```python
import torch

def _softmax(x, axis=-1):
    return torch.softmax(x, dim=axis)
def _gelu(x):
    return torch.nn.functional.gelu(x, approximate="tanh")
def _silu(x):
    return torch.nn.functional.silu(x)
def _sigmoid(x):
    return torch.sigmoid(x)
def _layernorm(x, axis=-1, eps=1e-5):
    m = x.mean(dim=axis, keepdim=True)
    v = x.var(dim=axis, keepdim=True, unbiased=False)
    return (x - m) / torch.sqrt(v + eps)
def _scatter_add(tgt, idx, src, axis=0):
    return tgt.clone().index_add_(axis, idx, src)
def _segment_sum(src, seg, n):
    out = torch.zeros((n,) + src.shape[1:], dtype=src.dtype)
    return out.index_add_(0, seg, src)
def _pad(x, pw):
    flat = tuple(v for pair in reversed(pw) for v in pair)
    return torch.nn.functional.pad(x, flat)

kernel_name = 'parallel_sum__grouped_kv_mqa__swiglu_ffn__prompt'

def setup_inputs():

    _w = (lambda a: (lambda t: t.to(torch.bfloat16) if t.is_floating_point() else t)(torch.as_tensor(a)))
    def _A_setup():
        B, S, D, H = 1, 2048, 1024, 32
        Dh = D // H
        return {
            "x": _w((lambda *s: torch.randn(*s, dtype=torch.bfloat16) * 0.05)(B, S, D)),
            "wq": _w((lambda *s: torch.randn(*s, dtype=torch.bfloat16) * 0.1)(D, H * Dh)),
            "wk": _w((lambda *s: torch.randn(*s, dtype=torch.bfloat16) * 0.1)(D, Dh)),
            "wv": _w((lambda *s: torch.randn(*s, dtype=torch.bfloat16) * 0.05)(D, Dh)),
            "wo": _w((lambda *s: torch.randn(*s, dtype=torch.bfloat16) * 0.05)(H * Dh, D)),
        }
    _A_in = _A_setup()

    def _B_setup():
        B, S, D, F = 1, 2048, 1024, 3584
        return {
            "x": _w((lambda *s: torch.randn(*s, dtype=torch.bfloat16) * 0.05)(B, S, D)),
            "w_gate": _w((lambda *s: torch.randn(*s, dtype=torch.bfloat16) * 0.05)(D, F)),
            "w_up": _w((lambda *s: torch.randn(*s, dtype=torch.bfloat16) * 0.05)(D, F)),
            "w_down": _w((lambda *s: torch.randn(*s, dtype=torch.bfloat16) * 0.05)(F, D)),
        }
    _B_in = _B_setup()

    return {
        "A_x": _A_in["x"],
        "A_wq": _A_in["wq"],
        "A_wk": _A_in["wk"],
        "A_wv": _A_in["wv"],
        "A_wo": _A_in["wo"],
        "B_x": _B_in["x"],
        "B_w_gate": _B_in["w_gate"],
        "B_w_up": _B_in["w_up"],
        "B_w_down": _B_in["w_down"],
    }

def reference(A_x, A_wq, A_wk, A_wv, A_wo, B_x, B_w_gate, B_w_up, B_w_down):
    def _A_ref(x, wq, wk, wv, wo):
        B, S, D = x.shape
        H = 32
        Dh = D // H
        q = (lambda x, *d: x.permute(*d))((x @ wq).reshape(B, S, H, Dh), 0, 2, 1, 3)
        k = x @ wk
        v = x @ wv
        scores = torch.einsum("bhqd,bkd->bhqk", q, k) * (Dh ** -0.5)
        p = _softmax(scores, axis=-1)
        o = torch.einsum("bhqk,bkd->bhqd", p, v)
        return (lambda x, *d: x.permute(*d))(o, 0, 2, 1, 3).reshape(B, S, H * Dh) @ wo

    def _B_ref(x, w_gate, w_up, w_down):
        g = _silu(x @ w_gate)
        u = x @ w_up
        return (g * u) @ w_down

    x = A_x
    xn = _layernorm(x, axis=-1)
    return x + _A_ref(xn, A_wq, A_wk, A_wv, A_wo) + _B_ref(xn, B_w_gate, B_w_up, B_w_down)
```

```asm
; @launch kernel=ln_kernel grid=(256,1,1) block=(512,1,1) lds=0
; @launch kernel=gemm1_kernel grid=(256,1,1) block=(256,1,1) lds=151552
; @launch kernel=fused_kernel grid=(256,1,1) block=(512,1,1) lds=151552
.amdgcn_target "amdgcn-amd-amdhsa--gfx950"
.text
.globl ln_kernel
.p2align 8
.type ln_kernel,@function
ln_kernel:

 s_cmp_ge_u32 s2, 256
 s_cbranch_scc1 L_ln_kernel_end
 s_load_dwordx2 s[4:5], s[0:1], 0
 s_load_dwordx2 s[6:7], s[0:1], 88
 v_lshrrev_b32 v74, 6, v0
 v_and_b32 v75, 63, v0
 v_lshlrev_b32 v1, 11, v74
 v_lshl_add_u32 v1, v75, 4, v1
 s_lshl_b32 s3, s2, 14
 v_add_u32 v1, s3, v1
 v_lshrrev_b32 v76, 2, v75
 v_lshlrev_b32 v76, 14, v76
 s_lshl_b32 s19, s2, 3
 s_and_b32 s19, s19, 255
 v_add_u32 v77, s19, v74
 v_lshl_add_u32 v76, v77, 6, v76
 v_lshrrev_b32 v77, 2, v77
 v_sub_u32 v77, 0, v77
 v_xor_b32 v77, v77, v75
 v_and_b32 v77, 3, v77
 v_lshl_add_u32 v76, v77, 4, v76
 s_lshr_b32 s19, s2, 5
 s_lshl_b32 s19, s19, 19
 v_add_u32 v76, s19, v76
 s_mov_b32 s26, 262144
 s_mov_b32 s16, 0xffff0000
 s_mov_b32 s17, 0x3a800000
 s_mov_b32 s18, 0x3727c5ac
 s_waitcnt lgkmcnt(0)
 s_mov_b32 s8, s4
 s_and_b32 s9, s5, 0xffff
 s_mov_b32 s10, 4194304
 s_mov_b32 s11, 0x20000
 buffer_load_dwordx4 v[8:11], v1, s[8:11], 0 offen
 buffer_load_dwordx4 v[12:15], v1, s[8:11], 0 offen offset:1024
 s_add_u32 s12, s6, 0
 s_addc_u32 s13, s7, 0
 s_and_b32 s13, s13, 0xffff
 s_mov_b32 s14, 4194304
 s_mov_b32 s15, 0x20000
 s_cmp_lg_u32 s2, 0
 s_cbranch_scc1 L_ln_kernel_nocnt
 s_add_u32 s36, s6, 8912896
 s_addc_u32 s37, s7, 0
 s_and_b32 s37, s37, 0xffff
 s_mov_b32 s38, 8192
 s_mov_b32 s39, 0x20000
 v_mul_u32_u24 v78, 256, v0
 v_mov_b32 v79, 0
 s_waitcnt vmcnt(0)
 buffer_store_dword v79, v78, s[36:39], 0 offen
L_ln_kernel_nocnt:
 s_waitcnt vmcnt(0)
 v_lshlrev_b32 v16, 16, v8
 v_and_b32 v17, s16, v8
 v_lshlrev_b32 v18, 16, v9
 v_and_b32 v19, s16, v9
 v_lshlrev_b32 v20, 16, v10
 v_and_b32 v21, s16, v10
 v_lshlrev_b32 v22, 16, v11
 v_and_b32 v23, s16, v11
 v_lshlrev_b32 v24, 16, v12
 v_and_b32 v25, s16, v12
 v_lshlrev_b32 v26, 16, v13
 v_and_b32 v27, s16, v13
 v_lshlrev_b32 v28, 16, v14
 v_and_b32 v29, s16, v14
 v_lshlrev_b32 v30, 16, v15
 v_and_b32 v31, s16, v15
 v_add_f32 v40, v16, v17
 v_add_f32 v41, v20, v21
 v_add_f32 v42, v24, v25
 v_add_f32 v43, v28, v29
 v_add_f32 v44, v18, v19
 v_add_f32 v45, v22, v23
 v_add_f32 v46, v26, v27
 v_add_f32 v47, v30, v31
 v_add_f32 v40, v40, v44
 v_add_f32 v41, v41, v45
 v_add_f32 v42, v42, v46
 v_add_f32 v43, v43, v47
 v_add_f32 v40, v40, v41
 v_add_f32 v42, v42, v43
 v_add_f32 v4, v40, v42
 s_nop 1
 v_add_f32_dpp v4, v4, v4 quad_perm:[1,0,3,2] row_mask:0xf bank_mask:0xf
 s_nop 1
 v_add_f32_dpp v4, v4, v4 quad_perm:[2,3,0,1] row_mask:0xf bank_mask:0xf
 s_nop 1
 v_add_f32_dpp v4, v4, v4 row_half_mirror row_mask:0xf bank_mask:0xf
 s_nop 1
 v_add_f32_dpp v4, v4, v4 row_mirror row_mask:0xf bank_mask:0xf
 v_mov_b32 v6, v4
 s_nop 1
 v_permlane16_swap_b32 v6, v4
 s_nop 1
 v_add_f32 v4, v4, v6
 v_mov_b32 v6, v4
 s_nop 1
 v_permlane32_swap_b32 v6, v4
 s_nop 1
 v_add_f32 v4, v4, v6
 v_mul_f32 v72, s17, v4
 v_sub_f32 v40, v16, v72
 v_sub_f32 v41, v17, v72
 v_sub_f32 v42, v18, v72
 v_sub_f32 v43, v19, v72
 v_sub_f32 v44, v20, v72
 v_sub_f32 v45, v21, v72
 v_sub_f32 v46, v22, v72
 v_sub_f32 v47, v23, v72
 v_sub_f32 v48, v24, v72
 v_sub_f32 v49, v25, v72
 v_sub_f32 v50, v26, v72
 v_sub_f32 v51, v27, v72
 v_sub_f32 v52, v28, v72
 v_sub_f32 v53, v29, v72
 v_sub_f32 v54, v30, v72
 v_sub_f32 v55, v31, v72
 v_mul_f32 v56, v40, v40
 v_mul_f32 v57, v44, v44
 v_mul_f32 v58, v48, v48
 v_mul_f32 v59, v52, v52
 v_fmac_f32 v56, v41, v41
 v_fmac_f32 v57, v45, v45
 v_fmac_f32 v58, v49, v49
 v_fmac_f32 v59, v53, v53
 v_fmac_f32 v56, v42, v42
 v_fmac_f32 v57, v46, v46
 v_fmac_f32 v58, v50, v50
 v_fmac_f32 v59, v54, v54
 v_fmac_f32 v56, v43, v43
 v_fmac_f32 v57, v47, v47
 v_fmac_f32 v58, v51, v51
 v_fmac_f32 v59, v55, v55
 v_add_f32 v56, v56, v57
 v_add_f32 v58, v58, v59
 v_add_f32 v4, v56, v58
 s_nop 1
 v_add_f32_dpp v4, v4, v4 quad_perm:[1,0,3,2] row_mask:0xf bank_mask:0xf
 s_nop 1
 v_add_f32_dpp v4, v4, v4 quad_perm:[2,3,0,1] row_mask:0xf bank_mask:0xf
 s_nop 1
 v_add_f32_dpp v4, v4, v4 row_half_mirror row_mask:0xf bank_mask:0xf
 s_nop 1
 v_add_f32_dpp v4, v4, v4 row_mirror row_mask:0xf bank_mask:0xf
 v_mov_b32 v6, v4
 s_nop 1
 v_permlane16_swap_b32 v6, v4
 s_nop 1
 v_add_f32 v4, v4, v6
 v_mov_b32 v6, v4
 s_nop 1
 v_permlane32_swap_b32 v6, v4
 s_nop 1
 v_add_f32 v4, v4, v6
 v_mul_f32 v4, s17, v4
 v_cvt_pk_bf16_f32 v72, v72, v72
 v_lshlrev_b32 v72, 16, v72
 v_cvt_pk_bf16_f32 v4, v4, v4
 v_lshlrev_b32 v4, 16, v4
 v_add_f32 v4, s18, v4
 v_cvt_pk_bf16_f32 v4, v4, v4
 v_lshlrev_b32 v4, 16, v4
 v_sqrt_f32 v4, v4
 s_nop 0
 v_cvt_pk_bf16_f32 v4, v4, v4
 v_lshlrev_b32 v4, 16, v4
 v_rcp_f32 v4, v4
 v_sub_f32 v16, v16, v72
 v_sub_f32 v17, v17, v72
 v_sub_f32 v18, v18, v72
 v_sub_f32 v19, v19, v72
 v_sub_f32 v20, v20, v72
 v_sub_f32 v21, v21, v72
 v_sub_f32 v22, v22, v72
 v_sub_f32 v23, v23, v72
 v_sub_f32 v24, v24, v72
 v_sub_f32 v25, v25, v72
 v_sub_f32 v26, v26, v72
 v_sub_f32 v27, v27, v72
 v_sub_f32 v28, v28, v72
 v_sub_f32 v29, v29, v72
 v_sub_f32 v30, v30, v72
 v_sub_f32 v31, v31, v72
 v_cvt_pk_bf16_f32 v40, v16, v17
 v_cvt_pk_bf16_f32 v41, v18, v19
 v_cvt_pk_bf16_f32 v42, v20, v21
 v_cvt_pk_bf16_f32 v43, v22, v23
 v_cvt_pk_bf16_f32 v44, v24, v25
 v_cvt_pk_bf16_f32 v45, v26, v27
 v_cvt_pk_bf16_f32 v46, v28, v29
 v_cvt_pk_bf16_f32 v47, v30, v31
 v_lshlrev_b32 v16, 16, v40
 v_and_b32 v17, s16, v40
 v_lshlrev_b32 v18, 16, v41
 v_and_b32 v19, s16, v41
 v_lshlrev_b32 v20, 16, v42
 v_and_b32 v21, s16, v42
 v_lshlrev_b32 v22, 16, v43
 v_and_b32 v23, s16, v43
 v_lshlrev_b32 v24, 16, v44
 v_and_b32 v25, s16, v44
 v_lshlrev_b32 v26, 16, v45
 v_and_b32 v27, s16, v45
 v_lshlrev_b32 v28, 16, v46
 v_and_b32 v29, s16, v46
 v_lshlrev_b32 v30, 16, v47
 v_and_b32 v31, s16, v47
 v_mul_f32 v16, v16, v4
 v_mul_f32 v17, v17, v4
 v_mul_f32 v18, v18, v4
 v_mul_f32 v19, v19, v4
 v_mul_f32 v20, v20, v4
 v_mul_f32 v21, v21, v4
 v_mul_f32 v22, v22, v4
 v_mul_f32 v23, v23, v4
 v_mul_f32 v24, v24, v4
 v_mul_f32 v25, v25, v4
 v_mul_f32 v26, v26, v4
 v_mul_f32 v27, v27, v4
 v_mul_f32 v28, v28, v4
 v_mul_f32 v29, v29, v4
 v_mul_f32 v30, v30, v4
 v_mul_f32 v31, v31, v4
 v_cvt_pk_bf16_f32 v8, v16, v17
 v_cvt_pk_bf16_f32 v9, v18, v19
 v_cvt_pk_bf16_f32 v10, v20, v21
 v_cvt_pk_bf16_f32 v11, v22, v23
 v_cvt_pk_bf16_f32 v12, v24, v25
 v_cvt_pk_bf16_f32 v13, v26, v27
 v_cvt_pk_bf16_f32 v14, v28, v29
 v_cvt_pk_bf16_f32 v15, v30, v31
 buffer_store_dwordx4 v[8:11], v76, s[12:15], 0 offen
 buffer_store_dwordx4 v[12:15], v76, s[12:15], s26 offen
L_ln_kernel_end:
 s_endpgm
.globl gemm1_kernel
.p2align 8
.type gemm1_kernel,@function
gemm1_kernel:

 s_cmp_ge_u32 s2, 256
 s_cbranch_scc1 L_gemm1_kernel_end
 s_load_dwordx2 s[4:5], s[0:1], 88
 s_load_dwordx4 s[8:11], s[0:1], 8
 s_load_dwordx2 s[12:13], s[0:1], 24
 s_load_dwordx4 s[16:19], s[0:1], 48
 s_load_dwordx2 s[90:91], s[0:1], 32
 s_load_dwordx2 s[92:93], s[0:1], 64
 v_lshrrev_b32 v1, 6, v0
 v_and_b32 v0, 63, v0
 v_readfirstlane_b32 s20, v1
 s_lshr_b32 s21, s2, 3
 s_and_b32 s21, s21, 7
 s_and_b32 s22, s2, 7
 s_lshl_b32 s22, s22, 2
 s_lshr_b32 s52, s2, 6
 s_add_u32 s22, s22, s52
 s_lshr_b32 s48, s22, 1
 s_nop 2
 s_lshr_b32 s49, s20, 1
 s_and_b32 s50, s20, 1
 s_cmp_lt_u32 s22, 4
 s_movk_i32 s52, 2048
 s_cselect_b32 s23, s52, 7168
 s_and_b32 s54, s20, 3
 v_lshlrev_b32 v186, 4, v0
 s_lshl_b32 s52, s54, 12
 v_add_u32 v186, s52, v186
 v_lshrrev_b32 v187, 4, v0
 v_mul_lo_u32 v188, v187, s23
 v_lshlrev_b32 v187, 1, v187
 s_and_b32 s52, s54, 1
 v_add_u32 v187, s52, v187
 v_lshrrev_b32 v189, 1, v0
 v_xor_b32 v189, v189, v187
 v_and_b32 v189, 7, v189
 v_lshl_add_u32 v188, v189, 5, v188
 v_and_b32 v189, 1, v0
 v_lshl_add_u32 v188, v189, 4, v188
 s_mul_i32 s52, s54, s23
 s_lshl_b32 s52, s52, 3
 v_add_u32 v188, s52, v188
 s_lshl_b32 s53, s23, 2
 s_sub_u32 s53, s53, 2048
 v_add_u32 v174, 0, v186
 v_add_u32 v175, 0, v186
 v_add_u32 v176, 0, v186
 v_add_u32 v177, 0, v186
 v_mov_b32 v178, v188
 v_mov_b32 v179, v188
 v_add_u32 v180, s53, v188
 v_add_u32 v181, s53, v188
 s_lshl_b32 s43, s23, 5
 s_lshl_b32 s44, s54, 12
 s_add_u32 s45, s44, 16384
 s_mov_b32 s40, 0
 s_mov_b32 s41, 0
 s_mov_b32 s42, 0
 v_lshrrev_b32 v185, 2, v0
 v_lshlrev_b32 v185, 6, v185
 v_and_b32 v189, 3, v0
 v_lshl_add_u32 v185, v189, 4, v185
 s_and_b32 s52, s20, 1
 s_lshl_b32 s52, s52, 10
 v_add_u32 v185, s52, v185
 s_lshl_b32 s46, s20, 10
 s_add_u32 s46, s46, 131072
 s_mul_i32 s52, s2, 256
 s_lshl_b32 s53, s20, 6
 s_add_u32 s52, s52, s53
 v_add_u32 v1, s52, v0
 v_mul_u32_u24 v1, 128, v1
 s_waitcnt lgkmcnt(0)
 s_cmp_lt_u32 s22, 4
 s_cselect_b32 s54, s8, s16
 s_cselect_b32 s55, s9, s17
 s_cselect_b32 s56, s8, s18
 s_cselect_b32 s57, s9, s19
 s_lshl_b32 s52, s22, 9
 s_sub_u32 s53, s22, 4
 s_lshl_b32 s53, s53, 8
 s_cmp_lt_u32 s22, 4
 s_cselect_b32 s58, s52, s53
 s_cselect_b32 s59, 256, 0
 s_add_u32 s59, s59, s58
 s_lshl_b32 s60, s23, 10
 s_add_u32 s28, s54, s58
 s_addc_u32 s29, s55, 0
 s_and_b32 s29, s29, 0xffff
 s_sub_u32 s30, s60, s58
 s_mov_b32 s31, 0x20000
 s_add_u32 s32, s56, s59
 s_addc_u32 s33, s57, 0
 s_sub_u32 s32, s32, 1024
 s_subb_u32 s33, s33, 0
 s_and_b32 s33, s33, 0xffff
 s_sub_u32 s34, s60, s59
 s_add_u32 s34, s34, 1024
 s_mov_b32 s35, 0x20000
 s_lshl_b32 s52, s21, 19
 s_add_u32 s52, s52, 0
 s_add_u32 s24, s4, s52
 s_addc_u32 s25, s5, 0
 s_and_b32 s25, s25, 0xffff
 s_mov_b32 s26, 524288
 s_mov_b32 s27, 0x20000
 s_cmp_lt_u32 s20, 2
 s_cselect_b32 s36, s10, s12
 s_cselect_b32 s37, s11, s13
 s_and_b32 s37, s37, 0xffff
 s_mov_b32 s38, 65536
 s_mov_b32 s39, 0x20000
 s_bitcmp0_b32 s22, 0
 s_cbranch_scc0 L_gemm1_kernel_nokv
 s_add_u32 m0, s44, 0
 s_nop 0
 buffer_load_dwordx4 v174, s[24:27], s40 offen offset:0 lds
 buffer_load_dwordx4 v175, s[24:27], s40 offen offset:1024 lds
 buffer_load_dwordx4 v176, s[24:27], s40 offen offset:2048 lds
 buffer_load_dwordx4 v177, s[24:27], s40 offen offset:3072 lds
 s_add_u32 s40, s40, 16384
 s_add_u32 m0, s45, 0
 s_nop 0
 buffer_load_dwordx4 v178, s[28:31], s41 offen offset:0 lds
 buffer_load_dwordx4 v179, s[32:35], s41 offen offset:1024 lds
 buffer_load_dwordx4 v180, s[28:31], s41 offen offset:2048 lds
 buffer_load_dwordx4 v181, s[32:35], s41 offen offset:3072 lds
 s_add_u32 s41, s41, s43
 s_add_u32 m0, s46, 0
 s_nop 0
 buffer_load_dwordx4 v185, s[36:39], s42 offen lds
 s_add_u32 s42, s42, 2048
 s_add_u32 m0, s44, 32768
 s_nop 0
 buffer_load_dwordx4 v174, s[24:27], s40 offen offset:0 lds
 buffer_load_dwordx4 v175, s[24:27], s40 offen offset:1024 lds
 buffer_load_dwordx4 v176, s[24:27], s40 offen offset:2048 lds
 buffer_load_dwordx4 v177, s[24:27], s40 offen offset:3072 lds
 s_add_u32 s40, s40, 16384
 s_add_u32 m0, s45, 32768
 s_nop 0
 buffer_load_dwordx4 v178, s[28:31], s41 offen offset:0 lds
 buffer_load_dwordx4 v179, s[32:35], s41 offen offset:1024 lds
 buffer_load_dwordx4 v180, s[28:31], s41 offen offset:2048 lds
 buffer_load_dwordx4 v181, s[32:35], s41 offen offset:3072 lds
 s_add_u32 s41, s41, s43
 s_add_u32 m0, s46, 4096
 s_nop 0
 buffer_load_dwordx4 v185, s[36:39], s42 offen lds
 s_add_u32 s42, s42, 2048
 v_bfe_u32 v187, v0, 2, 2
 v_lshrrev_b32 v186, 4, v0
 v_lshlrev_b32 v188, 12, v186
 v_lshl_add_u32 v188, v187, 8, v188
 v_and_b32 v189, 3, v0
 v_lshl_add_u32 v188, v189, 3, v188
 v_add_u32 v188, 16384, v188
 v_and_b32 v189, 1, v186
 v_lshl_add_u32 v2, v187, 1, v189
 s_lshl_b32 s52, s49, 2
 s_add_u32 s52, s52, 0
 v_xor_b32 v189, s52, v2
 v_lshl_add_u32 v164, v189, 5, v188
 v_add_u32 v165, 65536, v164
 s_lshl_b32 s52, s49, 2
 s_add_u32 s52, s52, 1
 v_xor_b32 v189, s52, v2
 v_lshl_add_u32 v166, v189, 5, v188
 v_add_u32 v167, 65536, v166
 s_lshl_b32 s52, s49, 2
 s_add_u32 s52, s52, 2
 v_xor_b32 v189, s52, v2
 v_lshl_add_u32 v168, v189, 5, v188
 v_add_u32 v169, 65536, v168
 s_lshl_b32 s52, s49, 2
 s_add_u32 s52, s52, 3
 v_xor_b32 v189, s52, v2
 v_lshl_add_u32 v170, v189, 5, v188
 v_add_u32 v171, 65536, v170
 s_lshl_b32 s52, s50, 13
 v_and_b32 v188, 15, v0
 v_lshrrev_b32 v189, 4, v0
 v_lshrrev_b32 v2, 2, v188
 v_sub_u32 v2, 0, v2
 v_xor_b32 v189, v189, v2
 v_and_b32 v189, 3, v189
 v_lshlrev_b32 v188, 6, v188
 v_add_u32 v188, s52, v188
 v_lshl_add_u32 v172, v189, 4, v188
 v_add_u32 v173, 65536, v172
 v_bfe_u32 v187, v0, 2, 2
 v_lshrrev_b32 v186, 4, v0
 v_lshlrev_b32 v188, 9, v186
 v_lshl_add_u32 v188, v187, 6, v188
 v_and_b32 v189, 3, v0
 v_lshl_add_u32 v188, v189, 3, v188
 s_lshr_b32 s52, s20, 1
 s_lshl_b32 s52, s52, 11
 s_and_b32 s53, s20, 1
 s_lshl_b32 s53, s53, 5
 s_add_u32 s52, s52, s53
 s_add_u32 s52, s52, 131072
 v_add_u32 v182, s52, v188
 s_and_b32 s52, s48, 15
 s_lshl_b32 s52, s52, 10
 v_and_b32 v188, 15, v0
 v_lshrrev_b32 v189, 4, v0
 v_lshrrev_b32 v2, 2, v188
 v_sub_u32 v2, 0, v2
 v_xor_b32 v189, v189, v2
 v_and_b32 v189, 3, v189
 v_lshlrev_b32 v188, 6, v188
 v_add_u32 v188, s52, v188
 v_lshl_add_u32 v183, v189, 4, v188
 v_add_u32 v184, 65536, v183
 s_mov_b32 s47, 0
 s_waitcnt vmcnt(9)
 s_barrier
 ds_read_b64_tr_b16 v[16:17], v164 offset:0
 ds_read_b64_tr_b16 v[18:19], v164 offset:2048
 ds_read_b128 v[48:51], v172 offset:0
 ds_read_b64_tr_b16 v[20:21], v166 offset:0
 ds_read_b64_tr_b16 v[22:23], v166 offset:2048
 ds_read_b128 v[52:55], v172 offset:1024
 ds_read_b64_tr_b16 v[24:25], v168 offset:0
 ds_read_b64_tr_b16 v[26:27], v168 offset:2048
 ds_read_b128 v[56:59], v172 offset:2048
 ds_read_b64_tr_b16 v[28:29], v170 offset:0
 ds_read_b64_tr_b16 v[30:31], v170 offset:2048
 ds_read_b128 v[60:63], v172 offset:3072
 ds_read_b64_tr_b16 v[32:33], v164 offset:1024
 ds_read_b64_tr_b16 v[34:35], v164 offset:3072
 ds_read_b128 v[64:67], v172 offset:4096
 ds_read_b64_tr_b16 v[36:37], v166 offset:1024
 ds_read_b64_tr_b16 v[38:39], v166 offset:3072
 ds_read_b128 v[68:71], v172 offset:5120
 ds_read_b64_tr_b16 v[40:41], v168 offset:1024
 ds_read_b64_tr_b16 v[42:43], v168 offset:3072
 ds_read_b128 v[72:75], v172 offset:6144
 ds_read_b64_tr_b16 v[44:45], v170 offset:1024
 ds_read_b64_tr_b16 v[46:47], v170 offset:3072
 ds_read_b128 v[76:79], v172 offset:7168
 ds_read_b64_tr_b16 v[144:145], v182 offset:0
 ds_read_b64_tr_b16 v[146:147], v182 offset:256
 ds_read_b128 v[148:151], v183 offset:0
 s_waitcnt lgkmcnt(0)
 v_mfma_f32_16x16x32_bf16 a[0:3], v[16:19], v[48:51], 0
 s_add_u32 m0, s44, 65536
 v_mfma_f32_16x16x32_bf16 a[4:7], v[16:19], v[52:55], 0
 buffer_load_dwordx4 v174, s[24:27], s40 offen offset:0 lds
 v_mfma_f32_16x16x32_bf16 a[8:11], v[16:19], v[56:59], 0
 buffer_load_dwordx4 v175, s[24:27], s40 offen offset:1024 lds
 v_mfma_f32_16x16x32_bf16 a[12:15], v[16:19], v[60:63], 0
 v_mfma_f32_16x16x32_bf16 a[16:19], v[16:19], v[64:67], 0
 buffer_load_dwordx4 v176, s[24:27], s40 offen offset:2048 lds
 v_mfma_f32_16x16x32_bf16 a[20:23], v[16:19], v[68:71], 0
 buffer_load_dwordx4 v177, s[24:27], s40 offen offset:3072 lds
 s_add_u32 s40, s40, 16384
 v_mfma_f32_16x16x32_bf16 v[192:195], v[16:19], v[72:75], 0
 s_add_u32 m0, s45, 65536
 v_mfma_f32_16x16x32_bf16 v[196:199], v[16:19], v[76:79], 0
 v_mfma_f32_16x16x32_bf16 v[204:207], v[20:23], v[76:79], 0
 buffer_load_dwordx4 v178, s[28:31], s41 offen offset:0 lds
 v_mfma_f32_16x16x32_bf16 v[200:203], v[20:23], v[72:75], 0
 buffer_load_dwordx4 v179, s[32:35], s41 offen offset:1024 lds
 v_mfma_f32_16x16x32_bf16 a[52:55], v[20:23], v[68:71], 0
 buffer_load_dwordx4 v180, s[28:31], s41 offen offset:2048 lds
 v_mfma_f32_16x16x32_bf16 a[48:51], v[20:23], v[64:67], 0
 v_mfma_f32_16x16x32_bf16 a[44:47], v[20:23], v[60:63], 0
 buffer_load_dwordx4 v181, s[32:35], s41 offen offset:3072 lds
 s_add_u32 s41, s41, s43
 v_mfma_f32_16x16x32_bf16 a[40:43], v[20:23], v[56:59], 0
 s_add_u32 m0, s46, 8192
 v_mfma_f32_16x16x32_bf16 a[36:39], v[20:23], v[52:55], 0
 buffer_load_dwordx4 v185, s[36:39], s42 offen lds
 s_add_u32 s42, s42, 2048
 v_mfma_f32_16x16x32_bf16 a[32:35], v[20:23], v[48:51], 0
 s_waitcnt vmcnt(9)
 s_barrier
 v_mfma_f32_16x16x32_bf16 a[64:67], v[24:27], v[48:51], 0
 ds_read_b64_tr_b16 v[80:81], v164 offset:32768
 v_mfma_f32_16x16x32_bf16 a[68:71], v[24:27], v[52:55], 0
 ds_read_b64_tr_b16 v[82:83], v164 offset:34816
 s_add_u32 m0, s44, 98304
 v_mfma_f32_16x16x32_bf16 a[72:75], v[24:27], v[56:59], 0
 ds_read_b128 v[112:115], v172 offset:32768
 buffer_load_dwordx4 v174, s[24:27], s40 offen offset:0 lds
 v_mfma_f32_16x16x32_bf16 a[76:79], v[24:27], v[60:63], 0
 v_mfma_f32_16x16x32_bf16 a[80:83], v[24:27], v[64:67], 0
 ds_read_b64_tr_b16 v[84:85], v166 offset:32768
 buffer_load_dwordx4 v175, s[24:27], s40 offen offset:1024 lds
 v_mfma_f32_16x16x32_bf16 a[84:87], v[24:27], v[68:71], 0
 ds_read_b64_tr_b16 v[86:87], v166 offset:34816
 v_mfma_f32_16x16x32_bf16 v[208:211], v[24:27], v[72:75], 0
 buffer_load_dwordx4 v176, s[24:27], s40 offen offset:2048 lds
 v_mfma_f32_16x16x32_bf16 v[212:215], v[24:27], v[76:79], 0
 ds_read_b128 v[116:119], v172 offset:33792
 v_mfma_f32_16x16x32_bf16 v[220:223], v[28:31], v[76:79], 0
 ds_read_b64_tr_b16 v[88:89], v168 offset:32768
 buffer_load_dwordx4 v177, s[24:27], s40 offen offset:3072 lds
 s_add_u32 s40, s40, 16384
 v_mfma_f32_16x16x32_bf16 v[216:219], v[28:31], v[72:75], 0
 v_mfma_f32_16x16x32_bf16 a[116:119], v[28:31], v[68:71], 0
 ds_read_b64_tr_b16 v[90:91], v168 offset:34816
 s_add_u32 m0, s45, 98304
 v_mfma_f32_16x16x32_bf16 a[112:115], v[28:31], v[64:67], 0
 ds_read_b128 v[120:123], v172 offset:34816
 v_mfma_f32_16x16x32_bf16 a[108:111], v[28:31], v[60:63], 0
 buffer_load_dwordx4 v178, s[28:31], s41 offen offset:0 lds
 v_mfma_f32_16x16x32_bf16 a[104:107], v[28:31], v[56:59], 0
 ds_read_b64_tr_b16 v[92:93], v170 offset:32768
 v_mfma_f32_16x16x32_bf16 a[100:103], v[28:31], v[52:55], 0
 ds_read_b64_tr_b16 v[94:95], v170 offset:34816
 buffer_load_dwordx4 v179, s[32:35], s41 offen offset:1024 lds
 v_mfma_f32_16x16x32_bf16 a[96:99], v[28:31], v[48:51], 0
 ds_read_b128 v[124:127], v172 offset:35840
 v_mfma_f32_16x16x32_bf16 a[128:131], v[32:35], v[48:51], 0
 buffer_load_dwordx4 v180, s[28:31], s41 offen offset:2048 lds
 v_mfma_f32_16x16x32_bf16 a[132:135], v[32:35], v[52:55], 0
 ds_read_b64_tr_b16 v[96:97], v164 offset:33792
 v_mfma_f32_16x16x32_bf16 a[136:139], v[32:35], v[56:59], 0
 ds_read_b64_tr_b16 v[98:99], v164 offset:35840
 buffer_load_dwordx4 v181, s[32:35], s41 offen offset:3072 lds
 s_add_u32 s41, s41, s43
 v_mfma_f32_16x16x32_bf16 a[140:143], v[32:35], v[60:63], 0
 v_mfma_f32_16x16x32_bf16 a[144:147], v[32:35], v[64:67], 0
 ds_read_b128 v[128:131], v172 offset:36864
 s_add_u32 m0, s46, 12288
 v_mfma_f32_16x16x32_bf16 a[148:151], v[32:35], v[68:71], 0
 ds_read_b64_tr_b16 v[100:101], v166 offset:33792
 v_mfma_f32_16x16x32_bf16 v[224:227], v[32:35], v[72:75], 0
 buffer_load_dwordx4 v185, s[36:39], s42 offen lds
 s_add_u32 s42, s42, 2048
 v_mfma_f32_16x16x32_bf16 v[228:231], v[32:35], v[76:79], 0
 ds_read_b64_tr_b16 v[102:103], v166 offset:35840
 v_mfma_f32_16x16x32_bf16 v[236:239], v[36:39], v[76:79], 0
 ds_read_b128 v[132:135], v172 offset:37888
 s_add_u32 m0, s44, 0
 v_mfma_f32_16x16x32_bf16 v[232:235], v[36:39], v[72:75], 0
 v_mfma_f32_16x16x32_bf16 a[180:183], v[36:39], v[68:71], 0
 ds_read_b64_tr_b16 v[104:105], v168 offset:33792
 buffer_load_dwordx4 v174, s[24:27], s40 offen offset:0 lds
 v_mfma_f32_16x16x32_bf16 a[176:179], v[36:39], v[64:67], 0
 ds_read_b64_tr_b16 v[106:107], v168 offset:35840
 v_mfma_f32_16x16x32_bf16 a[172:175], v[36:39], v[60:63], 0
 ds_read_b128 v[136:139], v172 offset:38912
 buffer_load_dwordx4 v175, s[24:27], s40 offen offset:1024 lds
 v_mfma_f32_16x16x32_bf16 a[168:171], v[36:39], v[56:59], 0
 v_mfma_f32_16x16x32_bf16 a[164:167], v[36:39], v[52:55], 0
 ds_read_b64_tr_b16 v[108:109], v170 offset:33792
 buffer_load_dwordx4 v176, s[24:27], s40 offen offset:2048 lds
 v_mfma_f32_16x16x32_bf16 a[160:163], v[36:39], v[48:51], 0
 ds_read_b64_tr_b16 v[110:111], v170 offset:35840
 v_mfma_f32_16x16x32_bf16 a[192:195], v[40:43], v[48:51], 0
 buffer_load_dwordx4 v177, s[24:27], s40 offen offset:3072 lds
 s_add_u32 s40, s40, 16384
 v_mfma_f32_16x16x32_bf16 a[196:199], v[40:43], v[52:55], 0
 ds_read_b128 v[140:143], v172 offset:39936
 v_mfma_f32_16x16x32_bf16 a[200:203], v[40:43], v[56:59], 0
 ds_read_b64_tr_b16 v[152:153], v182 offset:4096
 s_add_u32 m0, s45, 0
 v_mfma_f32_16x16x32_bf16 a[204:207], v[40:43], v[60:63], 0
 v_mfma_f32_16x16x32_bf16 a[208:211], v[40:43], v[64:67], 0
 ds_read_b64_tr_b16 v[154:155], v182 offset:4352
 buffer_load_dwordx4 v178, s[28:31], s41 offen offset:0 lds
 v_mfma_f32_16x16x32_bf16 a[212:215], v[40:43], v[68:71], 0
 ds_read_b128 v[156:159], v183 offset:32768
 v_mfma_f32_16x16x32_bf16 v[240:243], v[40:43], v[72:75], 0
 buffer_load_dwordx4 v179, s[32:35], s41 offen offset:1024 lds
 v_mfma_f32_16x16x32_bf16 v[244:247], v[40:43], v[76:79], 0
 v_mfma_f32_16x16x32_bf16 v[252:255], v[44:47], v[76:79], 0
 buffer_load_dwordx4 v180, s[28:31], s41 offen offset:2048 lds
 v_mfma_f32_16x16x32_bf16 v[248:251], v[44:47], v[72:75], 0
 v_mfma_f32_16x16x32_bf16 a[244:247], v[44:47], v[68:71], 0
 buffer_load_dwordx4 v181, s[32:35], s41 offen offset:3072 lds
 s_add_u32 s41, s41, s43
 v_mfma_f32_16x16x32_bf16 a[240:243], v[44:47], v[64:67], 0
 v_mfma_f32_16x16x32_bf16 a[236:239], v[44:47], v[60:63], 0
 s_add_u32 m0, s46, 0
 v_mfma_f32_16x16x32_bf16 a[232:235], v[44:47], v[56:59], 0
 v_mfma_f32_16x16x32_bf16 a[228:231], v[44:47], v[52:55], 0
 buffer_load_dwordx4 v185, s[36:39], s42 offen lds
 s_add_u32 s42, s42, 2048
 v_mfma_f32_16x16x32_bf16 a[224:227], v[44:47], v[48:51], 0
 v_mfma_f32_16x16x32_bf16 v[160:163], v[144:147], v[148:151], 0
.p2align 6
L_gemm1_kernel_lkv:
 s_waitcnt vmcnt(18) lgkmcnt(0)
 s_barrier
 v_mfma_f32_16x16x32_bf16 a[0:3], v[80:83], v[112:115], a[0:3]
 ds_read_b64_tr_b16 v[16:17], v165 offset:0
 v_mfma_f32_16x16x32_bf16 a[4:7], v[80:83], v[116:119], a[4:7]
 ds_read_b64_tr_b16 v[18:19], v165 offset:2048
 s_add_u32 m0, s44, 32768
 v_mfma_f32_16x16x32_bf16 a[8:11], v[80:83], v[120:123], a[8:11]
 v_mfma_f32_16x16x32_bf16 a[12:15], v[80:83], v[124:127], a[12:15]
 ds_read_b128 v[48:51], v173 offset:0
 v_mfma_f32_16x16x32_bf16 a[16:19], v[80:83], v[128:131], a[16:19]
 v_mfma_f32_16x16x32_bf16 a[20:23], v[80:83], v[132:135], a[20:23]
 ds_read_b64_tr_b16 v[20:21], v167 offset:0
 v_mfma_f32_16x16x32_bf16 v[192:195], v[80:83], v[136:139], v[192:195]
 ds_read_b64_tr_b16 v[22:23], v167 offset:2048
 buffer_load_dwordx4 v174, s[24:27], s40 offen offset:0 lds
 v_mfma_f32_16x16x32_bf16 v[196:199], v[80:83], v[140:143], v[196:199]
 v_mfma_f32_16x16x32_bf16 v[204:207], v[84:87], v[140:143], v[204:207]
 ds_read_b128 v[52:55], v173 offset:1024
 v_mfma_f32_16x16x32_bf16 v[200:203], v[84:87], v[136:139], v[200:203]
 v_mfma_f32_16x16x32_bf16 a[52:55], v[84:87], v[132:135], a[52:55]
 ds_read_b64_tr_b16 v[24:25], v169 offset:0
 v_mfma_f32_16x16x32_bf16 a[48:51], v[84:87], v[128:131], a[48:51]
 ds_read_b64_tr_b16 v[26:27], v169 offset:2048
 buffer_load_dwordx4 v175, s[24:27], s40 offen offset:1024 lds
 v_mfma_f32_16x16x32_bf16 a[44:47], v[84:87], v[124:127], a[44:47]
 v_mfma_f32_16x16x32_bf16 a[40:43], v[84:87], v[120:123], a[40:43]
 ds_read_b128 v[56:59], v173 offset:2048
 v_mfma_f32_16x16x32_bf16 a[36:39], v[84:87], v[116:119], a[36:39]
 v_mfma_f32_16x16x32_bf16 a[32:35], v[84:87], v[112:115], a[32:35]
 ds_read_b64_tr_b16 v[28:29], v171 offset:0
 v_mfma_f32_16x16x32_bf16 a[64:67], v[88:91], v[112:115], a[64:67]
 ds_read_b64_tr_b16 v[30:31], v171 offset:2048
 buffer_load_dwordx4 v176, s[24:27], s40 offen offset:2048 lds
 v_mfma_f32_16x16x32_bf16 a[68:71], v[88:91], v[116:119], a[68:71]
 v_mfma_f32_16x16x32_bf16 a[72:75], v[88:91], v[120:123], a[72:75]
 ds_read_b128 v[60:63], v173 offset:3072
 v_mfma_f32_16x16x32_bf16 a[76:79], v[88:91], v[124:127], a[76:79]
 v_mfma_f32_16x16x32_bf16 a[80:83], v[88:91], v[128:131], a[80:83]
 ds_read_b64_tr_b16 v[32:33], v165 offset:1024
 v_mfma_f32_16x16x32_bf16 a[84:87], v[88:91], v[132:135], a[84:87]
 ds_read_b64_tr_b16 v[34:35], v165 offset:3072
 v_mfma_f32_16x16x32_bf16 v[208:211], v[88:91], v[136:139], v[208:211]
 buffer_load_dwordx4 v177, s[24:27], s40 offen offset:3072 lds
 s_add_u32 s40, s40, 16384
 v_mfma_f32_16x16x32_bf16 v[212:215], v[88:91], v[140:143], v[212:215]
 ds_read_b128 v[64:67], v173 offset:4096
 v_mfma_f32_16x16x32_bf16 v[220:223], v[92:95], v[140:143], v[220:223]
 v_mfma_f32_16x16x32_bf16 v[216:219], v[92:95], v[136:139], v[216:219]
 ds_read_b64_tr_b16 v[36:37], v167 offset:1024
 v_mfma_f32_16x16x32_bf16 a[116:119], v[92:95], v[132:135], a[116:119]
 ds_read_b64_tr_b16 v[38:39], v167 offset:3072
 v_mfma_f32_16x16x32_bf16 a[112:115], v[92:95], v[128:131], a[112:115]
 s_add_u32 m0, s45, 32768
 v_mfma_f32_16x16x32_bf16 a[108:111], v[92:95], v[124:127], a[108:111]
 ds_read_b128 v[68:71], v173 offset:5120
 v_mfma_f32_16x16x32_bf16 a[104:107], v[92:95], v[120:123], a[104:107]
 v_mfma_f32_16x16x32_bf16 a[100:103], v[92:95], v[116:119], a[100:103]
 ds_read_b64_tr_b16 v[40:41], v169 offset:1024
 v_mfma_f32_16x16x32_bf16 a[96:99], v[92:95], v[112:115], a[96:99]
 ds_read_b64_tr_b16 v[42:43], v169 offset:3072
 v_mfma_f32_16x16x32_bf16 a[128:131], v[96:99], v[112:115], a[128:131]
 buffer_load_dwordx4 v178, s[28:31], s41 offen offset:0 lds
 v_mfma_f32_16x16x32_bf16 a[132:135], v[96:99], v[116:119], a[132:135]
 ds_read_b128 v[72:75], v173 offset:6144
 v_mfma_f32_16x16x32_bf16 a[136:139], v[96:99], v[120:123], a[136:139]
 v_mfma_f32_16x16x32_bf16 a[140:143], v[96:99], v[124:127], a[140:143]
 ds_read_b64_tr_b16 v[44:45], v171 offset:1024
 v_mfma_f32_16x16x32_bf16 a[144:147], v[96:99], v[128:131], a[144:147]
 ds_read_b64_tr_b16 v[46:47], v171 offset:3072
 v_mfma_f32_16x16x32_bf16 a[148:151], v[96:99], v[132:135], a[148:151]
 buffer_load_dwordx4 v179, s[32:35], s41 offen offset:1024 lds
 v_mfma_f32_16x16x32_bf16 v[224:227], v[96:99], v[136:139], v[224:227]
 ds_read_b128 v[76:79], v173 offset:7168
 v_mfma_f32_16x16x32_bf16 v[228:231], v[96:99], v[140:143], v[228:231]
 v_mfma_f32_16x16x32_bf16 v[236:239], v[100:103], v[140:143], v[236:239]
 ds_read_b64_tr_b16 v[144:145], v182 offset:8192
 v_mfma_f32_16x16x32_bf16 v[232:235], v[100:103], v[136:139], v[232:235]
 ds_read_b64_tr_b16 v[146:147], v182 offset:8448
 v_mfma_f32_16x16x32_bf16 a[180:183], v[100:103], v[132:135], a[180:183]
 v_mfma_f32_16x16x32_bf16 a[176:179], v[100:103], v[128:131], a[176:179]
 ds_read_b128 v[148:151], v184 offset:0
 buffer_load_dwordx4 v180, s[28:31], s41 offen offset:2048 lds
 v_mfma_f32_16x16x32_bf16 a[172:175], v[100:103], v[124:127], a[172:175]
 v_mfma_f32_16x16x32_bf16 a[168:171], v[100:103], v[120:123], a[168:171]
 v_mfma_f32_16x16x32_bf16 a[164:167], v[100:103], v[116:119], a[164:167]
 v_mfma_f32_16x16x32_bf16 a[160:163], v[100:103], v[112:115], a[160:163]
 v_mfma_f32_16x16x32_bf16 a[192:195], v[104:107], v[112:115], a[192:195]
 buffer_load_dwordx4 v181, s[32:35], s41 offen offset:3072 lds
 s_add_u32 s41, s41, s43
 v_mfma_f32_16x16x32_bf16 a[196:199], v[104:107], v[116:119], a[196:199]
 v_mfma_f32_16x16x32_bf16 a[200:203], v[104:107], v[120:123], a[200:203]
 v_mfma_f32_16x16x32_bf16 a[204:207], v[104:107], v[124:127], a[204:207]
 v_mfma_f32_16x16x32_bf16 a[208:211], v[104:107], v[128:131], a[208:211]
 v_mfma_f32_16x16x32_bf16 a[212:215], v[104:107], v[132:135], a[212:215]
 s_add_u32 m0, s46, 4096
 v_mfma_f32_16x16x32_bf16 v[240:243], v[104:107], v[136:139], v[240:243]
 v_mfma_f32_16x16x32_bf16 v[244:247], v[104:107], v[140:143], v[244:247]
 v_mfma_f32_16x16x32_bf16 v[252:255], v[108:111], v[140:143], v[252:255]
 v_mfma_f32_16x16x32_bf16 v[248:251], v[108:111], v[136:139], v[248:251]
 v_mfma_f32_16x16x32_bf16 a[244:247], v[108:111], v[132:135], a[244:247]
 buffer_load_dwordx4 v185, s[36:39], s42 offen lds
 s_add_u32 s42, s42, 2048
 v_mfma_f32_16x16x32_bf16 a[240:243], v[108:111], v[128:131], a[240:243]
 v_mfma_f32_16x16x32_bf16 a[236:239], v[108:111], v[124:127], a[236:239]
 v_mfma_f32_16x16x32_bf16 a[232:235], v[108:111], v[120:123], a[232:235]
 v_mfma_f32_16x16x32_bf16 a[228:231], v[108:111], v[116:119], a[228:231]
 v_mfma_f32_16x16x32_bf16 a[224:227], v[108:111], v[112:115], a[224:227]
 v_mfma_f32_16x16x32_bf16 v[160:163], v[152:155], v[156:159], v[160:163]
 s_waitcnt vmcnt(18) lgkmcnt(0)
 s_barrier
 v_mfma_f32_16x16x32_bf16 a[0:3], v[16:19], v[48:51], a[0:3]
 ds_read_b64_tr_b16 v[80:81], v165 offset:32768
 v_mfma_f32_16x16x32_bf16 a[4:7], v[16:19], v[52:55], a[4:7]
 ds_read_b64_tr_b16 v[82:83], v165 offset:34816
 s_add_u32 m0, s44, 65536
 v_mfma_f32_16x16x32_bf16 a[8:11], v[16:19], v[56:59], a[8:11]
 v_mfma_f32_16x16x32_bf16 a[12:15], v[16:19], v[60:63], a[12:15]
 ds_read_b128 v[112:115], v173 offset:32768
 v_mfma_f32_16x16x32_bf16 a[16:19], v[16:19], v[64:67], a[16:19]
 v_mfma_f32_16x16x32_bf16 a[20:23], v[16:19], v[68:71], a[20:23]
 ds_read_b64_tr_b16 v[84:85], v167 offset:32768
 v_mfma_f32_16x16x32_bf16 v[192:195], v[16:19], v[72:75], v[192:195]
 ds_read_b64_tr_b16 v[86:87], v167 offset:34816
 buffer_load_dwordx4 v174, s[24:27], s40 offen offset:0 lds
 v_mfma_f32_16x16x32_bf16 v[196:199], v[16:19], v[76:79], v[196:199]
 v_mfma_f32_16x16x32_bf16 v[204:207], v[20:23], v[76:79], v[204:207]
 ds_read_b128 v[116:119], v173 offset:33792
 v_mfma_f32_16x16x32_bf16 v[200:203], v[20:23], v[72:75], v[200:203]
 v_mfma_f32_16x16x32_bf16 a[52:55], v[20:23], v[68:71], a[52:55]
 ds_read_b64_tr_b16 v[88:89], v169 offset:32768
 v_mfma_f32_16x16x32_bf16 a[48:51], v[20:23], v[64:67], a[48:51]
 ds_read_b64_tr_b16 v[90:91], v169 offset:34816
 buffer_load_dwordx4 v175, s[24:27], s40 offen offset:1024 lds
 v_mfma_f32_16x16x32_bf16 a[44:47], v[20:23], v[60:63], a[44:47]
 v_mfma_f32_16x16x32_bf16 a[40:43], v[20:23], v[56:59], a[40:43]
 ds_read_b128 v[120:123], v173 offset:34816
 v_mfma_f32_16x16x32_bf16 a[36:39], v[20:23], v[52:55], a[36:39]
 v_mfma_f32_16x16x32_bf16 a[32:35], v[20:23], v[48:51], a[32:35]
 ds_read_b64_tr_b16 v[92:93], v171 offset:32768
 v_mfma_f32_16x16x32_bf16 a[64:67], v[24:27], v[48:51], a[64:67]
 ds_read_b64_tr_b16 v[94:95], v171 offset:34816
 buffer_load_dwordx4 v176, s[24:27], s40 offen offset:2048 lds
 v_mfma_f32_16x16x32_bf16 a[68:71], v[24:27], v[52:55], a[68:71]
 v_mfma_f32_16x16x32_bf16 a[72:75], v[24:27], v[56:59], a[72:75]
 ds_read_b128 v[124:127], v173 offset:35840
 v_mfma_f32_16x16x32_bf16 a[76:79], v[24:27], v[60:63], a[76:79]
 v_mfma_f32_16x16x32_bf16 a[80:83], v[24:27], v[64:67], a[80:83]
 ds_read_b64_tr_b16 v[96:97], v165 offset:33792
 v_mfma_f32_16x16x32_bf16 a[84:87], v[24:27], v[68:71], a[84:87]
 ds_read_b64_tr_b16 v[98:99], v165 offset:35840
 v_mfma_f32_16x16x32_bf16 v[208:211], v[24:27], v[72:75], v[208:211]
 buffer_load_dwordx4 v177, s[24:27], s40 offen offset:3072 lds
 s_add_u32 s40, s40, 16384
 v_mfma_f32_16x16x32_bf16 v[212:215], v[24:27], v[76:79], v[212:215]
 ds_read_b128 v[128:131], v173 offset:36864
 v_mfma_f32_16x16x32_bf16 v[220:223], v[28:31], v[76:79], v[220:223]
 v_mfma_f32_16x16x32_bf16 v[216:219], v[28:31], v[72:75], v[216:219]
 ds_read_b64_tr_b16 v[100:101], v167 offset:33792
 v_mfma_f32_16x16x32_bf16 a[116:119], v[28:31], v[68:71], a[116:119]
 ds_read_b64_tr_b16 v[102:103], v167 offset:35840
 v_mfma_f32_16x16x32_bf16 a[112:115], v[28:31], v[64:67], a[112:115]
 s_add_u32 m0, s45, 65536
 v_mfma_f32_16x16x32_bf16 a[108:111], v[28:31], v[60:63], a[108:111]
 ds_read_b128 v[132:135], v173 offset:37888
 v_mfma_f32_16x16x32_bf16 a[104:107], v[28:31], v[56:59], a[104:107]
 v_mfma_f32_16x16x32_bf16 a[100:103], v[28:31], v[52:55], a[100:103]
 ds_read_b64_tr_b16 v[104:105], v169 offset:33792
 v_mfma_f32_16x16x32_bf16 a[96:99], v[28:31], v[48:51], a[96:99]
 ds_read_b64_tr_b16 v[106:107], v169 offset:35840
 v_mfma_f32_16x16x32_bf16 a[128:131], v[32:35], v[48:51], a[128:131]
 buffer_load_dwordx4 v178, s[28:31], s41 offen offset:0 lds
 v_mfma_f32_16x16x32_bf16 a[132:135], v[32:35], v[52:55], a[132:135]
 ds_read_b128 v[136:139], v173 offset:38912
 v_mfma_f32_16x16x32_bf16 a[136:139], v[32:35], v[56:59], a[136:139]
 v_mfma_f32_16x16x32_bf16 a[140:143], v[32:35], v[60:63], a[140:143]
 ds_read_b64_tr_b16 v[108:109], v171 offset:33792
 v_mfma_f32_16x16x32_bf16 a[144:147], v[32:35], v[64:67], a[144:147]
 ds_read_b64_tr_b16 v[110:111], v171 offset:35840
 v_mfma_f32_16x16x32_bf16 a[148:151], v[32:35], v[68:71], a[148:151]
 buffer_load_dwordx4 v179, s[32:35], s41 offen offset:1024 lds
 v_mfma_f32_16x16x32_bf16 v[224:227], v[32:35], v[72:75], v[224:227]
 ds_read_b128 v[140:143], v173 offset:39936
 v_mfma_f32_16x16x32_bf16 v[228:231], v[32:35], v[76:79], v[228:231]
 v_mfma_f32_16x16x32_bf16 v[236:239], v[36:39], v[76:79], v[236:239]
 ds_read_b64_tr_b16 v[152:153], v182 offset:12288
 v_mfma_f32_16x16x32_bf16 v[232:235], v[36:39], v[72:75], v[232:235]
 ds_read_b64_tr_b16 v[154:155], v182 offset:12544
 v_mfma_f32_16x16x32_bf16 a[180:183], v[36:39], v[68:71], a[180:183]
 v_mfma_f32_16x16x32_bf16 a[176:179], v[36:39], v[64:67], a[176:179]
 ds_read_b128 v[156:159], v184 offset:32768
 buffer_load_dwordx4 v180, s[28:31], s41 offen offset:2048 lds
 v_mfma_f32_16x16x32_bf16 a[172:175], v[36:39], v[60:63], a[172:175]
 v_mfma_f32_16x16x32_bf16 a[168:171], v[36:39], v[56:59], a[168:171]
 v_mfma_f32_16x16x32_bf16 a[164:167], v[36:39], v[52:55], a[164:167]
 v_mfma_f32_16x16x32_bf16 a[160:163], v[36:39], v[48:51], a[160:163]
 v_mfma_f32_16x16x32_bf16 a[192:195], v[40:43], v[48:51], a[192:195]
 buffer_load_dwordx4 v181, s[32:35], s41 offen offset:3072 lds
 s_add_u32 s41, s41, s43
 v_mfma_f32_16x16x32_bf16 a[196:199], v[40:43], v[52:55], a[196:199]
 v_mfma_f32_16x16x32_bf16 a[200:203], v[40:43], v[56:59], a[200:203]
 v_mfma_f32_16x16x32_bf16 a[204:207], v[40:43], v[60:63], a[204:207]
 v_mfma_f32_16x16x32_bf16 a[208:211], v[40:43], v[64:67], a[208:211]
 v_mfma_f32_16x16x32_bf16 a[212:215], v[40:43], v[68:71], a[212:215]
 s_add_u32 m0, s46, 8192
 v_mfma_f32_16x16x32_bf16 v[240:243], v[40:43], v[72:75], v[240:243]
 v_mfma_f32_16x16x32_bf16 v[244:247], v[40:43], v[76:79], v[244:247]
 v_mfma_f32_16x16x32_bf16 v[252:255], v[44:47], v[76:79], v[252:255]
 v_mfma_f32_16x16x32_bf16 v[248:251], v[44:47], v[72:75], v[248:251]
 v_mfma_f32_16x16x32_bf16 a[244:247], v[44:47], v[68:71], a[244:247]
 buffer_load_dwordx4 v185, s[36:39], s42 offen lds
 s_add_u32 s42, s42, 2048
 v_mfma_f32_16x16x32_bf16 a[240:243], v[44:47], v[64:67], a[240:243]
 v_mfma_f32_16x16x32_bf16 a[236:239], v[44:47], v[60:63], a[236:239]
 v_mfma_f32_16x16x32_bf16 a[232:235], v[44:47], v[56:59], a[232:235]
 v_mfma_f32_16x16x32_bf16 a[228:231], v[44:47], v[52:55], a[228:231]
 v_mfma_f32_16x16x32_bf16 a[224:227], v[44:47], v[48:51], a[224:227]
 v_mfma_f32_16x16x32_bf16 v[160:163], v[144:147], v[148:151], v[160:163]
 s_waitcnt vmcnt(18) lgkmcnt(0)
 s_barrier
 v_mfma_f32_16x16x32_bf16 a[0:3], v[80:83], v[112:115], a[0:3]
 ds_read_b64_tr_b16 v[16:17], v164 offset:0
 v_mfma_f32_16x16x32_bf16 a[4:7], v[80:83], v[116:119], a[4:7]
 ds_read_b64_tr_b16 v[18:19], v164 offset:2048
 s_add_u32 m0, s44, 98304
 v_mfma_f32_16x16x32_bf16 a[8:11], v[80:83], v[120:123], a[8:11]
 v_mfma_f32_16x16x32_bf16 a[12:15], v[80:83], v[124:127], a[12:15]
 ds_read_b128 v[48:51], v172 offset:0
 v_mfma_f32_16x16x32_bf16 a[16:19], v[80:83], v[128:131], a[16:19]
 v_mfma_f32_16x16x32_bf16 a[20:23], v[80:83], v[132:135], a[20:23]
 ds_read_b64_tr_b16 v[20:21], v166 offset:0
 v_mfma_f32_16x16x32_bf16 v[192:195], v[80:83], v[136:139], v[192:195]
 ds_read_b64_tr_b16 v[22:23], v166 offset:2048
 buffer_load_dwordx4 v174, s[24:27], s40 offen offset:0 lds
 v_mfma_f32_16x16x32_bf16 v[196:199], v[80:83], v[140:143], v[196:199]
 v_mfma_f32_16x16x32_bf16 v[204:207], v[84:87], v[140:143], v[204:207]
 ds_read_b128 v[52:55], v172 offset:1024
 v_mfma_f32_16x16x32_bf16 v[200:203], v[84:87], v[136:139], v[200:203]
 v_mfma_f32_16x16x32_bf16 a[52:55], v[84:87], v[132:135], a[52:55]
 ds_read_b64_tr_b16 v[24:25], v168 offset:0
 v_mfma_f32_16x16x32_bf16 a[48:51], v[84:87], v[128:131], a[48:51]
 ds_read_b64_tr_b16 v[26:27], v168 offset:2048
 buffer_load_dwordx4 v175, s[24:27], s40 offen offset:1024 lds
 v_mfma_f32_16x16x32_bf16 a[44:47], v[84:87], v[124:127], a[44:47]
 v_mfma_f32_16x16x32_bf16 a[40:43], v[84:87], v[120:123], a[40:43]
 ds_read_b128 v[56:59], v172 offset:2048
 v_mfma_f32_16x16x32_bf16 a[36:39], v[84:87], v[116:119], a[36:39]
 v_mfma_f32_16x16x32_bf16 a[32:35], v[84:87], v[112:115], a[32:35]
 ds_read_b64_tr_b16 v[28:29], v170 offset:0
 v_mfma_f32_16x16x32_bf16 a[64:67], v[88:91], v[112:115], a[64:67]
 ds_read_b64_tr_b16 v[30:31], v170 offset:2048
 buffer_load_dwordx4 v176, s[24:27], s40 offen offset:2048 lds
 v_mfma_f32_16x16x32_bf16 a[68:71], v[88:91], v[116:119], a[68:71]
 v_mfma_f32_16x16x32_bf16 a[72:75], v[88:91], v[120:123], a[72:75]
 ds_read_b128 v[60:63], v172 offset:3072
 v_mfma_f32_16x16x32_bf16 a[76:79], v[88:91], v[124:127], a[76:79]
 v_mfma_f32_16x16x32_bf16 a[80:83], v[88:91], v[128:131], a[80:83]
 ds_read_b64_tr_b16 v[32:33], v164 offset:1024
 v_mfma_f32_16x16x32_bf16 a[84:87], v[88:91], v[132:135], a[84:87]
 ds_read_b64_tr_b16 v[34:35], v164 offset:3072
 v_mfma_f32_16x16x32_bf16 v[208:211], v[88:91], v[136:139], v[208:211]
 buffer_load_dwordx4 v177, s[24:27], s40 offen offset:3072 lds
 s_add_u32 s40, s40, 16384
 v_mfma_f32_16x16x32_bf16 v[212:215], v[88:91], v[140:143], v[212:215]
 ds_read_b128 v[64:67], v172 offset:4096
 v_mfma_f32_16x16x32_bf16 v[220:223], v[92:95], v[140:143], v[220:223]
 v_mfma_f32_16x16x32_bf16 v[216:219], v[92:95], v[136:139], v[216:219]
 ds_read_b64_tr_b16 v[36:37], v166 offset:1024
 v_mfma_f32_16x16x32_bf16 a[116:119], v[92:95], v[132:135], a[116:119]
 ds_read_b64_tr_b16 v[38:39], v166 offset:3072
 v_mfma_f32_16x16x32_bf16 a[112:115], v[92:95], v[128:131], a[112:115]
 s_add_u32 m0, s45, 98304
 v_mfma_f32_16x16x32_bf16 a[108:111], v[92:95], v[124:127], a[108:111]
 ds_read_b128 v[68:71], v172 offset:5120
 v_mfma_f32_16x16x32_bf16 a[104:107], v[92:95], v[120:123], a[104:107]
 v_mfma_f32_16x16x32_bf16 a[100:103], v[92:95], v[116:119], a[100:103]
 ds_read_b64_tr_b16 v[40:41], v168 offset:1024
 v_mfma_f32_16x16x32_bf16 a[96:99], v[92:95], v[112:115], a[96:99]
 ds_read_b64_tr_b16 v[42:43], v168 offset:3072
 v_mfma_f32_16x16x32_bf16 a[128:131], v[96:99], v[112:115], a[128:131]
 buffer_load_dwordx4 v178, s[28:31], s41 offen offset:0 lds
 v_mfma_f32_16x16x32_bf16 a[132:135], v[96:99], v[116:119], a[132:135]
 ds_read_b128 v[72:75], v172 offset:6144
 v_mfma_f32_16x16x32_bf16 a[136:139], v[96:99], v[120:123], a[136:139]
 v_mfma_f32_16x16x32_bf16 a[140:143], v[96:99], v[124:127], a[140:143]
 ds_read_b64_tr_b16 v[44:45], v170 offset:1024
 v_mfma_f32_16x16x32_bf16 a[144:147], v[96:99], v[128:131], a[144:147]
 ds_read_b64_tr_b16 v[46:47], v170 offset:3072
 v_mfma_f32_16x16x32_bf16 a[148:151], v[96:99], v[132:135], a[148:151]
 buffer_load_dwordx4 v179, s[32:35], s41 offen offset:1024 lds
 v_mfma_f32_16x16x32_bf16 v[224:227], v[96:99], v[136:139], v[224:227]
 ds_read_b128 v[76:79], v172 offset:7168
 v_mfma_f32_16x16x32_bf16 v[228:231], v[96:99], v[140:143], v[228:231]
 v_mfma_f32_16x16x32_bf16 v[236:239], v[100:103], v[140:143], v[236:239]
 ds_read_b64_tr_b16 v[144:145], v182 offset:0
 v_mfma_f32_16x16x32_bf16 v[232:235], v[100:103], v[136:139], v[232:235]
 ds_read_b64_tr_b16 v[146:147], v182 offset:256
 v_mfma_f32_16x16x32_bf16 a[180:183], v[100:103], v[132:135], a[180:183]
 v_mfma_f32_16x16x32_bf16 a[176:179], v[100:103], v[128:131], a[176:179]
 ds_read_b128 v[148:151], v183 offset:0
 buffer_load_dwordx4 v180, s[28:31], s41 offen offset:2048 lds
 v_mfma_f32_16x16x32_bf16 a[172:175], v[100:103], v[124:127], a[172:175]
 v_mfma_f32_16x16x32_bf16 a[168:171], v[100:103], v[120:123], a[168:171]
 v_mfma_f32_16x16x32_bf16 a[164:167], v[100:103], v[116:119], a[164:167]
 v_mfma_f32_16x16x32_bf16 a[160:163], v[100:103], v[112:115], a[160:163]
 v_mfma_f32_16x16x32_bf16 a[192:195], v[104:107], v[112:115], a[192:195]
 buffer_load_dwordx4 v181, s[32:35], s41 offen offset:3072 lds
 s_add_u32 s41, s41, s43
 v_mfma_f32_16x16x32_bf16 a[196:199], v[104:107], v[116:119], a[196:199]
 v_mfma_f32_16x16x32_bf16 a[200:203], v[104:107], v[120:123], a[200:203]
 v_mfma_f32_16x16x32_bf16 a[204:207], v[104:107], v[124:127], a[204:207]
 v_mfma_f32_16x16x32_bf16 a[208:211], v[104:107], v[128:131], a[208:211]
 v_mfma_f32_16x16x32_bf16 a[212:215], v[104:107], v[132:135], a[212:215]
 s_add_u32 m0, s46, 12288
 v_mfma_f32_16x16x32_bf16 v[240:243], v[104:107], v[136:139], v[240:243]
 v_mfma_f32_16x16x32_bf16 v[244:247], v[104:107], v[140:143], v[244:247]
 v_mfma_f32_16x16x32_bf16 v[252:255], v[108:111], v[140:143], v[252:255]
 v_mfma_f32_16x16x32_bf16 v[248:251], v[108:111], v[136:139], v[248:251]
 v_mfma_f32_16x16x32_bf16 a[244:247], v[108:111], v[132:135], a[244:247]
 buffer_load_dwordx4 v185, s[36:39], s42 offen lds
 s_add_u32 s42, s42, 2048
 v_mfma_f32_16x16x32_bf16 a[240:243], v[108:111], v[128:131], a[240:243]
 v_mfma_f32_16x16x32_bf16 a[236:239], v[108:111], v[124:127], a[236:239]
 v_mfma_f32_16x16x32_bf16 a[232:235], v[108:111], v[120:123], a[232:235]
 v_mfma_f32_16x16x32_bf16 a[228:231], v[108:111], v[116:119], a[228:231]
 v_mfma_f32_16x16x32_bf16 a[224:227], v[108:111], v[112:115], a[224:227]
 v_mfma_f32_16x16x32_bf16 v[160:163], v[152:155], v[156:159], v[160:163]
 s_waitcnt vmcnt(18) lgkmcnt(0)
 s_barrier
 v_mfma_f32_16x16x32_bf16 a[0:3], v[16:19], v[48:51], a[0:3]
 ds_read_b64_tr_b16 v[80:81], v164 offset:32768
 v_mfma_f32_16x16x32_bf16 a[4:7], v[16:19], v[52:55], a[4:7]
 ds_read_b64_tr_b16 v[82:83], v164 offset:34816
 s_add_u32 m0, s44, 0
 v_mfma_f32_16x16x32_bf16 a[8:11], v[16:19], v[56:59], a[8:11]
 v_mfma_f32_16x16x32_bf16 a[12:15], v[16:19], v[60:63], a[12:15]
 ds_read_b128 v[112:115], v172 offset:32768
 v_mfma_f32_16x16x32_bf16 a[16:19], v[16:19], v[64:67], a[16:19]
 v_mfma_f32_16x16x32_bf16 a[20:23], v[16:19], v[68:71], a[20:23]
 ds_read_b64_tr_b16 v[84:85], v166 offset:32768
 v_mfma_f32_16x16x32_bf16 v[192:195], v[16:19], v[72:75], v[192:195]
 ds_read_b64_tr_b16 v[86:87], v166 offset:34816
 buffer_load_dwordx4 v174, s[24:27], s40 offen offset:0 lds
 v_mfma_f32_16x16x32_bf16 v[196:199], v[16:19], v[76:79], v[196:199]
 v_mfma_f32_16x16x32_bf16 v[204:207], v[20:23], v[76:79], v[204:207]
 ds_read_b128 v[116:119], v172 offset:33792
 v_mfma_f32_16x16x32_bf16 v[200:203], v[20:23], v[72:75], v[200:203]
 v_mfma_f32_16x16x32_bf16 a[52:55], v[20:23], v[68:71], a[52:55]
 ds_read_b64_tr_b16 v[88:89], v168 offset:32768
 v_mfma_f32_16x16x32_bf16 a[48:51], v[20:23], v[64:67], a[48:51]
 ds_read_b64_tr_b16 v[90:91], v168 offset:34816
 buffer_load_dwordx4 v175, s[24:27], s40 offen offset:1024 lds
 v_mfma_f32_16x16x32_bf16 a[44:47], v[20:23], v[60:63], a[44:47]
 v_mfma_f32_16x16x32_bf16 a[40:43], v[20:23], v[56:59], a[40:43]
 ds_read_b128 v[120:123], v172 offset:34816
 v_mfma_f32_16x16x32_bf16 a[36:39], v[20:23], v[52:55], a[36:39]
 v_mfma_f32_16x16x32_bf16 a[32:35], v[20:23], v[48:51], a[32:35]
 ds_read_b64_tr_b16 v[92:93], v170 offset:32768
 v_mfma_f32_16x16x32_bf16 a[64:67], v[24:27], v[48:51], a[64:67]
 ds_read_b64_tr_b16 v[94:95], v170 offset:34816
 buffer_load_dwordx4 v176, s[24:27], s40 offen offset:2048 lds
 v_mfma_f32_16x16x32_bf16 a[68:71], v[24:27], v[52:55], a[68:71]
 v_mfma_f32_16x16x32_bf16 a[72:75], v[24:27], v[56:59], a[72:75]
 ds_read_b128 v[124:127], v172 offset:35840
 v_mfma_f32_16x16x32_bf16 a[76:79], v[24:27], v[60:63], a[76:79]
 v_mfma_f32_16x16x32_bf16 a[80:83], v[24:27], v[64:67], a[80:83]
 ds_read_b64_tr_b16 v[96:97], v164 offset:33792
 v_mfma_f32_16x16x32_bf16 a[84:87], v[24:27], v[68:71], a[84:87]
 ds_read_b64_tr_b16 v[98:99], v164 offset:35840
 v_mfma_f32_16x16x32_bf16 v[208:211], v[24:27], v[72:75], v[208:211]
 buffer_load_dwordx4 v177, s[24:27], s40 offen offset:3072 lds
 s_add_u32 s40, s40, 16384
 v_mfma_f32_16x16x32_bf16 v[212:215], v[24:27], v[76:79], v[212:215]
 ds_read_b128 v[128:131], v172 offset:36864
 v_mfma_f32_16x16x32_bf16 v[220:223], v[28:31], v[76:79], v[220:223]
 v_mfma_f32_16x16x32_bf16 v[216:219], v[28:31], v[72:75], v[216:219]
 ds_read_b64_tr_b16 v[100:101], v166 offset:33792
 v_mfma_f32_16x16x32_bf16 a[116:119], v[28:31], v[68:71], a[116:119]
 ds_read_b64_tr_b16 v[102:103], v166 offset:35840
 v_mfma_f32_16x16x32_bf16 a[112:115], v[28:31], v[64:67], a[112:115]
 s_add_u32 m0, s45, 0
 v_mfma_f32_16x16x32_bf16 a[108:111], v[28:31], v[60:63], a[108:111]
 ds_read_b128 v[132:135], v172 offset:37888
 v_mfma_f32_16x16x32_bf16 a[104:107], v[28:31], v[56:59], a[104:107]
 v_mfma_f32_16x16x32_bf16 a[100:103], v[28:31], v[52:55], a[100:103]
 ds_read_b64_tr_b16 v[104:105], v168 offset:33792
 v_mfma_f32_16x16x32_bf16 a[96:99], v[28:31], v[48:51], a[96:99]
 ds_read_b64_tr_b16 v[106:107], v168 offset:35840
 v_mfma_f32_16x16x32_bf16 a[128:131], v[32:35], v[48:51], a[128:131]
 buffer_load_dwordx4 v178, s[28:31], s41 offen offset:0 lds
 v_mfma_f32_16x16x32_bf16 a[132:135], v[32:35], v[52:55], a[132:135]
 ds_read_b128 v[136:139], v172 offset:38912
 v_mfma_f32_16x16x32_bf16 a[136:139], v[32:35], v[56:59], a[136:139]
 v_mfma_f32_16x16x32_bf16 a[140:143], v[32:35], v[60:63], a[140:143]
 ds_read_b64_tr_b16 v[108:109], v170 offset:33792
 v_mfma_f32_16x16x32_bf16 a[144:147], v[32:35], v[64:67], a[144:147]
 ds_read_b64_tr_b16 v[110:111], v170 offset:35840
 v_mfma_f32_16x16x32_bf16 a[148:151], v[32:35], v[68:71], a[148:151]
 buffer_load_dwordx4 v179, s[32:35], s41 offen offset:1024 lds
 v_mfma_f32_16x16x32_bf16 v[224:227], v[32:35], v[72:75], v[224:227]
 ds_read_b128 v[140:143], v172 offset:39936
 v_mfma_f32_16x16x32_bf16 v[228:231], v[32:35], v[76:79], v[228:231]
 v_mfma_f32_16x16x32_bf16 v[236:239], v[36:39], v[76:79], v[236:239]
 ds_read_b64_tr_b16 v[152:153], v182 offset:4096
 v_mfma_f32_16x16x32_bf16 v[232:235], v[36:39], v[72:75], v[232:235]
 ds_read_b64_tr_b16 v[154:155], v182 offset:4352
 v_mfma_f32_16x16x32_bf16 a[180:183], v[36:39], v[68:71], a[180:183]
 v_mfma_f32_16x16x32_bf16 a[176:179], v[36:39], v[64:67], a[176:179]
 ds_read_b128 v[156:159], v183 offset:32768
 buffer_load_dwordx4 v180, s[28:31], s41 offen offset:2048 lds
 v_mfma_f32_16x16x32_bf16 a[172:175], v[36:39], v[60:63], a[172:175]
 v_mfma_f32_16x16x32_bf16 a[168:171], v[36:39], v[56:59], a[168:171]
 v_mfma_f32_16x16x32_bf16 a[164:167], v[36:39], v[52:55], a[164:167]
 v_mfma_f32_16x16x32_bf16 a[160:163], v[36:39], v[48:51], a[160:163]
 v_mfma_f32_16x16x32_bf16 a[192:195], v[40:43], v[48:51], a[192:195]
 buffer_load_dwordx4 v181, s[32:35], s41 offen offset:3072 lds
 s_add_u32 s41, s41, s43
 v_mfma_f32_16x16x32_bf16 a[196:199], v[40:43], v[52:55], a[196:199]
 v_mfma_f32_16x16x32_bf16 a[200:203], v[40:43], v[56:59], a[200:203]
 v_mfma_f32_16x16x32_bf16 a[204:207], v[40:43], v[60:63], a[204:207]
 v_mfma_f32_16x16x32_bf16 a[208:211], v[40:43], v[64:67], a[208:211]
 v_mfma_f32_16x16x32_bf16 a[212:215], v[40:43], v[68:71], a[212:215]
 s_add_u32 m0, s46, 0
 v_mfma_f32_16x16x32_bf16 v[240:243], v[40:43], v[72:75], v[240:243]
 v_mfma_f32_16x16x32_bf16 v[244:247], v[40:43], v[76:79], v[244:247]
 v_mfma_f32_16x16x32_bf16 v[252:255], v[44:47], v[76:79], v[252:255]
 v_mfma_f32_16x16x32_bf16 v[248:251], v[44:47], v[72:75], v[248:251]
 v_mfma_f32_16x16x32_bf16 a[244:247], v[44:47], v[68:71], a[244:247]
 buffer_load_dwordx4 v185, s[36:39], s42 offen lds
 s_add_u32 s42, s42, 2048
 v_mfma_f32_16x16x32_bf16 a[240:243], v[44:47], v[64:67], a[240:243]
 v_mfma_f32_16x16x32_bf16 a[236:239], v[44:47], v[60:63], a[236:239]
 v_mfma_f32_16x16x32_bf16 a[232:235], v[44:47], v[56:59], a[232:235]
 v_mfma_f32_16x16x32_bf16 a[228:231], v[44:47], v[52:55], a[228:231]
 v_mfma_f32_16x16x32_bf16 a[224:227], v[44:47], v[48:51], a[224:227]
 v_mfma_f32_16x16x32_bf16 v[160:163], v[144:147], v[148:151], v[160:163]
 s_add_u32 s47, s47, 1
 s_cmp_lt_u32 s47, 6
 s_cbranch_scc1 L_gemm1_kernel_lkv
 s_waitcnt vmcnt(18) lgkmcnt(0)
 s_barrier
 v_mfma_f32_16x16x32_bf16 a[0:3], v[80:83], v[112:115], a[0:3]
 ds_read_b64_tr_b16 v[16:17], v165 offset:0
 v_mfma_f32_16x16x32_bf16 a[4:7], v[80:83], v[116:119], a[4:7]
 ds_read_b64_tr_b16 v[18:19], v165 offset:2048
 s_add_u32 m0, s44, 32768
 v_mfma_f32_16x16x32_bf16 a[8:11], v[80:83], v[120:123], a[8:11]
 v_mfma_f32_16x16x32_bf16 a[12:15], v[80:83], v[124:127], a[12:15]
 ds_read_b128 v[48:51], v173 offset:0
 v_mfma_f32_16x16x32_bf16 a[16:19], v[80:83], v[128:131], a[16:19]
 v_mfma_f32_16x16x32_bf16 a[20:23], v[80:83], v[132:135], a[20:23]
 ds_read_b64_tr_b16 v[20:21], v167 offset:0
 v_mfma_f32_16x16x32_bf16 v[192:195], v[80:83], v[136:139], v[192:195]
 ds_read_b64_tr_b16 v[22:23], v167 offset:2048
 buffer_load_dwordx4 v174, s[24:27], s40 offen offset:0 lds
 v_mfma_f32_16x16x32_bf16 v[196:199], v[80:83], v[140:143], v[196:199]
 v_mfma_f32_16x16x32_bf16 v[204:207], v[84:87], v[140:143], v[204:207]
 ds_read_b128 v[52:55], v173 offset:1024
 v_mfma_f32_16x16x32_bf16 v[200:203], v[84:87], v[136:139], v[200:203]
 v_mfma_f32_16x16x32_bf16 a[52:55], v[84:87], v[132:135], a[52:55]
 ds_read_b64_tr_b16 v[24:25], v169 offset:0
 v_mfma_f32_16x16x32_bf16 a[48:51], v[84:87], v[128:131], a[48:51]
 ds_read_b64_tr_b16 v[26:27], v169 offset:2048
 buffer_load_dwordx4 v175, s[24:27], s40 offen offset:1024 lds
 v_mfma_f32_16x16x32_bf16 a[44:47], v[84:87], v[124:127], a[44:47]
 v_mfma_f32_16x16x32_bf16 a[40:43], v[84:87], v[120:123], a[40:43]
 ds_read_b128 v[56:59], v173 offset:2048
 v_mfma_f32_16x16x32_bf16 a[36:39], v[84:87], v[116:119], a[36:39]
 v_mfma_f32_16x16x32_bf16 a[32:35], v[84:87], v[112:115], a[32:35]
 ds_read_b64_tr_b16 v[28:29], v171 offset:0
 v_mfma_f32_16x16x32_bf16 a[64:67], v[88:91], v[112:115], a[64:67]
 ds_read_b64_tr_b16 v[30:31], v171 offset:2048
 buffer_load_dwordx4 v176, s[24:27], s40 offen offset:2048 lds
 v_mfma_f32_16x16x32_bf16 a[68:71], v[88:91], v[116:119], a[68:71]
 v_mfma_f32_16x16x32_bf16 a[72:75], v[88:91], v[120:123], a[72:75]
 ds_read_b128 v[60:63], v173 offset:3072
 v_mfma_f32_16x16x32_bf16 a[76:79], v[88:91], v[124:127], a[76:79]
 v_mfma_f32_16x16x32_bf16 a[80:83], v[88:91], v[128:131], a[80:83]
 ds_read_b64_tr_b16 v[32:33], v165 offset:1024
 v_mfma_f32_16x16x32_bf16 a[84:87], v[88:91], v[132:135], a[84:87]
 ds_read_b64_tr_b16 v[34:35], v165 offset:3072
 v_mfma_f32_16x16x32_bf16 v[208:211], v[88:91], v[136:139], v[208:211]
 buffer_load_dwordx4 v177, s[24:27], s40 offen offset:3072 lds
 s_add_u32 s40, s40, 16384
 v_mfma_f32_16x16x32_bf16 v[212:215], v[88:91], v[140:143], v[212:215]
 ds_read_b128 v[64:67], v173 offset:4096
 v_mfma_f32_16x16x32_bf16 v[220:223], v[92:95], v[140:143], v[220:223]
 v_mfma_f32_16x16x32_bf16 v[216:219], v[92:95], v[136:139], v[216:219]
 ds_read_b64_tr_b16 v[36:37], v167 offset:1024
 v_mfma_f32_16x16x32_bf16 a[116:119], v[92:95], v[132:135], a[116:119]
 ds_read_b64_tr_b16 v[38:39], v167 offset:3072
 v_mfma_f32_16x16x32_bf16 a[112:115], v[92:95], v[128:131], a[112:115]
 s_add_u32 m0, s45, 32768
 v_mfma_f32_16x16x32_bf16 a[108:111], v[92:95], v[124:127], a[108:111]
 ds_read_b128 v[68:71], v173 offset:5120
 v_mfma_f32_16x16x32_bf16 a[104:107], v[92:95], v[120:123], a[104:107]
 v_mfma_f32_16x16x32_bf16 a[100:103], v[92:95], v[116:119], a[100:103]
 ds_read_b64_tr_b16 v[40:41], v169 offset:1024
 v_mfma_f32_16x16x32_bf16 a[96:99], v[92:95], v[112:115], a[96:99]
 ds_read_b64_tr_b16 v[42:43], v169 offset:3072
 v_mfma_f32_16x16x32_bf16 a[128:131], v[96:99], v[112:115], a[128:131]
 buffer_load_dwordx4 v178, s[28:31], s41 offen offset:0 lds
 v_mfma_f32_16x16x32_bf16 a[132:135], v[96:99], v[116:119], a[132:135]
 ds_read_b128 v[72:75], v173 offset:6144
 v_mfma_f32_16x16x32_bf16 a[136:139], v[96:99], v[120:123], a[136:139]
 v_mfma_f32_16x16x32_bf16 a[140:143], v[96:99], v[124:127], a[140:143]
 ds_read_b64_tr_b16 v[44:45], v171 offset:1024
 v_mfma_f32_16x16x32_bf16 a[144:147], v[96:99], v[128:131], a[144:147]
 ds_read_b64_tr_b16 v[46:47], v171 offset:3072
 v_mfma_f32_16x16x32_bf16 a[148:151], v[96:99], v[132:135], a[148:151]
 buffer_load_dwordx4 v179, s[32:35], s41 offen offset:1024 lds
 v_mfma_f32_16x16x32_bf16 v[224:227], v[96:99], v[136:139], v[224:227]
 ds_read_b128 v[76:79], v173 offset:7168
 v_mfma_f32_16x16x32_bf16 v[228:231], v[96:99], v[140:143], v[228:231]
 v_mfma_f32_16x16x32_bf16 v[236:239], v[100:103], v[140:143], v[236:239]
 ds_read_b64_tr_b16 v[144:145], v182 offset:8192
 v_mfma_f32_16x16x32_bf16 v[232:235], v[100:103], v[136:139], v[232:235]
 ds_read_b64_tr_b16 v[146:147], v182 offset:8448
 v_mfma_f32_16x16x32_bf16 a[180:183], v[100:103], v[132:135], a[180:183]
 v_mfma_f32_16x16x32_bf16 a[176:179], v[100:103], v[128:131], a[176:179]
 ds_read_b128 v[148:151], v184 offset:0
 buffer_load_dwordx4 v180, s[28:31], s41 offen offset:2048 lds
 v_mfma_f32_16x16x32_bf16 a[172:175], v[100:103], v[124:127], a[172:175]
 v_mfma_f32_16x16x32_bf16 a[168:171], v[100:103], v[120:123], a[168:171]
 v_mfma_f32_16x16x32_bf16 a[164:167], v[100:103], v[116:119], a[164:167]
 v_mfma_f32_16x16x32_bf16 a[160:163], v[100:103], v[112:115], a[160:163]
 v_mfma_f32_16x16x32_bf16 a[192:195], v[104:107], v[112:115], a[192:195]
 buffer_load_dwordx4 v181, s[32:35], s41 offen offset:3072 lds
 s_add_u32 s41, s41, s43
 v_mfma_f32_16x16x32_bf16 a[196:199], v[104:107], v[116:119], a[196:199]
 v_mfma_f32_16x16x32_bf16 a[200:203], v[104:107], v[120:123], a[200:203]
 v_mfma_f32_16x16x32_bf16 a[204:207], v[104:107], v[124:127], a[204:207]
 v_mfma_f32_16x16x32_bf16 a[208:211], v[104:107], v[128:131], a[208:211]
 v_mfma_f32_16x16x32_bf16 a[212:215], v[104:107], v[132:135], a[212:215]
 s_add_u32 m0, s46, 4096
 v_mfma_f32_16x16x32_bf16 v[240:243], v[104:107], v[136:139], v[240:243]
 v_mfma_f32_16x16x32_bf16 v[244:247], v[104:107], v[140:143], v[244:247]
 v_mfma_f32_16x16x32_bf16 v[252:255], v[108:111], v[140:143], v[252:255]
 v_mfma_f32_16x16x32_bf16 v[248:251], v[108:111], v[136:139], v[248:251]
 v_mfma_f32_16x16x32_bf16 a[244:247], v[108:111], v[132:135], a[244:247]
 buffer_load_dwordx4 v185, s[36:39], s42 offen lds
 s_add_u32 s42, s42, 2048
 v_mfma_f32_16x16x32_bf16 a[240:243], v[108:111], v[128:131], a[240:243]
 v_mfma_f32_16x16x32_bf16 a[236:239], v[108:111], v[124:127], a[236:239]
 v_mfma_f32_16x16x32_bf16 a[232:235], v[108:111], v[120:123], a[232:235]
 v_mfma_f32_16x16x32_bf16 a[228:231], v[108:111], v[116:119], a[228:231]
 v_mfma_f32_16x16x32_bf16 a[224:227], v[108:111], v[112:115], a[224:227]
 v_mfma_f32_16x16x32_bf16 v[160:163], v[152:155], v[156:159], v[160:163]
 s_waitcnt vmcnt(18) lgkmcnt(0)
 s_barrier
 v_mfma_f32_16x16x32_bf16 a[0:3], v[16:19], v[48:51], a[0:3]
 ds_read_b64_tr_b16 v[80:81], v165 offset:32768
 v_mfma_f32_16x16x32_bf16 a[4:7], v[16:19], v[52:55], a[4:7]
 ds_read_b64_tr_b16 v[82:83], v165 offset:34816
 s_add_u32 m0, s44, 65536
 v_mfma_f32_16x16x32_bf16 a[8:11], v[16:19], v[56:59], a[8:11]
 v_mfma_f32_16x16x32_bf16 a[12:15], v[16:19], v[60:63], a[12:15]
 ds_read_b128 v[112:115], v173 offset:32768
 v_mfma_f32_16x16x32_bf16 a[16:19], v[16:19], v[64:67], a[16:19]
 v_mfma_f32_16x16x32_bf16 a[20:23], v[16:19], v[68:71], a[20:23]
 ds_read_b64_tr_b16 v[84:85], v167 offset:32768
 v_mfma_f32_16x16x32_bf16 v[192:195], v[16:19], v[72:75], v[192:195]
 ds_read_b64_tr_b16 v[86:87], v167 offset:34816
 buffer_load_dwordx4 v174, s[24:27], s40 offen offset:0 lds
 v_mfma_f32_16x16x32_bf16 v[196:199], v[16:19], v[76:79], v[196:199]
 v_mfma_f32_16x16x32_bf16 v[204:207], v[20:23], v[76:79], v[204:207]
 ds_read_b128 v[116:119], v173 offset:33792
 v_mfma_f32_16x16x32_bf16 v[200:203], v[20:23], v[72:75], v[200:203]
 v_mfma_f32_16x16x32_bf16 a[52:55], v[20:23], v[68:71], a[52:55]
 ds_read_b64_tr_b16 v[88:89], v169 offset:32768
 v_mfma_f32_16x16x32_bf16 a[48:51], v[20:23], v[64:67], a[48:51]
 ds_read_b64_tr_b16 v[90:91], v169 offset:34816
 buffer_load_dwordx4 v175, s[24:27], s40 offen offset:1024 lds
 v_mfma_f32_16x16x32_bf16 a[44:47], v[20:23], v[60:63], a[44:47]
 v_mfma_f32_16x16x32_bf16 a[40:43], v[20:23], v[56:59], a[40:43]
 ds_read_b128 v[120:123], v173 offset:34816
 v_mfma_f32_16x16x32_bf16 a[36:39], v[20:23], v[52:55], a[36:39]
 v_mfma_f32_16x16x32_bf16 a[32:35], v[20:23], v[48:51], a[32:35]
 ds_read_b64_tr_b16 v[92:93], v171 offset:32768
 v_mfma_f32_16x16x32_bf16 a[64:67], v[24:27], v[48:51], a[64:67]
 ds_read_b64_tr_b16 v[94:95], v171 offset:34816
 buffer_load_dwordx4 v176, s[24:27], s40 offen offset:2048 lds
 v_mfma_f32_16x16x32_bf16 a[68:71], v[24:27], v[52:55], a[68:71]
 v_mfma_f32_16x16x32_bf16 a[72:75], v[24:27], v[56:59], a[72:75]
 ds_read_b128 v[124:127], v173 offset:35840
 v_mfma_f32_16x16x32_bf16 a[76:79], v[24:27], v[60:63], a[76:79]
 v_mfma_f32_16x16x32_bf16 a[80:83], v[24:27], v[64:67], a[80:83]
 ds_read_b64_tr_b16 v[96:97], v165 offset:33792
 v_mfma_f32_16x16x32_bf16 a[84:87], v[24:27], v[68:71], a[84:87]
 ds_read_b64_tr_b16 v[98:99], v165 offset:35840
 v_mfma_f32_16x16x32_bf16 v[208:211], v[24:27], v[72:75], v[208:211]
 buffer_load_dwordx4 v177, s[24:27], s40 offen offset:3072 lds
 s_add_u32 s40, s40, 16384
 v_mfma_f32_16x16x32_bf16 v[212:215], v[24:27], v[76:79], v[212:215]
 ds_read_b128 v[128:131], v173 offset:36864
 v_mfma_f32_16x16x32_bf16 v[220:223], v[28:31], v[76:79], v[220:223]
 v_mfma_f32_16x16x32_bf16 v[216:219], v[28:31], v[72:75], v[216:219]
 ds_read_b64_tr_b16 v[100:101], v167 offset:33792
 v_mfma_f32_16x16x32_bf16 a[116:119], v[28:31], v[68:71], a[116:119]
 ds_read_b64_tr_b16 v[102:103], v167 offset:35840
 v_mfma_f32_16x16x32_bf16 a[112:115], v[28:31], v[64:67], a[112:115]
 s_add_u32 m0, s45, 65536
 v_mfma_f32_16x16x32_bf16 a[108:111], v[28:31], v[60:63], a[108:111]
 ds_read_b128 v[132:135], v173 offset:37888
 v_mfma_f32_16x16x32_bf16 a[104:107], v[28:31], v[56:59], a[104:107]
 v_mfma_f32_16x16x32_bf16 a[100:103], v[28:31], v[52:55], a[100:103]
 ds_read_b64_tr_b16 v[104:105], v169 offset:33792
 v_mfma_f32_16x16x32_bf16 a[96:99], v[28:31], v[48:51], a[96:99]
 ds_read_b64_tr_b16 v[106:107], v169 offset:35840
 v_mfma_f32_16x16x32_bf16 a[128:131], v[32:35], v[48:51], a[128:131]
 buffer_load_dwordx4 v178, s[28:31], s41 offen offset:0 lds
 v_mfma_f32_16x16x32_bf16 a[132:135], v[32:35], v[52:55], a[132:135]
 ds_read_b128 v[136:139], v173 offset:38912
 v_mfma_f32_16x16x32_bf16 a[136:139], v[32:35], v[56:59], a[136:139]
 v_mfma_f32_16x16x32_bf16 a[140:143], v[32:35], v[60:63], a[140:143]
 ds_read_b64_tr_b16 v[108:109], v171 offset:33792
 v_mfma_f32_16x16x32_bf16 a[144:147], v[32:35], v[64:67], a[144:147]
 ds_read_b64_tr_b16 v[110:111], v171 offset:35840
 v_mfma_f32_16x16x32_bf16 a[148:151], v[32:35], v[68:71], a[148:151]
 buffer_load_dwordx4 v179, s[32:35], s41 offen offset:1024 lds
 v_mfma_f32_16x16x32_bf16 v[224:227], v[32:35], v[72:75], v[224:227]
 ds_read_b128 v[140:143], v173 offset:39936
 v_mfma_f32_16x16x32_bf16 v[228:231], v[32:35], v[76:79], v[228:231]
 v_mfma_f32_16x16x32_bf16 v[236:239], v[36:39], v[76:79], v[236:239]
 ds_read_b64_tr_b16 v[152:153], v182 offset:12288
 v_mfma_f32_16x16x32_bf16 v[232:235], v[36:39], v[72:75], v[232:235]
 ds_read_b64_tr_b16 v[154:155], v182 offset:12544
 v_mfma_f32_16x16x32_bf16 a[180:183], v[36:39], v[68:71], a[180:183]
 v_mfma_f32_16x16x32_bf16 a[176:179], v[36:39], v[64:67], a[176:179]
 ds_read_b128 v[156:159], v184 offset:32768
 buffer_load_dwordx4 v180, s[28:31], s41 offen offset:2048 lds
 v_mfma_f32_16x16x32_bf16 a[172:175], v[36:39], v[60:63], a[172:175]
 v_mfma_f32_16x16x32_bf16 a[168:171], v[36:39], v[56:59], a[168:171]
 v_mfma_f32_16x16x32_bf16 a[164:167], v[36:39], v[52:55], a[164:167]
 v_mfma_f32_16x16x32_bf16 a[160:163], v[36:39], v[48:51], a[160:163]
 v_mfma_f32_16x16x32_bf16 a[192:195], v[40:43], v[48:51], a[192:195]
 buffer_load_dwordx4 v181, s[32:35], s41 offen offset:3072 lds
 s_add_u32 s41, s41, s43
 v_mfma_f32_16x16x32_bf16 a[196:199], v[40:43], v[52:55], a[196:199]
 v_mfma_f32_16x16x32_bf16 a[200:203], v[40:43], v[56:59], a[200:203]
 v_mfma_f32_16x16x32_bf16 a[204:207], v[40:43], v[60:63], a[204:207]
 v_mfma_f32_16x16x32_bf16 a[208:211], v[40:43], v[64:67], a[208:211]
 v_mfma_f32_16x16x32_bf16 a[212:215], v[40:43], v[68:71], a[212:215]
 s_add_u32 m0, s46, 8192
 v_mfma_f32_16x16x32_bf16 v[240:243], v[40:43], v[72:75], v[240:243]
 v_mfma_f32_16x16x32_bf16 v[244:247], v[40:43], v[76:79], v[244:247]
 v_mfma_f32_16x16x32_bf16 v[252:255], v[44:47], v[76:79], v[252:255]
 v_mfma_f32_16x16x32_bf16 v[248:251], v[44:47], v[72:75], v[248:251]
 v_mfma_f32_16x16x32_bf16 a[244:247], v[44:47], v[68:71], a[244:247]
 buffer_load_dwordx4 v185, s[36:39], s42 offen lds
 s_add_u32 s42, s42, 2048
 v_mfma_f32_16x16x32_bf16 a[240:243], v[44:47], v[64:67], a[240:243]
 v_mfma_f32_16x16x32_bf16 a[236:239], v[44:47], v[60:63], a[236:239]
 v_mfma_f32_16x16x32_bf16 a[232:235], v[44:47], v[56:59], a[232:235]
 v_mfma_f32_16x16x32_bf16 a[228:231], v[44:47], v[52:55], a[228:231]
 v_mfma_f32_16x16x32_bf16 a[224:227], v[44:47], v[48:51], a[224:227]
 v_mfma_f32_16x16x32_bf16 v[160:163], v[144:147], v[148:151], v[160:163]
 s_waitcnt vmcnt(18) lgkmcnt(0)
 s_barrier
 v_mfma_f32_16x16x32_bf16 a[0:3], v[80:83], v[112:115], a[0:3]
 ds_read_b64_tr_b16 v[16:17], v164 offset:0
 v_mfma_f32_16x16x32_bf16 a[4:7], v[80:83], v[116:119], a[4:7]
 ds_read_b64_tr_b16 v[18:19], v164 offset:2048
 s_add_u32 m0, s44, 98304
 v_mfma_f32_16x16x32_bf16 a[8:11], v[80:83], v[120:123], a[8:11]
 v_mfma_f32_16x16x32_bf16 a[12:15], v[80:83], v[124:127], a[12:15]
 ds_read_b128 v[48:51], v172 offset:0
 v_mfma_f32_16x16x32_bf16 a[16:19], v[80:83], v[128:131], a[16:19]
 v_mfma_f32_16x16x32_bf16 a[20:23], v[80:83], v[132:135], a[20:23]
 ds_read_b64_tr_b16 v[20:21], v166 offset:0
 v_mfma_f32_16x16x32_bf16 v[192:195], v[80:83], v[136:139], v[192:195]
 ds_read_b64_tr_b16 v[22:23], v166 offset:2048
 buffer_load_dwordx4 v174, s[24:27], s40 offen offset:0 lds
 v_mfma_f32_16x16x32_bf16 v[196:199], v[80:83], v[140:143], v[196:199]
 v_mfma_f32_16x16x32_bf16 v[204:207], v[84:87], v[140:143], v[204:207]
 ds_read_b128 v[52:55], v172 offset:1024
 v_mfma_f32_16x16x32_bf16 v[200:203], v[84:87], v[136:139], v[200:203]
 v_mfma_f32_16x16x32_bf16 a[52:55], v[84:87], v[132:135], a[52:55]
 ds_read_b64_tr_b16 v[24:25], v168 offset:0
 v_mfma_f32_16x16x32_bf16 a[48:51], v[84:87], v[128:131], a[48:51]
 ds_read_b64_tr_b16 v[26:27], v168 offset:2048
 buffer_load_dwordx4 v175, s[24:27], s40 offen offset:1024 lds
 v_mfma_f32_16x16x32_bf16 a[44:47], v[84:87], v[124:127], a[44:47]
 v_mfma_f32_16x16x32_bf16 a[40:43], v[84:87], v[120:123], a[40:43]
 ds_read_b128 v[56:59], v172 offset:2048
 v_mfma_f32_16x16x32_bf16 a[36:39], v[84:87], v[116:119], a[36:39]
 v_mfma_f32_16x16x32_bf16 a[32:35], v[84:87], v[112:115], a[32:35]
 ds_read_b64_tr_b16 v[28:29], v170 offset:0
 v_mfma_f32_16x16x32_bf16 a[64:67], v[88:91], v[112:115], a[64:67]
 ds_read_b64_tr_b16 v[30:31], v170 offset:2048
 buffer_load_dwordx4 v176, s[24:27], s40 offen offset:2048 lds
 v_mfma_f32_16x16x32_bf16 a[68:71], v[88:91], v[116:119], a[68:71]
 v_mfma_f32_16x16x32_bf16 a[72:75], v[88:91], v[120:123], a[72:75]
 ds_read_b128 v[60:63], v172 offset:3072
 v_mfma_f32_16x16x32_bf16 a[76:79], v[88:91], v[124:127], a[76:79]
 v_mfma_f32_16x16x32_bf16 a[80:83], v[88:91], v[128:131], a[80:83]
 ds_read_b64_tr_b16 v[32:33], v164 offset:1024
 v_mfma_f32_16x16x32_bf16 a[84:87], v[88:91], v[132:135], a[84:87]
 ds_read_b64_tr_b16 v[34:35], v164 offset:3072
 v_mfma_f32_16x16x32_bf16 v[208:211], v[88:91], v[136:139], v[208:211]
 buffer_load_dwordx4 v177, s[24:27], s40 offen offset:3072 lds
 s_add_u32 s40, s40, 16384
 v_mfma_f32_16x16x32_bf16 v[212:215], v[88:91], v[140:143], v[212:215]
 ds_read_b128 v[64:67], v172 offset:4096
 v_mfma_f32_16x16x32_bf16 v[220:223], v[92:95], v[140:143], v[220:223]
 v_mfma_f32_16x16x32_bf16 v[216:219], v[92:95], v[136:139], v[216:219]
 ds_read_b64_tr_b16 v[36:37], v166 offset:1024
 v_mfma_f32_16x16x32_bf16 a[116:119], v[92:95], v[132:135], a[116:119]
 ds_read_b64_tr_b16 v[38:39], v166 offset:3072
 v_mfma_f32_16x16x32_bf16 a[112:115], v[92:95], v[128:131], a[112:115]
 s_add_u32 m0, s45, 98304
 v_mfma_f32_16x16x32_bf16 a[108:111], v[92:95], v[124:127], a[108:111]
 ds_read_b128 v[68:71], v172 offset:5120
 v_mfma_f32_16x16x32_bf16 a[104:107], v[92:95], v[120:123], a[104:107]
 v_mfma_f32_16x16x32_bf16 a[100:103], v[92:95], v[116:119], a[100:103]
 ds_read_b64_tr_b16 v[40:41], v168 offset:1024
 v_mfma_f32_16x16x32_bf16 a[96:99], v[92:95], v[112:115], a[96:99]
 ds_read_b64_tr_b16 v[42:43], v168 offset:3072
 v_mfma_f32_16x16x32_bf16 a[128:131], v[96:99], v[112:115], a[128:131]
 buffer_load_dwordx4 v178, s[28:31], s41 offen offset:0 lds
 v_mfma_f32_16x16x32_bf16 a[132:135], v[96:99], v[116:119], a[132:135]
 ds_read_b128 v[72:75], v172 offset:6144
 v_mfma_f32_16x16x32_bf16 a[136:139], v[96:99], v[120:123], a[136:139]
 v_mfma_f32_16x16x32_bf16 a[140:143], v[96:99], v[124:127], a[140:143]
 ds_read_b64_tr_b16 v[44:45], v170 offset:1024
 v_mfma_f32_16x16x32_bf16 a[144:147], v[96:99], v[128:131], a[144:147]
 ds_read_b64_tr_b16 v[46:47], v170 offset:3072
 v_mfma_f32_16x16x32_bf16 a[148:151], v[96:99], v[132:135], a[148:151]
 buffer_load_dwordx4 v179, s[32:35], s41 offen offset:1024 lds
 v_mfma_f32_16x16x32_bf16 v[224:227], v[96:99], v[136:139], v[224:227]
 ds_read_b128 v[76:79], v172 offset:7168
 v_mfma_f32_16x16x32_bf16 v[228:231], v[96:99], v[140:143], v[228:231]
 v_mfma_f32_16x16x32_bf16 v[236:239], v[100:103], v[140:143], v[236:239]
 ds_read_b64_tr_b16 v[144:145], v182 offset:0
 v_mfma_f32_16x16x32_bf16 v[232:235], v[100:103], v[136:139], v[232:235]
 ds_read_b64_tr_b16 v[146:147], v182 offset:256
 v_mfma_f32_16x16x32_bf16 a[180:183], v[100:103], v[132:135], a[180:183]
 v_mfma_f32_16x16x32_bf16 a[176:179], v[100:103], v[128:131], a[176:179]
 ds_read_b128 v[148:151], v183 offset:0
 buffer_load_dwordx4 v180, s[28:31], s41 offen offset:2048 lds
 v_mfma_f32_16x16x32_bf16 a[172:175], v[100:103], v[124:127], a[172:175]
 v_mfma_f32_16x16x32_bf16 a[168:171], v[100:103], v[120:123], a[168:171]
 v_mfma_f32_16x16x32_bf16 a[164:167], v[100:103], v[116:119], a[164:167]
 v_mfma_f32_16x16x32_bf16 a[160:163], v[100:103], v[112:115], a[160:163]
 v_mfma_f32_16x16x32_bf16 a[192:195], v[104:107], v[112:115], a[192:195]
 buffer_load_dwordx4 v181, s[32:35], s41 offen offset:3072 lds
 s_add_u32 s41, s41, s43
 v_mfma_f32_16x16x32_bf16 a[196:199], v[104:107], v[116:119], a[196:199]
 v_mfma_f32_16x16x32_bf16 a[200:203], v[104:107], v[120:123], a[200:203]
 v_mfma_f32_16x16x32_bf16 a[204:207], v[104:107], v[124:127], a[204:207]
 v_mfma_f32_16x16x32_bf16 a[208:211], v[104:107], v[128:131], a[208:211]
 v_mfma_f32_16x16x32_bf16 a[212:215], v[104:107], v[132:135], a[212:215]
 s_add_u32 m0, s46, 12288
 v_mfma_f32_16x16x32_bf16 v[240:243], v[104:107], v[136:139], v[240:243]
 v_mfma_f32_16x16x32_bf16 v[244:247], v[104:107], v[140:143], v[244:247]
 v_mfma_f32_16x16x32_bf16 v[252:255], v[108:111], v[140:143], v[252:255]
 v_mfma_f32_16x16x32_bf16 v[248:251], v[108:111], v[136:139], v[248:251]
 v_mfma_f32_16x16x32_bf16 a[244:247], v[108:111], v[132:135], a[244:247]
 buffer_load_dwordx4 v185, s[36:39], s42 offen lds
 s_add_u32 s42, s42, 2048
 v_mfma_f32_16x16x32_bf16 a[240:243], v[108:111], v[128:131], a[240:243]
 v_mfma_f32_16x16x32_bf16 a[236:239], v[108:111], v[124:127], a[236:239]
 v_mfma_f32_16x16x32_bf16 a[232:235], v[108:111], v[120:123], a[232:235]
 v_mfma_f32_16x16x32_bf16 a[228:231], v[108:111], v[116:119], a[228:231]
 v_mfma_f32_16x16x32_bf16 a[224:227], v[108:111], v[112:115], a[224:227]
 v_mfma_f32_16x16x32_bf16 v[160:163], v[152:155], v[156:159], v[160:163]
 s_waitcnt vmcnt(18) lgkmcnt(0)
 s_barrier
 v_mfma_f32_16x16x32_bf16 a[0:3], v[16:19], v[48:51], a[0:3]
 ds_read_b64_tr_b16 v[80:81], v164 offset:32768
 v_mfma_f32_16x16x32_bf16 a[4:7], v[16:19], v[52:55], a[4:7]
 ds_read_b64_tr_b16 v[82:83], v164 offset:34816
 v_mfma_f32_16x16x32_bf16 a[8:11], v[16:19], v[56:59], a[8:11]
 v_mfma_f32_16x16x32_bf16 a[12:15], v[16:19], v[60:63], a[12:15]
 ds_read_b128 v[112:115], v172 offset:32768
 v_mfma_f32_16x16x32_bf16 a[16:19], v[16:19], v[64:67], a[16:19]
 v_mfma_f32_16x16x32_bf16 a[20:23], v[16:19], v[68:71], a[20:23]
 ds_read_b64_tr_b16 v[84:85], v166 offset:32768
 v_mfma_f32_16x16x32_bf16 v[192:195], v[16:19], v[72:75], v[192:195]
 ds_read_b64_tr_b16 v[86:87], v166 offset:34816
 v_mfma_f32_16x16x32_bf16 v[196:199], v[16:19], v[76:79], v[196:199]
 v_mfma_f32_16x16x32_bf16 v[204:207], v[20:23], v[76:79], v[204:207]
 ds_read_b128 v[116:119], v172 offset:33792
 v_mfma_f32_16x16x32_bf16 v[200:203], v[20:23], v[72:75], v[200:203]
 v_mfma_f32_16x16x32_bf16 a[52:55], v[20:23], v[68:71], a[52:55]
 ds_read_b64_tr_b16 v[88:89], v168 offset:32768
 v_mfma_f32_16x16x32_bf16 a[48:51], v[20:23], v[64:67], a[48:51]
 ds_read_b64_tr_b16 v[90:91], v168 offset:34816
 v_mfma_f32_16x16x32_bf16 a[44:47], v[20:23], v[60:63], a[44:47]
 v_mfma_f32_16x16x32_bf16 a[40:43], v[20:23], v[56:59], a[40:43]
 ds_read_b128 v[120:123], v172 offset:34816
 v_mfma_f32_16x16x32_bf16 a[36:39], v[20:23], v[52:55], a[36:39]
 v_mfma_f32_16x16x32_bf16 a[32:35], v[20:23], v[48:51], a[32:35]
 ds_read_b64_tr_b16 v[92:93], v170 offset:32768
 v_mfma_f32_16x16x32_bf16 a[64:67], v[24:27], v[48:51], a[64:67]
 ds_read_b64_tr_b16 v[94:95], v170 offset:34816
 v_mfma_f32_16x16x32_bf16 a[68:71], v[24:27], v[52:55], a[68:71]
 v_mfma_f32_16x16x32_bf16 a[72:75], v[24:27], v[56:59], a[72:75]
 ds_read_b128 v[124:127], v172 offset:35840
 v_mfma_f32_16x16x32_bf16 a[76:79], v[24:27], v[60:63], a[76:79]
 v_mfma_f32_16x16x32_bf16 a[80:83], v[24:27], v[64:67], a[80:83]
 ds_read_b64_tr_b16 v[96:97], v164 offset:33792
 v_mfma_f32_16x16x32_bf16 a[84:87], v[24:27], v[68:71], a[84:87]
 ds_read_b64_tr_b16 v[98:99], v164 offset:35840
 v_mfma_f32_16x16x32_bf16 v[208:211], v[24:27], v[72:75], v[208:211]
 v_mfma_f32_16x16x32_bf16 v[212:215], v[24:27], v[76:79], v[212:215]
 ds_read_b128 v[128:131], v172 offset:36864
 v_mfma_f32_16x16x32_bf16 v[220:223], v[28:31], v[76:79], v[220:223]
 v_mfma_f32_16x16x32_bf16 v[216:219], v[28:31], v[72:75], v[216:219]
 ds_read_b64_tr_b16 v[100:101], v166 offset:33792
 v_mfma_f32_16x16x32_bf16 a[116:119], v[28:31], v[68:71], a[116:119]
 ds_read_b64_tr_b16 v[102:103], v166 offset:35840
 v_mfma_f32_16x16x32_bf16 a[112:115], v[28:31], v[64:67], a[112:115]
 v_mfma_f32_16x16x32_bf16 a[108:111], v[28:31], v[60:63], a[108:111]
 ds_read_b128 v[132:135], v172 offset:37888
 v_mfma_f32_16x16x32_bf16 a[104:107], v[28:31], v[56:59], a[104:107]
 v_mfma_f32_16x16x32_bf16 a[100:103], v[28:31], v[52:55], a[100:103]
 ds_read_b64_tr_b16 v[104:105], v168 offset:33792
 v_mfma_f32_16x16x32_bf16 a[96:99], v[28:31], v[48:51], a[96:99]
 ds_read_b64_tr_b16 v[106:107], v168 offset:35840
 v_mfma_f32_16x16x32_bf16 a[128:131], v[32:35], v[48:51], a[128:131]
 v_mfma_f32_16x16x32_bf16 a[132:135], v[32:35], v[52:55], a[132:135]
 ds_read_b128 v[136:139], v172 offset:38912
 v_mfma_f32_16x16x32_bf16 a[136:139], v[32:35], v[56:59], a[136:139]
 v_mfma_f32_16x16x32_bf16 a[140:143], v[32:35], v[60:63], a[140:143]
 ds_read_b64_tr_b16 v[108:109], v170 offset:33792
 v_mfma_f32_16x16x32_bf16 a[144:147], v[32:35], v[64:67], a[144:147]
 ds_read_b64_tr_b16 v[110:111], v170 offset:35840
 v_mfma_f32_16x16x32_bf16 a[148:151], v[32:35], v[68:71], a[148:151]
 v_mfma_f32_16x16x32_bf16 v[224:227], v[32:35], v[72:75], v[224:227]
 ds_read_b128 v[140:143], v172 offset:39936
 v_mfma_f32_16x16x32_bf16 v[228:231], v[32:35], v[76:79], v[228:231]
 v_mfma_f32_16x16x32_bf16 v[236:239], v[36:39], v[76:79], v[236:239]
 ds_read_b64_tr_b16 v[152:153], v182 offset:4096
 v_mfma_f32_16x16x32_bf16 v[232:235], v[36:39], v[72:75], v[232:235]
 ds_read_b64_tr_b16 v[154:155], v182 offset:4352
 v_mfma_f32_16x16x32_bf16 a[180:183], v[36:39], v[68:71], a[180:183]
 v_mfma_f32_16x16x32_bf16 a[176:179], v[36:39], v[64:67], a[176:179]
 ds_read_b128 v[156:159], v183 offset:32768
 v_mfma_f32_16x16x32_bf16 a[172:175], v[36:39], v[60:63], a[172:175]
 v_mfma_f32_16x16x32_bf16 a[168:171], v[36:39], v[56:59], a[168:171]
 v_mfma_f32_16x16x32_bf16 a[164:167], v[36:39], v[52:55], a[164:167]
 v_mfma_f32_16x16x32_bf16 a[160:163], v[36:39], v[48:51], a[160:163]
 v_mfma_f32_16x16x32_bf16 a[192:195], v[40:43], v[48:51], a[192:195]
 v_mfma_f32_16x16x32_bf16 a[196:199], v[40:43], v[52:55], a[196:199]
 v_mfma_f32_16x16x32_bf16 a[200:203], v[40:43], v[56:59], a[200:203]
 v_mfma_f32_16x16x32_bf16 a[204:207], v[40:43], v[60:63], a[204:207]
 v_mfma_f32_16x16x32_bf16 a[208:211], v[40:43], v[64:67], a[208:211]
 v_mfma_f32_16x16x32_bf16 a[212:215], v[40:43], v[68:71], a[212:215]
 v_mfma_f32_16x16x32_bf16 v[240:243], v[40:43], v[72:75], v[240:243]
 v_mfma_f32_16x16x32_bf16 v[244:247], v[40:43], v[76:79], v[244:247]
 v_mfma_f32_16x16x32_bf16 v[252:255], v[44:47], v[76:79], v[252:255]
 v_mfma_f32_16x16x32_bf16 v[248:251], v[44:47], v[72:75], v[248:251]
 v_mfma_f32_16x16x32_bf16 a[244:247], v[44:47], v[68:71], a[244:247]
 v_mfma_f32_16x16x32_bf16 a[240:243], v[44:47], v[64:67], a[240:243]
 v_mfma_f32_16x16x32_bf16 a[236:239], v[44:47], v[60:63], a[236:239]
 v_mfma_f32_16x16x32_bf16 a[232:235], v[44:47], v[56:59], a[232:235]
 v_mfma_f32_16x16x32_bf16 a[228:231], v[44:47], v[52:55], a[228:231]
 v_mfma_f32_16x16x32_bf16 a[224:227], v[44:47], v[48:51], a[224:227]
 v_mfma_f32_16x16x32_bf16 v[160:163], v[144:147], v[148:151], v[160:163]
 s_waitcnt vmcnt(9) lgkmcnt(0)
 s_barrier
 v_mfma_f32_16x16x32_bf16 a[0:3], v[80:83], v[112:115], a[0:3]
 ds_read_b64_tr_b16 v[16:17], v165 offset:0
 s_mov_b32 s64, s92
 s_and_b32 s65, s93, 0xffff
 s_mov_b32 s66, 7340032
 s_mov_b32 s67, 0x20000
 s_mov_b32 s52, 0
 buffer_load_dword v3, v1, s[64:67], s52 offen
 v_mfma_f32_16x16x32_bf16 a[4:7], v[80:83], v[116:119], a[4:7]
 ds_read_b64_tr_b16 v[18:19], v165 offset:2048
 v_mfma_f32_16x16x32_bf16 a[8:11], v[80:83], v[120:123], a[8:11]
 v_mfma_f32_16x16x32_bf16 a[12:15], v[80:83], v[124:127], a[12:15]
 ds_read_b128 v[48:51], v173 offset:0
 v_mfma_f32_16x16x32_bf16 a[16:19], v[80:83], v[128:131], a[16:19]
 v_mfma_f32_16x16x32_bf16 a[20:23], v[80:83], v[132:135], a[20:23]
 ds_read_b64_tr_b16 v[20:21], v167 offset:0
 v_mfma_f32_16x16x32_bf16 v[192:195], v[80:83], v[136:139], v[192:195]
 ds_read_b64_tr_b16 v[22:23], v167 offset:2048
 v_mfma_f32_16x16x32_bf16 v[196:199], v[80:83], v[140:143], v[196:199]
 v_mfma_f32_16x16x32_bf16 v[204:207], v[84:87], v[140:143], v[204:207]
 ds_read_b128 v[52:55], v173 offset:1024
 v_mfma_f32_16x16x32_bf16 v[200:203], v[84:87], v[136:139], v[200:203]
 v_mfma_f32_16x16x32_bf16 a[52:55], v[84:87], v[132:135], a[52:55]
 ds_read_b64_tr_b16 v[24:25], v169 offset:0
 v_mfma_f32_16x16x32_bf16 a[48:51], v[84:87], v[128:131], a[48:51]
 ds_read_b64_tr_b16 v[26:27], v169 offset:2048
 v_mfma_f32_16x16x32_bf16 a[44:47], v[84:87], v[124:127], a[44:47]
 v_mfma_f32_16x16x32_bf16 a[40:43], v[84:87], v[120:123], a[40:43]
 ds_read_b128 v[56:59], v173 offset:2048
 v_mfma_f32_16x16x32_bf16 a[36:39], v[84:87], v[116:119], a[36:39]
 v_mfma_f32_16x16x32_bf16 a[32:35], v[84:87], v[112:115], a[32:35]
 ds_read_b64_tr_b16 v[28:29], v171 offset:0
 v_mfma_f32_16x16x32_bf16 a[64:67], v[88:91], v[112:115], a[64:67]
 ds_read_b64_tr_b16 v[30:31], v171 offset:2048
 v_mfma_f32_16x16x32_bf16 a[68:71], v[88:91], v[116:119], a[68:71]
 v_mfma_f32_16x16x32_bf16 a[72:75], v[88:91], v[120:123], a[72:75]
 ds_read_b128 v[60:63], v173 offset:3072
 v_mfma_f32_16x16x32_bf16 a[76:79], v[88:91], v[124:127], a[76:79]
 v_mfma_f32_16x16x32_bf16 a[80:83], v[88:91], v[128:131], a[80:83]
 ds_read_b64_tr_b16 v[32:33], v165 offset:1024
 v_mfma_f32_16x16x32_bf16 a[84:87], v[88:91], v[132:135], a[84:87]
 ds_read_b64_tr_b16 v[34:35], v165 offset:3072
 v_mfma_f32_16x16x32_bf16 v[208:211], v[88:91], v[136:139], v[208:211]
 v_mfma_f32_16x16x32_bf16 v[212:215], v[88:91], v[140:143], v[212:215]
 ds_read_b128 v[64:67], v173 offset:4096
 v_mfma_f32_16x16x32_bf16 v[220:223], v[92:95], v[140:143], v[220:223]
 v_mfma_f32_16x16x32_bf16 v[216:219], v[92:95], v[136:139], v[216:219]
 ds_read_b64_tr_b16 v[36:37], v167 offset:1024
 v_mfma_f32_16x16x32_bf16 a[116:119], v[92:95], v[132:135], a[116:119]
 ds_read_b64_tr_b16 v[38:39], v167 offset:3072
 v_mfma_f32_16x16x32_bf16 a[112:115], v[92:95], v[128:131], a[112:115]
 v_mfma_f32_16x16x32_bf16 a[108:111], v[92:95], v[124:127], a[108:111]
 ds_read_b128 v[68:71], v173 offset:5120
 v_mfma_f32_16x16x32_bf16 a[104:107], v[92:95], v[120:123], a[104:107]
 v_mfma_f32_16x16x32_bf16 a[100:103], v[92:95], v[116:119], a[100:103]
 ds_read_b64_tr_b16 v[40:41], v169 offset:1024
 v_mfma_f32_16x16x32_bf16 a[96:99], v[92:95], v[112:115], a[96:99]
 ds_read_b64_tr_b16 v[42:43], v169 offset:3072
 v_mfma_f32_16x16x32_bf16 a[128:131], v[96:99], v[112:115], a[128:131]
 v_mfma_f32_16x16x32_bf16 a[132:135], v[96:99], v[116:119], a[132:135]
 ds_read_b128 v[72:75], v173 offset:6144
 v_mfma_f32_16x16x32_bf16 a[136:139], v[96:99], v[120:123], a[136:139]
 v_mfma_f32_16x16x32_bf16 a[140:143], v[96:99], v[124:127], a[140:143]
 ds_read_b64_tr_b16 v[44:45], v171 offset:1024
 v_mfma_f32_16x16x32_bf16 a[144:147], v[96:99], v[128:131], a[144:147]
 ds_read_b64_tr_b16 v[46:47], v171 offset:3072
 v_mfma_f32_16x16x32_bf16 a[148:151], v[96:99], v[132:135], a[148:151]
 v_mfma_f32_16x16x32_bf16 v[224:227], v[96:99], v[136:139], v[224:227]
 ds_read_b128 v[76:79], v173 offset:7168
 v_mfma_f32_16x16x32_bf16 v[228:231], v[96:99], v[140:143], v[228:231]
 v_mfma_f32_16x16x32_bf16 v[236:239], v[100:103], v[140:143], v[236:239]
 ds_read_b64_tr_b16 v[144:145], v182 offset:8192
 v_mfma_f32_16x16x32_bf16 v[232:235], v[100:103], v[136:139], v[232:235]
 ds_read_b64_tr_b16 v[146:147], v182 offset:8448
 v_mfma_f32_16x16x32_bf16 a[180:183], v[100:103], v[132:135], a[180:183]
 v_mfma_f32_16x16x32_bf16 a[176:179], v[100:103], v[128:131], a[176:179]
 ds_read_b128 v[148:151], v184 offset:0
 v_mfma_f32_16x16x32_bf16 a[172:175], v[100:103], v[124:127], a[172:175]
 v_mfma_f32_16x16x32_bf16 a[168:171], v[100:103], v[120:123], a[168:171]
 v_mfma_f32_16x16x32_bf16 a[164:167], v[100:103], v[116:119], a[164:167]
 v_mfma_f32_16x16x32_bf16 a[160:163], v[100:103], v[112:115], a[160:163]
 v_mfma_f32_16x16x32_bf16 a[192:195], v[104:107], v[112:115], a[192:195]
 v_mfma_f32_16x16x32_bf16 a[196:199], v[104:107], v[116:119], a[196:199]
 v_mfma_f32_16x16x32_bf16 a[200:203], v[104:107], v[120:123], a[200:203]
 v_mfma_f32_16x16x32_bf16 a[204:207], v[104:107], v[124:127], a[204:207]
 v_mfma_f32_16x16x32_bf16 a[208:211], v[104:107], v[128:131], a[208:211]
 v_mfma_f32_16x16x32_bf16 a[212:215], v[104:107], v[132:135], a[212:215]
 v_mfma_f32_16x16x32_bf16 v[240:243], v[104:107], v[136:139], v[240:243]
 v_mfma_f32_16x16x32_bf16 v[244:247], v[104:107], v[140:143], v[244:247]
 v_mfma_f32_16x16x32_bf16 v[252:255], v[108:111], v[140:143], v[252:255]
 v_mfma_f32_16x16x32_bf16 v[248:251], v[108:111], v[136:139], v[248:251]
 v_mfma_f32_16x16x32_bf16 a[244:247], v[108:111], v[132:135], a[244:247]
 v_mfma_f32_16x16x32_bf16 a[240:243], v[108:111], v[128:131], a[240:243]
 v_mfma_f32_16x16x32_bf16 a[236:239], v[108:111], v[124:127], a[236:239]
 v_mfma_f32_16x16x32_bf16 a[232:235], v[108:111], v[120:123], a[232:235]
 v_mfma_f32_16x16x32_bf16 a[228:231], v[108:111], v[116:119], a[228:231]
 v_mfma_f32_16x16x32_bf16 a[224:227], v[108:111], v[112:115], a[224:227]
 v_mfma_f32_16x16x32_bf16 v[160:163], v[152:155], v[156:159], v[160:163]
 s_waitcnt vmcnt(1) lgkmcnt(0)
 s_barrier
 v_mfma_f32_16x16x32_bf16 a[0:3], v[16:19], v[48:51], a[0:3]
 ds_read_b64_tr_b16 v[80:81], v165 offset:32768
 s_mov_b32 s64, s90
 s_and_b32 s65, s91, 0xffff
 s_mov_b32 s66, 2097152
 s_mov_b32 s67, 0x20000
 s_mov_b32 s52, 0
 buffer_load_dword v3, v1, s[64:67], s52 offen
 v_mfma_f32_16x16x32_bf16 a[4:7], v[16:19], v[52:55], a[4:7]
 ds_read_b64_tr_b16 v[82:83], v165 offset:34816
 v_mfma_f32_16x16x32_bf16 a[8:11], v[16:19], v[56:59], a[8:11]
 v_mfma_f32_16x16x32_bf16 a[12:15], v[16:19], v[60:63], a[12:15]
 ds_read_b128 v[112:115], v173 offset:32768
 v_mfma_f32_16x16x32_bf16 a[16:19], v[16:19], v[64:67], a[16:19]
 v_mfma_f32_16x16x32_bf16 a[20:23], v[16:19], v[68:71], a[20:23]
 ds_read_b64_tr_b16 v[84:85], v167 offset:32768
 v_mfma_f32_16x16x32_bf16 v[192:195], v[16:19], v[72:75], v[192:195]
 ds_read_b64_tr_b16 v[86:87], v167 offset:34816
 v_mfma_f32_16x16x32_bf16 v[196:199], v[16:19], v[76:79], v[196:199]
 v_mfma_f32_16x16x32_bf16 v[204:207], v[20:23], v[76:79], v[204:207]
 ds_read_b128 v[116:119], v173 offset:33792
 v_mfma_f32_16x16x32_bf16 v[200:203], v[20:23], v[72:75], v[200:203]
 v_mfma_f32_16x16x32_bf16 a[52:55], v[20:23], v[68:71], a[52:55]
 ds_read_b64_tr_b16 v[88:89], v169 offset:32768
 v_mfma_f32_16x16x32_bf16 a[48:51], v[20:23], v[64:67], a[48:51]
 ds_read_b64_tr_b16 v[90:91], v169 offset:34816
 v_mfma_f32_16x16x32_bf16 a[44:47], v[20:23], v[60:63], a[44:47]
 v_mfma_f32_16x16x32_bf16 a[40:43], v[20:23], v[56:59], a[40:43]
 ds_read_b128 v[120:123], v173 offset:34816
 v_mfma_f32_16x16x32_bf16 a[36:39], v[20:23], v[52:55], a[36:39]
 v_mfma_f32_16x16x32_bf16 a[32:35], v[20:23], v[48:51], a[32:35]
 ds_read_b64_tr_b16 v[92:93], v171 offset:32768
 v_mfma_f32_16x16x32_bf16 a[64:67], v[24:27], v[48:51], a[64:67]
 ds_read_b64_tr_b16 v[94:95], v171 offset:34816
 v_mfma_f32_16x16x32_bf16 a[68:71], v[24:27], v[52:55], a[68:71]
 v_mfma_f32_16x16x32_bf16 a[72:75], v[24:27], v[56:59], a[72:75]
 ds_read_b128 v[124:127], v173 offset:35840
 v_mfma_f32_16x16x32_bf16 a[76:79], v[24:27], v[60:63], a[76:79]
 v_mfma_f32_16x16x32_bf16 a[80:83], v[24:27], v[64:67], a[80:83]
 ds_read_b64_tr_b16 v[96:97], v165 offset:33792
 v_mfma_f32_16x16x32_bf16 a[84:87], v[24:27], v[68:71], a[84:87]
 ds_read_b64_tr_b16 v[98:99], v165 offset:35840
 v_mfma_f32_16x16x32_bf16 v[208:211], v[24:27], v[72:75], v[208:211]
 v_mfma_f32_16x16x32_bf16 v[212:215], v[24:27], v[76:79], v[212:215]
 ds_read_b128 v[128:131], v173 offset:36864
 v_mfma_f32_16x16x32_bf16 v[220:223], v[28:31], v[76:79], v[220:223]
 v_mfma_f32_16x16x32_bf16 v[216:219], v[28:31], v[72:75], v[216:219]
 ds_read_b64_tr_b16 v[100:101], v167 offset:33792
 v_mfma_f32_16x16x32_bf16 a[116:119], v[28:31], v[68:71], a[116:119]
 ds_read_b64_tr_b16 v[102:103], v167 offset:35840
 v_mfma_f32_16x16x32_bf16 a[112:115], v[28:31], v[64:67], a[112:115]
 v_mfma_f32_16x16x32_bf16 a[108:111], v[28:31], v[60:63], a[108:111]
 ds_read_b128 v[132:135], v173 offset:37888
 v_mfma_f32_16x16x32_bf16 a[104:107], v[28:31], v[56:59], a[104:107]
 v_mfma_f32_16x16x32_bf16 a[100:103], v[28:31], v[52:55], a[100:103]
 ds_read_b64_tr_b16 v[104:105], v169 offset:33792
 v_mfma_f32_16x16x32_bf16 a[96:99], v[28:31], v[48:51], a[96:99]
 ds_read_b64_tr_b16 v[106:107], v169 offset:35840
 v_mfma_f32_16x16x32_bf16 a[128:131], v[32:35], v[48:51], a[128:131]
 v_mfma_f32_16x16x32_bf16 a[132:135], v[32:35], v[52:55], a[132:135]
 ds_read_b128 v[136:139], v173 offset:38912
 v_mfma_f32_16x16x32_bf16 a[136:139], v[32:35], v[56:59], a[136:139]
 v_mfma_f32_16x16x32_bf16 a[140:143], v[32:35], v[60:63], a[140:143]
 ds_read_b64_tr_b16 v[108:109], v171 offset:33792
 v_mfma_f32_16x16x32_bf16 a[144:147], v[32:35], v[64:67], a[144:147]
 ds_read_b64_tr_b16 v[110:111], v171 offset:35840
 v_mfma_f32_16x16x32_bf16 a[148:151], v[32:35], v[68:71], a[148:151]
 v_mfma_f32_16x16x32_bf16 v[224:227], v[32:35], v[72:75], v[224:227]
 ds_read_b128 v[140:143], v173 offset:39936
 v_mfma_f32_16x16x32_bf16 v[228:231], v[32:35], v[76:79], v[228:231]
 v_mfma_f32_16x16x32_bf16 v[236:239], v[36:39], v[76:79], v[236:239]
 ds_read_b64_tr_b16 v[152:153], v182 offset:12288
 v_mfma_f32_16x16x32_bf16 v[232:235], v[36:39], v[72:75], v[232:235]
 ds_read_b64_tr_b16 v[154:155], v182 offset:12544
 v_mfma_f32_16x16x32_bf16 a[180:183], v[36:39], v[68:71], a[180:183]
 v_mfma_f32_16x16x32_bf16 a[176:179], v[36:39], v[64:67], a[176:179]
 ds_read_b128 v[156:159], v184 offset:32768
 v_mfma_f32_16x16x32_bf16 a[172:175], v[36:39], v[60:63], a[172:175]
 v_mfma_f32_16x16x32_bf16 a[168:171], v[36:39], v[56:59], a[168:171]
 v_mfma_f32_16x16x32_bf16 a[164:167], v[36:39], v[52:55], a[164:167]
 v_mfma_f32_16x16x32_bf16 a[160:163], v[36:39], v[48:51], a[160:163]
 v_mfma_f32_16x16x32_bf16 a[192:195], v[40:43], v[48:51], a[192:195]
 v_mfma_f32_16x16x32_bf16 a[196:199], v[40:43], v[52:55], a[196:199]
 v_mfma_f32_16x16x32_bf16 a[200:203], v[40:43], v[56:59], a[200:203]
 v_mfma_f32_16x16x32_bf16 a[204:207], v[40:43], v[60:63], a[204:207]
 v_mfma_f32_16x16x32_bf16 a[208:211], v[40:43], v[64:67], a[208:211]
 v_mfma_f32_16x16x32_bf16 a[212:215], v[40:43], v[68:71], a[212:215]
 v_mfma_f32_16x16x32_bf16 v[240:243], v[40:43], v[72:75], v[240:243]
 v_mfma_f32_16x16x32_bf16 v[244:247], v[40:43], v[76:79], v[244:247]
 v_mfma_f32_16x16x32_bf16 v[252:255], v[44:47], v[76:79], v[252:255]
 v_mfma_f32_16x16x32_bf16 v[248:251], v[44:47], v[72:75], v[248:251]
 v_mfma_f32_16x16x32_bf16 a[244:247], v[44:47], v[68:71], a[244:247]
 v_mfma_f32_16x16x32_bf16 a[240:243], v[44:47], v[64:67], a[240:243]
 v_mfma_f32_16x16x32_bf16 a[236:239], v[44:47], v[60:63], a[236:239]
 v_mfma_f32_16x16x32_bf16 a[232:235], v[44:47], v[56:59], a[232:235]
 v_mfma_f32_16x16x32_bf16 a[228:231], v[44:47], v[52:55], a[228:231]
 v_mfma_f32_16x16x32_bf16 a[224:227], v[44:47], v[48:51], a[224:227]
 v_mfma_f32_16x16x32_bf16 v[160:163], v[144:147], v[148:151], v[160:163]
 s_waitcnt vmcnt(63) lgkmcnt(0)
 s_barrier
 v_mfma_f32_16x16x32_bf16 a[0:3], v[80:83], v[112:115], a[0:3]
 v_mfma_f32_16x16x32_bf16 a[4:7], v[80:83], v[116:119], a[4:7]
 v_mfma_f32_16x16x32_bf16 a[8:11], v[80:83], v[120:123], a[8:11]
 v_mfma_f32_16x16x32_bf16 a[12:15], v[80:83], v[124:127], a[12:15]
 v_mfma_f32_16x16x32_bf16 a[16:19], v[80:83], v[128:131], a[16:19]
 v_mfma_f32_16x16x32_bf16 a[20:23], v[80:83], v[132:135], a[20:23]
 v_mfma_f32_16x16x32_bf16 v[192:195], v[80:83], v[136:139], v[192:195]
 v_mfma_f32_16x16x32_bf16 v[196:199], v[80:83], v[140:143], v[196:199]
 v_mfma_f32_16x16x32_bf16 v[204:207], v[84:87], v[140:143], v[204:207]
 v_mfma_f32_16x16x32_bf16 v[200:203], v[84:87], v[136:139], v[200:203]
 v_mfma_f32_16x16x32_bf16 a[52:55], v[84:87], v[132:135], a[52:55]
 v_mfma_f32_16x16x32_bf16 a[48:51], v[84:87], v[128:131], a[48:51]
 v_mfma_f32_16x16x32_bf16 a[44:47], v[84:87], v[124:127], a[44:47]
 v_mfma_f32_16x16x32_bf16 a[40:43], v[84:87], v[120:123], a[40:43]
 v_mfma_f32_16x16x32_bf16 a[36:39], v[84:87], v[116:119], a[36:39]
 v_mfma_f32_16x16x32_bf16 a[32:35], v[84:87], v[112:115], a[32:35]
 v_mfma_f32_16x16x32_bf16 a[64:67], v[88:91], v[112:115], a[64:67]
 v_mfma_f32_16x16x32_bf16 a[68:71], v[88:91], v[116:119], a[68:71]
 v_mfma_f32_16x16x32_bf16 a[72:75], v[88:91], v[120:123], a[72:75]
 v_mfma_f32_16x16x32_bf16 a[76:79], v[88:91], v[124:127], a[76:79]
 v_mfma_f32_16x16x32_bf16 a[80:83], v[88:91], v[128:131], a[80:83]
 v_mfma_f32_16x16x32_bf16 a[84:87], v[88:91], v[132:135], a[84:87]
 v_mfma_f32_16x16x32_bf16 v[208:211], v[88:91], v[136:139], v[208:211]
 v_mfma_f32_16x16x32_bf16 v[212:215], v[88:91], v[140:143], v[212:215]
 v_mfma_f32_16x16x32_bf16 v[220:223], v[92:95], v[140:143], v[220:223]
 v_mfma_f32_16x16x32_bf16 v[216:219], v[92:95], v[136:139], v[216:219]
 v_mfma_f32_16x16x32_bf16 a[116:119], v[92:95], v[132:135], a[116:119]
 v_mfma_f32_16x16x32_bf16 a[112:115], v[92:95], v[128:131], a[112:115]
 v_mfma_f32_16x16x32_bf16 a[108:111], v[92:95], v[124:127], a[108:111]
 v_mfma_f32_16x16x32_bf16 a[104:107], v[92:95], v[120:123], a[104:107]
 v_mfma_f32_16x16x32_bf16 a[100:103], v[92:95], v[116:119], a[100:103]
 v_mfma_f32_16x16x32_bf16 a[96:99], v[92:95], v[112:115], a[96:99]
 v_mfma_f32_16x16x32_bf16 a[128:131], v[96:99], v[112:115], a[128:131]
 v_mfma_f32_16x16x32_bf16 a[132:135], v[96:99], v[116:119], a[132:135]
 v_mfma_f32_16x16x32_bf16 a[136:139], v[96:99], v[120:123], a[136:139]
 v_mfma_f32_16x16x32_bf16 a[140:143], v[96:99], v[124:127], a[140:143]
 v_mfma_f32_16x16x32_bf16 a[144:147], v[96:99], v[128:131], a[144:147]
 v_mfma_f32_16x16x32_bf16 a[148:151], v[96:99], v[132:135], a[148:151]
 v_mfma_f32_16x16x32_bf16 v[224:227], v[96:99], v[136:139], v[224:227]
 v_mfma_f32_16x16x32_bf16 v[228:231], v[96:99], v[140:143], v[228:231]
 v_mfma_f32_16x16x32_bf16 v[236:239], v[100:103], v[140:143], v[236:239]
 v_mfma_f32_16x16x32_bf16 v[232:235], v[100:103], v[136:139], v[232:235]
 v_mfma_f32_16x16x32_bf16 a[180:183], v[100:103], v[132:135], a[180:183]
 v_mfma_f32_16x16x32_bf16 a[176:179], v[100:103], v[128:131], a[176:179]
 v_mfma_f32_16x16x32_bf16 a[172:175], v[100:103], v[124:127], a[172:175]
 v_mfma_f32_16x16x32_bf16 a[168:171], v[100:103], v[120:123], a[168:171]
 v_mfma_f32_16x16x32_bf16 a[164:167], v[100:103], v[116:119], a[164:167]
 v_mfma_f32_16x16x32_bf16 a[160:163], v[100:103], v[112:115], a[160:163]
 v_mfma_f32_16x16x32_bf16 a[192:195], v[104:107], v[112:115], a[192:195]
 v_mfma_f32_16x16x32_bf16 a[196:199], v[104:107], v[116:119], a[196:199]
 v_mfma_f32_16x16x32_bf16 a[200:203], v[104:107], v[120:123], a[200:203]
 v_mfma_f32_16x16x32_bf16 a[204:207], v[104:107], v[124:127], a[204:207]
 v_mfma_f32_16x16x32_bf16 a[208:211], v[104:107], v[128:131], a[208:211]
 v_mfma_f32_16x16x32_bf16 a[212:215], v[104:107], v[132:135], a[212:215]
 v_mfma_f32_16x16x32_bf16 v[240:243], v[104:107], v[136:139], v[240:243]
 v_mfma_f32_16x16x32_bf16 v[244:247], v[104:107], v[140:143], v[244:247]
 v_mfma_f32_16x16x32_bf16 v[252:255], v[108:111], v[140:143], v[252:255]
 v_mfma_f32_16x16x32_bf16 v[248:251], v[108:111], v[136:139], v[248:251]
 v_mfma_f32_16x16x32_bf16 a[244:247], v[108:111], v[132:135], a[244:247]
 v_mfma_f32_16x16x32_bf16 a[240:243], v[108:111], v[128:131], a[240:243]
 v_mfma_f32_16x16x32_bf16 a[236:239], v[108:111], v[124:127], a[236:239]
 v_mfma_f32_16x16x32_bf16 a[232:235], v[108:111], v[120:123], a[232:235]
 v_mfma_f32_16x16x32_bf16 a[228:231], v[108:111], v[116:119], a[228:231]
 v_mfma_f32_16x16x32_bf16 a[224:227], v[108:111], v[112:115], a[224:227]
 v_mfma_f32_16x16x32_bf16 v[160:163], v[152:155], v[156:159], v[160:163]
 s_nop 15
 s_nop 3
 s_lshl_b32 s52, s21, 3
 s_lshr_b32 s53, s48, 1
 s_add_u32 s52, s52, s53
 s_lshl_b32 s52, s52, 12
 s_add_u32 s52, s52, 8388608
 s_add_u32 s68, s4, s52
 s_addc_u32 s69, s5, 0
 s_and_b32 s69, s69, 0xffff
 s_mov_b32 s70, 4096
 s_mov_b32 s71, 0x20000
 v_cvt_pk_bf16_f32 v144, v160, v161
 v_cvt_pk_bf16_f32 v145, v162, v163
 s_and_b32 s52, s48, 1
 s_and_b32 s53, s20, 1
 v_and_b32 v187, 15, v0
 v_lshrrev_b32 v188, 4, v0
 s_cmp_lt_u32 s20, 2
 s_cbranch_scc0 L_gemm1_kernel_vst
 v_lshlrev_b32 v189, 4, v0
 s_lshl_b32 s52, s52, 10
 s_lshl_b32 s53, s53, 3
 s_add_u32 s52, s52, s53
 buffer_store_dwordx2 v[144:145], v189, s[68:71], s52 offen
 s_branch L_gemm1_kernel_kvdone
L_gemm1_kernel_vst:
 v_lshlrev_b32 v189, 2, v188
 v_lshrrev_b32 v188, 2, v187
 v_lshl_add_u32 v189, v188, 4, v189
 v_lshlrev_b32 v189, 4, v189
 v_and_b32 v188, 3, v187
 v_lshl_add_u32 v189, v188, 1, v189
 s_lshl_b32 s52, s52, 3
 s_lshl_b32 s53, s53, 10
 s_add_u32 s52, s52, s53
 s_add_u32 s52, s52, 2048
 buffer_store_short v144, v189, s[68:71], s52 offen offset:0
 buffer_store_short_d16_hi v144, v189, s[68:71], s52 offen offset:16
 buffer_store_short v145, v189, s[68:71], s52 offen offset:32
 buffer_store_short_d16_hi v145, v189, s[68:71], s52 offen offset:48
L_gemm1_kernel_kvdone:
 s_branch L_gemm1_kernel_sel
L_gemm1_kernel_nokv:
 s_add_u32 m0, s44, 0
 s_nop 0
 buffer_load_dwordx4 v174, s[24:27], s40 offen offset:0 lds
 buffer_load_dwordx4 v175, s[24:27], s40 offen offset:1024 lds
 buffer_load_dwordx4 v176, s[24:27], s40 offen offset:2048 lds
 buffer_load_dwordx4 v177, s[24:27], s40 offen offset:3072 lds
 s_add_u32 s40, s40, 16384
 s_add_u32 m0, s45, 0
 s_nop 0
 buffer_load_dwordx4 v178, s[28:31], s41 offen offset:0 lds
 buffer_load_dwordx4 v179, s[32:35], s41 offen offset:1024 lds
 buffer_load_dwordx4 v180, s[28:31], s41 offen offset:2048 lds
 buffer_load_dwordx4 v181, s[32:35], s41 offen offset:3072 lds
 s_add_u32 s41, s41, s43
 s_add_u32 m0, s44, 32768
 s_nop 0
 buffer_load_dwordx4 v174, s[24:27], s40 offen offset:0 lds
 buffer_load_dwordx4 v175, s[24:27], s40 offen offset:1024 lds
 buffer_load_dwordx4 v176, s[24:27], s40 offen offset:2048 lds
 buffer_load_dwordx4 v177, s[24:27], s40 offen offset:3072 lds
 s_add_u32 s40, s40, 16384
 s_add_u32 m0, s45, 32768
 s_nop 0
 buffer_load_dwordx4 v178, s[28:31], s41 offen offset:0 lds
 buffer_load_dwordx4 v179, s[32:35], s41 offen offset:1024 lds
 buffer_load_dwordx4 v180, s[28:31], s41 offen offset:2048 lds
 buffer_load_dwordx4 v181, s[32:35], s41 offen offset:3072 lds
 s_add_u32 s41, s41, s43
 v_bfe_u32 v187, v0, 2, 2
 v_lshrrev_b32 v186, 4, v0
 v_lshlrev_b32 v188, 12, v186
 v_lshl_add_u32 v188, v187, 8, v188
 v_and_b32 v189, 3, v0
 v_lshl_add_u32 v188, v189, 3, v188
 v_add_u32 v188, 16384, v188
 v_and_b32 v189, 1, v186
 v_lshl_add_u32 v2, v187, 1, v189
 s_lshl_b32 s52, s49, 2
 s_add_u32 s52, s52, 0
 v_xor_b32 v189, s52, v2
 v_lshl_add_u32 v164, v189, 5, v188
 v_add_u32 v165, 65536, v164
 s_lshl_b32 s52, s49, 2
 s_add_u32 s52, s52, 1
 v_xor_b32 v189, s52, v2
 v_lshl_add_u32 v166, v189, 5, v188
 v_add_u32 v167, 65536, v166
 s_lshl_b32 s52, s49, 2
 s_add_u32 s52, s52, 2
 v_xor_b32 v189, s52, v2
 v_lshl_add_u32 v168, v189, 5, v188
 v_add_u32 v169, 65536, v168
 s_lshl_b32 s52, s49, 2
 s_add_u32 s52, s52, 3
 v_xor_b32 v189, s52, v2
 v_lshl_add_u32 v170, v189, 5, v188
 v_add_u32 v171, 65536, v170
 s_lshl_b32 s52, s50, 13
 v_and_b32 v188, 15, v0
 v_lshrrev_b32 v189, 4, v0
 v_lshrrev_b32 v2, 2, v188
 v_sub_u32 v2, 0, v2
 v_xor_b32 v189, v189, v2
 v_and_b32 v189, 3, v189
 v_lshlrev_b32 v188, 6, v188
 v_add_u32 v188, s52, v188
 v_lshl_add_u32 v172, v189, 4, v188
 v_add_u32 v173, 65536, v172
 v_bfe_u32 v187, v0, 2, 2
 v_lshrrev_b32 v186, 4, v0
 v_lshlrev_b32 v188, 9, v186
 v_lshl_add_u32 v188, v187, 6, v188
 v_and_b32 v189, 3, v0
 v_lshl_add_u32 v188, v189, 3, v188
 s_lshr_b32 s52, s20, 1
 s_lshl_b32 s52, s52, 11
 s_and_b32 s53, s20, 1
 s_lshl_b32 s53, s53, 5
 s_add_u32 s52, s52, s53
 s_add_u32 s52, s52, 131072
 v_add_u32 v182, s52, v188
 s_and_b32 s52, s48, 15
 s_lshl_b32 s52, s52, 10
 v_and_b32 v188, 15, v0
 v_lshrrev_b32 v189, 4, v0
 v_lshrrev_b32 v2, 2, v188
 v_sub_u32 v2, 0, v2
 v_xor_b32 v189, v189, v2
 v_and_b32 v189, 3, v189
 v_lshlrev_b32 v188, 6, v188
 v_add_u32 v188, s52, v188
 v_lshl_add_u32 v183, v189, 4, v188
 v_add_u32 v184, 65536, v183
 s_mov_b32 s47, 0
 s_waitcnt vmcnt(8)
 s_barrier
 ds_read_b64_tr_b16 v[16:17], v164 offset:0
 ds_read_b64_tr_b16 v[18:19], v164 offset:2048
 ds_read_b128 v[48:51], v172 offset:0
 ds_read_b64_tr_b16 v[20:21], v166 offset:0
 ds_read_b64_tr_b16 v[22:23], v166 offset:2048
 ds_read_b128 v[52:55], v172 offset:1024
 ds_read_b64_tr_b16 v[24:25], v168 offset:0
 ds_read_b64_tr_b16 v[26:27], v168 offset:2048
 ds_read_b128 v[56:59], v172 offset:2048
 ds_read_b64_tr_b16 v[28:29], v170 offset:0
 ds_read_b64_tr_b16 v[30:31], v170 offset:2048
 ds_read_b128 v[60:63], v172 offset:3072
 ds_read_b64_tr_b16 v[32:33], v164 offset:1024
 ds_read_b64_tr_b16 v[34:35], v164 offset:3072
 ds_read_b128 v[64:67], v172 offset:4096
 ds_read_b64_tr_b16 v[36:37], v166 offset:1024
 ds_read_b64_tr_b16 v[38:39], v166 offset:3072
 ds_read_b128 v[68:71], v172 offset:5120
 ds_read_b64_tr_b16 v[40:41], v168 offset:1024
 ds_read_b64_tr_b16 v[42:43], v168 offset:3072
 ds_read_b128 v[72:75], v172 offset:6144
 ds_read_b64_tr_b16 v[44:45], v170 offset:1024
 ds_read_b64_tr_b16 v[46:47], v170 offset:3072
 ds_read_b128 v[76:79], v172 offset:7168
 s_waitcnt lgkmcnt(0)
 v_mfma_f32_16x16x32_bf16 a[0:3], v[16:19], v[48:51], 0
 s_add_u32 m0, s44, 65536
 v_mfma_f32_16x16x32_bf16 a[4:7], v[16:19], v[52:55], 0
 buffer_load_dwordx4 v174, s[24:27], s40 offen offset:0 lds
 v_mfma_f32_16x16x32_bf16 a[8:11], v[16:19], v[56:59], 0
 v_mfma_f32_16x16x32_bf16 a[12:15], v[16:19], v[60:63], 0
 buffer_load_dwordx4 v175, s[24:27], s40 offen offset:1024 lds
 v_mfma_f32_16x16x32_bf16 a[16:19], v[16:19], v[64:67], 0
 buffer_load_dwordx4 v176, s[24:27], s40 offen offset:2048 lds
 v_mfma_f32_16x16x32_bf16 a[20:23], v[16:19], v[68:71], 0
 v_mfma_f32_16x16x32_bf16 v[192:195], v[16:19], v[72:75], 0
 buffer_load_dwordx4 v177, s[24:27], s40 offen offset:3072 lds
 s_add_u32 s40, s40, 16384
 v_mfma_f32_16x16x32_bf16 v[196:199], v[16:19], v[76:79], 0
 v_mfma_f32_16x16x32_bf16 v[204:207], v[20:23], v[76:79], 0
 s_add_u32 m0, s45, 65536
 v_mfma_f32_16x16x32_bf16 v[200:203], v[20:23], v[72:75], 0
 buffer_load_dwordx4 v178, s[28:31], s41 offen offset:0 lds
 v_mfma_f32_16x16x32_bf16 a[52:55], v[20:23], v[68:71], 0
 v_mfma_f32_16x16x32_bf16 a[48:51], v[20:23], v[64:67], 0
 buffer_load_dwordx4 v179, s[32:35], s41 offen offset:1024 lds
 v_mfma_f32_16x16x32_bf16 a[44:47], v[20:23], v[60:63], 0
 buffer_load_dwordx4 v180, s[28:31], s41 offen offset:2048 lds
 v_mfma_f32_16x16x32_bf16 a[40:43], v[20:23], v[56:59], 0
 v_mfma_f32_16x16x32_bf16 a[36:39], v[20:23], v[52:55], 0
 buffer_load_dwordx4 v181, s[32:35], s41 offen offset:3072 lds
 s_add_u32 s41, s41, s43
 v_mfma_f32_16x16x32_bf16 a[32:35], v[20:23], v[48:51], 0
 s_waitcnt vmcnt(8)
 s_barrier
 v_mfma_f32_16x16x32_bf16 a[64:67], v[24:27], v[48:51], 0
 ds_read_b64_tr_b16 v[80:81], v164 offset:32768
 v_mfma_f32_16x16x32_bf16 a[68:71], v[24:27], v[52:55], 0
 ds_read_b64_tr_b16 v[82:83], v164 offset:34816
 s_add_u32 m0, s44, 98304
 v_mfma_f32_16x16x32_bf16 a[72:75], v[24:27], v[56:59], 0
 v_mfma_f32_16x16x32_bf16 a[76:79], v[24:27], v[60:63], 0
 ds_read_b128 v[112:115], v172 offset:32768
 buffer_load_dwordx4 v174, s[24:27], s40 offen offset:0 lds
 v_mfma_f32_16x16x32_bf16 a[80:83], v[24:27], v[64:67], 0
 ds_read_b64_tr_b16 v[84:85], v166 offset:32768
 v_mfma_f32_16x16x32_bf16 a[84:87], v[24:27], v[68:71], 0
 buffer_load_dwordx4 v175, s[24:27], s40 offen offset:1024 lds
 v_mfma_f32_16x16x32_bf16 v[208:211], v[24:27], v[72:75], 0
 ds_read_b64_tr_b16 v[86:87], v166 offset:34816
 v_mfma_f32_16x16x32_bf16 v[212:215], v[24:27], v[76:79], 0
 ds_read_b128 v[116:119], v172 offset:33792
 buffer_load_dwordx4 v176, s[24:27], s40 offen offset:2048 lds
 v_mfma_f32_16x16x32_bf16 v[220:223], v[28:31], v[76:79], 0
 v_mfma_f32_16x16x32_bf16 v[216:219], v[28:31], v[72:75], 0
 ds_read_b64_tr_b16 v[88:89], v168 offset:32768
 v_mfma_f32_16x16x32_bf16 a[116:119], v[28:31], v[68:71], 0
 buffer_load_dwordx4 v177, s[24:27], s40 offen offset:3072 lds
 s_add_u32 s40, s40, 16384
 v_mfma_f32_16x16x32_bf16 a[112:115], v[28:31], v[64:67], 0
 ds_read_b64_tr_b16 v[90:91], v168 offset:34816
 v_mfma_f32_16x16x32_bf16 a[108:111], v[28:31], v[60:63], 0
 ds_read_b128 v[120:123], v172 offset:34816
 s_add_u32 m0, s45, 98304
 v_mfma_f32_16x16x32_bf16 a[104:107], v[28:31], v[56:59], 0
 v_mfma_f32_16x16x32_bf16 a[100:103], v[28:31], v[52:55], 0
 ds_read_b64_tr_b16 v[92:93], v170 offset:32768
 buffer_load_dwordx4 v178, s[28:31], s41 offen offset:0 lds
 v_mfma_f32_16x16x32_bf16 a[96:99], v[28:31], v[48:51], 0
 ds_read_b64_tr_b16 v[94:95], v170 offset:34816
 v_mfma_f32_16x16x32_bf16 a[128:131], v[32:35], v[48:51], 0
 v_mfma_f32_16x16x32_bf16 a[132:135], v[32:35], v[52:55], 0
 ds_read_b128 v[124:127], v172 offset:35840
 buffer_load_dwordx4 v179, s[32:35], s41 offen offset:1024 lds
 v_mfma_f32_16x16x32_bf16 a[136:139], v[32:35], v[56:59], 0
 v_mfma_f32_16x16x32_bf16 a[140:143], v[32:35], v[60:63], 0
 ds_read_b64_tr_b16 v[96:97], v164 offset:33792
 buffer_load_dwordx4 v180, s[28:31], s41 offen offset:2048 lds
 v_mfma_f32_16x16x32_bf16 a[144:147], v[32:35], v[64:67], 0
 ds_read_b64_tr_b16 v[98:99], v164 offset:35840
 v_mfma_f32_16x16x32_bf16 a[148:151], v[32:35], v[68:71], 0
 buffer_load_dwordx4 v181, s[32:35], s41 offen offset:3072 lds
 s_add_u32 s41, s41, s43
 v_mfma_f32_16x16x32_bf16 v[224:227], v[32:35], v[72:75], 0
 ds_read_b128 v[128:131], v172 offset:36864
 v_mfma_f32_16x16x32_bf16 v[228:231], v[32:35], v[76:79], 0
 ds_read_b64_tr_b16 v[100:101], v166 offset:33792
 v_mfma_f32_16x16x32_bf16 v[236:239], v[36:39], v[76:79], 0
 s_add_u32 m0, s44, 0
 v_mfma_f32_16x16x32_bf16 v[232:235], v[36:39], v[72:75], 0
 ds_read_b64_tr_b16 v[102:103], v166 offset:35840
 v_mfma_f32_16x16x32_bf16 a[180:183], v[36:39], v[68:71], 0
 ds_read_b128 v[132:135], v172 offset:37888
 buffer_load_dwordx4 v174, s[24:27], s40 offen offset:0 lds
 v_mfma_f32_16x16x32_bf16 a[176:179], v[36:39], v[64:67], 0
 v_mfma_f32_16x16x32_bf16 a[172:175], v[36:39], v[60:63], 0
 ds_read_b64_tr_b16 v[104:105], v168 offset:33792
 buffer_load_dwordx4 v175, s[24:27], s40 offen offset:1024 lds
 v_mfma_f32_16x16x32_bf16 a[168:171], v[36:39], v[56:59], 0
 v_mfma_f32_16x16x32_bf16 a[164:167], v[36:39], v[52:55], 0
 ds_read_b64_tr_b16 v[106:107], v168 offset:35840
 buffer_load_dwordx4 v176, s[24:27], s40 offen offset:2048 lds
 v_mfma_f32_16x16x32_bf16 a[160:163], v[36:39], v[48:51], 0
 ds_read_b128 v[136:139], v172 offset:38912
 v_mfma_f32_16x16x32_bf16 a[192:195], v[40:43], v[48:51], 0
 v_mfma_f32_16x16x32_bf16 a[196:199], v[40:43], v[52:55], 0
 ds_read_b64_tr_b16 v[108:109], v170 offset:33792
 buffer_load_dwordx4 v177, s[24:27], s40 offen offset:3072 lds
 s_add_u32 s40, s40, 16384
 v_mfma_f32_16x16x32_bf16 a[200:203], v[40:43], v[56:59], 0
 ds_read_b64_tr_b16 v[110:111], v170 offset:35840
 v_mfma_f32_16x16x32_bf16 a[204:207], v[40:43], v[60:63], 0
 s_add_u32 m0, s45, 0
 v_mfma_f32_16x16x32_bf16 a[208:211], v[40:43], v[64:67], 0
 ds_read_b128 v[140:143], v172 offset:39936
 v_mfma_f32_16x16x32_bf16 a[212:215], v[40:43], v[68:71], 0
 buffer_load_dwordx4 v178, s[28:31], s41 offen offset:0 lds
 v_mfma_f32_16x16x32_bf16 v[240:243], v[40:43], v[72:75], 0
 v_mfma_f32_16x16x32_bf16 v[244:247], v[40:43], v[76:79], 0
 v_mfma_f32_16x16x32_bf16 v[252:255], v[44:47], v[76:79], 0
 buffer_load_dwordx4 v179, s[32:35], s41 offen offset:1024 lds
 v_mfma_f32_16x16x32_bf16 v[248:251], v[44:47], v[72:75], 0
 v_mfma_f32_16x16x32_bf16 a[244:247], v[44:47], v[68:71], 0
 buffer_load_dwordx4 v180, s[28:31], s41 offen offset:2048 lds
 v_mfma_f32_16x16x32_bf16 a[240:243], v[44:47], v[64:67], 0
 v_mfma_f32_16x16x32_bf16 a[236:239], v[44:47], v[60:63], 0
 buffer_load_dwordx4 v181, s[32:35], s41 offen offset:3072 lds
 s_add_u32 s41, s41, s43
 v_mfma_f32_16x16x32_bf16 a[232:235], v[44:47], v[56:59], 0
 v_mfma_f32_16x16x32_bf16 a[228:231], v[44:47], v[52:55], 0
 v_mfma_f32_16x16x32_bf16 a[224:227], v[44:47], v[48:51], 0
.p2align 6
L_gemm1_kernel_lnk:
 s_waitcnt vmcnt(16) lgkmcnt(0)
 s_barrier
 v_mfma_f32_16x16x32_bf16 a[0:3], v[80:83], v[112:115], a[0:3]
 ds_read_b64_tr_b16 v[16:17], v165 offset:0
 v_mfma_f32_16x16x32_bf16 a[4:7], v[80:83], v[116:119], a[4:7]
 ds_read_b64_tr_b16 v[18:19], v165 offset:2048
 s_add_u32 m0, s44, 32768
 v_mfma_f32_16x16x32_bf16 a[8:11], v[80:83], v[120:123], a[8:11]
 v_mfma_f32_16x16x32_bf16 a[12:15], v[80:83], v[124:127], a[12:15]
 ds_read_b128 v[48:51], v173 offset:0
 v_mfma_f32_16x16x32_bf16 a[16:19], v[80:83], v[128:131], a[16:19]
 v_mfma_f32_16x16x32_bf16 a[20:23], v[80:83], v[132:135], a[20:23]
 ds_read_b64_tr_b16 v[20:21], v167 offset:0
 v_mfma_f32_16x16x32_bf16 v[192:195], v[80:83], v[136:139], v[192:195]
 v_mfma_f32_16x16x32_bf16 v[196:199], v[80:83], v[140:143], v[196:199]
 ds_read_b64_tr_b16 v[22:23], v167 offset:2048
 buffer_load_dwordx4 v174, s[24:27], s40 offen offset:0 lds
 v_mfma_f32_16x16x32_bf16 v[204:207], v[84:87], v[140:143], v[204:207]
 v_mfma_f32_16x16x32_bf16 v[200:203], v[84:87], v[136:139], v[200:203]
 ds_read_b128 v[52:55], v173 offset:1024
 v_mfma_f32_16x16x32_bf16 a[52:55], v[84:87], v[132:135], a[52:55]
 v_mfma_f32_16x16x32_bf16 a[48:51], v[84:87], v[128:131], a[48:51]
 ds_read_b64_tr_b16 v[24:25], v169 offset:0
 v_mfma_f32_16x16x32_bf16 a[44:47], v[84:87], v[124:127], a[44:47]
 ds_read_b64_tr_b16 v[26:27], v169 offset:2048
 v_mfma_f32_16x16x32_bf16 a[40:43], v[84:87], v[120:123], a[40:43]
 buffer_load_dwordx4 v175, s[24:27], s40 offen offset:1024 lds
 v_mfma_f32_16x16x32_bf16 a[36:39], v[84:87], v[116:119], a[36:39]
 ds_read_b128 v[56:59], v173 offset:2048
 v_mfma_f32_16x16x32_bf16 a[32:35], v[84:87], v[112:115], a[32:35]
 v_mfma_f32_16x16x32_bf16 a[64:67], v[88:91], v[112:115], a[64:67]
 ds_read_b64_tr_b16 v[28:29], v171 offset:0
 v_mfma_f32_16x16x32_bf16 a[68:71], v[88:91], v[116:119], a[68:71]
 v_mfma_f32_16x16x32_bf16 a[72:75], v[88:91], v[120:123], a[72:75]
 ds_read_b64_tr_b16 v[30:31], v171 offset:2048
 v_mfma_f32_16x16x32_bf16 a[76:79], v[88:91], v[124:127], a[76:79]
 buffer_load_dwordx4 v176, s[24:27], s40 offen offset:2048 lds
 v_mfma_f32_16x16x32_bf16 a[80:83], v[88:91], v[128:131], a[80:83]
 ds_read_b128 v[60:63], v173 offset:3072
 v_mfma_f32_16x16x32_bf16 a[84:87], v[88:91], v[132:135], a[84:87]
 v_mfma_f32_16x16x32_bf16 v[208:211], v[88:91], v[136:139], v[208:211]
 ds_read_b64_tr_b16 v[32:33], v165 offset:1024
 v_mfma_f32_16x16x32_bf16 v[212:215], v[88:91], v[140:143], v[212:215]
 ds_read_b64_tr_b16 v[34:35], v165 offset:3072
 v_mfma_f32_16x16x32_bf16 v[220:223], v[92:95], v[140:143], v[220:223]
 v_mfma_f32_16x16x32_bf16 v[216:219], v[92:95], v[136:139], v[216:219]
 ds_read_b128 v[64:67], v173 offset:4096
 buffer_load_dwordx4 v177, s[24:27], s40 offen offset:3072 lds
 s_add_u32 s40, s40, 16384
 v_mfma_f32_16x16x32_bf16 a[116:119], v[92:95], v[132:135], a[116:119]
 v_mfma_f32_16x16x32_bf16 a[112:115], v[92:95], v[128:131], a[112:115]
 ds_read_b64_tr_b16 v[36:37], v167 offset:1024
 v_mfma_f32_16x16x32_bf16 a[108:111], v[92:95], v[124:127], a[108:111]
 v_mfma_f32_16x16x32_bf16 a[104:107], v[92:95], v[120:123], a[104:107]
 ds_read_b64_tr_b16 v[38:39], v167 offset:3072
 v_mfma_f32_16x16x32_bf16 a[100:103], v[92:95], v[116:119], a[100:103]
 v_mfma_f32_16x16x32_bf16 a[96:99], v[92:95], v[112:115], a[96:99]
 ds_read_b128 v[68:71], v173 offset:5120
 v_mfma_f32_16x16x32_bf16 a[128:131], v[96:99], v[112:115], a[128:131]
 s_add_u32 m0, s45, 32768
 v_mfma_f32_16x16x32_bf16 a[132:135], v[96:99], v[116:119], a[132:135]
 ds_read_b64_tr_b16 v[40:41], v169 offset:1024
 v_mfma_f32_16x16x32_bf16 a[136:139], v[96:99], v[120:123], a[136:139]
 ds_read_b64_tr_b16 v[42:43], v169 offset:3072
 v_mfma_f32_16x16x32_bf16 a[140:143], v[96:99], v[124:127], a[140:143]
 v_mfma_f32_16x16x32_bf16 a[144:147], v[96:99], v[128:131], a[144:147]
 ds_read_b128 v[72:75], v173 offset:6144
 v_mfma_f32_16x16x32_bf16 a[148:151], v[96:99], v[132:135], a[148:151]
 v_mfma_f32_16x16x32_bf16 v[224:227], v[96:99], v[136:139], v[224:227]
 ds_read_b64_tr_b16 v[44:45], v171 offset:1024
 buffer_load_dwordx4 v178, s[28:31], s41 offen offset:0 lds
 v_mfma_f32_16x16x32_bf16 v[228:231], v[96:99], v[140:143], v[228:231]
 v_mfma_f32_16x16x32_bf16 v[236:239], v[100:103], v[140:143], v[236:239]
 ds_read_b64_tr_b16 v[46:47], v171 offset:3072
 v_mfma_f32_16x16x32_bf16 v[232:235], v[100:103], v[136:139], v[232:235]
 v_mfma_f32_16x16x32_bf16 a[180:183], v[100:103], v[132:135], a[180:183]
 ds_read_b128 v[76:79], v173 offset:7168
 v_mfma_f32_16x16x32_bf16 a[176:179], v[100:103], v[128:131], a[176:179]
 v_mfma_f32_16x16x32_bf16 a[172:175], v[100:103], v[124:127], a[172:175]
 buffer_load_dwordx4 v179, s[32:35], s41 offen offset:1024 lds
 v_mfma_f32_16x16x32_bf16 a[168:171], v[100:103], v[120:123], a[168:171]
 v_mfma_f32_16x16x32_bf16 a[164:167], v[100:103], v[116:119], a[164:167]
 v_mfma_f32_16x16x32_bf16 a[160:163], v[100:103], v[112:115], a[160:163]
 v_mfma_f32_16x16x32_bf16 a[192:195], v[104:107], v[112:115], a[192:195]
 v_mfma_f32_16x16x32_bf16 a[196:199], v[104:107], v[116:119], a[196:199]
 v_mfma_f32_16x16x32_bf16 a[200:203], v[104:107], v[120:123], a[200:203]
 buffer_load_dwordx4 v180, s[28:31], s41 offen offset:2048 lds
 v_mfma_f32_16x16x32_bf16 a[204:207], v[104:107], v[124:127], a[204:207]
 v_mfma_f32_16x16x32_bf16 a[208:211], v[104:107], v[128:131], a[208:211]
 v_mfma_f32_16x16x32_bf16 a[212:215], v[104:107], v[132:135], a[212:215]
 v_mfma_f32_16x16x32_bf16 v[240:243], v[104:107], v[136:139], v[240:243]
 v_mfma_f32_16x16x32_bf16 v[244:247], v[104:107], v[140:143], v[244:247]
 v_mfma_f32_16x16x32_bf16 v[252:255], v[108:111], v[140:143], v[252:255]
 buffer_load_dwordx4 v181, s[32:35], s41 offen offset:3072 lds
 s_add_u32 s41, s41, s43
 v_mfma_f32_16x16x32_bf16 v[248:251], v[108:111], v[136:139], v[248:251]
 v_mfma_f32_16x16x32_bf16 a[244:247], v[108:111], v[132:135], a[244:247]
 v_mfma_f32_16x16x32_bf16 a[240:243], v[108:111], v[128:131], a[240:243]
 v_mfma_f32_16x16x32_bf16 a[236:239], v[108:111], v[124:127], a[236:239]
 v_mfma_f32_16x16x32_bf16 a[232:235], v[108:111], v[120:123], a[232:235]
 v_mfma_f32_16x16x32_bf16 a[228:231], v[108:111], v[116:119], a[228:231]
 v_mfma_f32_16x16x32_bf16 a[224:227], v[108:111], v[112:115], a[224:227]
 s_waitcnt vmcnt(16) lgkmcnt(0)
 s_barrier
 v_mfma_f32_16x16x32_bf16 a[0:3], v[16:19], v[48:51], a[0:3]
 ds_read_b64_tr_b16 v[80:81], v165 offset:32768
 v_mfma_f32_16x16x32_bf16 a[4:7], v[16:19], v[52:55], a[4:7]
 ds_read_b64_tr_b16 v[82:83], v165 offset:34816
 s_add_u32 m0, s44, 65536
 v_mfma_f32_16x16x32_bf16 a[8:11], v[16:19], v[56:59], a[8:11]
 v_mfma_f32_16x16x32_bf16 a[12:15], v[16:19], v[60:63], a[12:15]
 ds_read_b128 v[112:115], v173 offset:32768
 v_mfma_f32_16x16x32_bf16 a[16:19], v[16:19], v[64:67], a[16:19]
 v_mfma_f32_16x16x32_bf16 a[20:23], v[16:19], v[68:71], a[20:23]
 ds_read_b64_tr_b16 v[84:85], v167 offset:32768
 v_mfma_f32_16x16x32_bf16 v[192:195], v[16:19], v[72:75], v[192:195]
 v_mfma_f32_16x16x32_bf16 v[196:199], v[16:19], v[76:79], v[196:199]
 ds_read_b64_tr_b16 v[86:87], v167 offset:34816
 buffer_load_dwordx4 v174, s[24:27], s40 offen offset:0 lds
 v_mfma_f32_16x16x32_bf16 v[204:207], v[20:23], v[76:79], v[204:207]
 v_mfma_f32_16x16x32_bf16 v[200:203], v[20:23], v[72:75], v[200:203]
 ds_read_b128 v[116:119], v173 offset:33792
 v_mfma_f32_16x16x32_bf16 a[52:55], v[20:23], v[68:71], a[52:55]
 v_mfma_f32_16x16x32_bf16 a[48:51], v[20:23], v[64:67], a[48:51]
 ds_read_b64_tr_b16 v[88:89], v169 offset:32768
 v_mfma_f32_16x16x32_bf16 a[44:47], v[20:23], v[60:63], a[44:47]
 ds_read_b64_tr_b16 v[90:91], v169 offset:34816
 v_mfma_f32_16x16x32_bf16 a[40:43], v[20:23], v[56:59], a[40:43]
 buffer_load_dwordx4 v175, s[24:27], s40 offen offset:1024 lds
 v_mfma_f32_16x16x32_bf16 a[36:39], v[20:23], v[52:55], a[36:39]
 ds_read_b128 v[120:123], v173 offset:34816
 v_mfma_f32_16x16x32_bf16 a[32:35], v[20:23], v[48:51], a[32:35]
 v_mfma_f32_16x16x32_bf16 a[64:67], v[24:27], v[48:51], a[64:67]
 ds_read_b64_tr_b16 v[92:93], v171 offset:32768
 v_mfma_f32_16x16x32_bf16 a[68:71], v[24:27], v[52:55], a[68:71]
 v_mfma_f32_16x16x32_bf16 a[72:75], v[24:27], v[56:59], a[72:75]
 ds_read_b64_tr_b16 v[94:95], v171 offset:34816
 v_mfma_f32_16x16x32_bf16 a[76:79], v[24:27], v[60:63], a[76:79]
 buffer_load_dwordx4 v176, s[24:27], s40 offen offset:2048 lds
 v_mfma_f32_16x16x32_bf16 a[80:83], v[24:27], v[64:67], a[80:83]
 ds_read_b128 v[124:127], v173 offset:35840
 v_mfma_f32_16x16x32_bf16 a[84:87], v[24:27], v[68:71], a[84:87]
 v_mfma_f32_16x16x32_bf16 v[208:211], v[24:27], v[72:75], v[208:211]
 ds_read_b64_tr_b16 v[96:97], v165 offset:33792
 v_mfma_f32_16x16x32_bf16 v[212:215], v[24:27], v[76:79], v[212:215]
 ds_read_b64_tr_b16 v[98:99], v165 offset:35840
 v_mfma_f32_16x16x32_bf16 v[220:223], v[28:31], v[76:79], v[220:223]
 v_mfma_f32_16x16x32_bf16 v[216:219], v[28:31], v[72:75], v[216:219]
 ds_read_b128 v[128:131], v173 offset:36864
 buffer_load_dwordx4 v177, s[24:27], s40 offen offset:3072 lds
 s_add_u32 s40, s40, 16384
 v_mfma_f32_16x16x32_bf16 a[116:119], v[28:31], v[68:71], a[116:119]
 v_mfma_f32_16x16x32_bf16 a[112:115], v[28:31], v[64:67], a[112:115]
 ds_read_b64_tr_b16 v[100:101], v167 offset:33792
 v_mfma_f32_16x16x32_bf16 a[108:111], v[28:31], v[60:63], a[108:111]
 v_mfma_f32_16x16x32_bf16 a[104:107], v[28:31], v[56:59], a[104:107]
 ds_read_b64_tr_b16 v[102:103], v167 offset:35840
 v_mfma_f32_16x16x32_bf16 a[100:103], v[28:31], v[52:55], a[100:103]
 v_mfma_f32_16x16x32_bf16 a[96:99], v[28:31], v[48:51], a[96:99]
 ds_read_b128 v[132:135], v173 offset:37888
 v_mfma_f32_16x16x32_bf16 a[128:131], v[32:35], v[48:51], a[128:131]
 s_add_u32 m0, s45, 65536
 v_mfma_f32_16x16x32_bf16 a[132:135], v[32:35], v[52:55], a[132:135]
 ds_read_b64_tr_b16 v[104:105], v169 offset:33792
 v_mfma_f32_16x16x32_bf16 a[136:139], v[32:35], v[56:59], a[136:139]
 ds_read_b64_tr_b16 v[106:107], v169 offset:35840
 v_mfma_f32_16x16x32_bf16 a[140:143], v[32:35], v[60:63], a[140:143]
 v_mfma_f32_16x16x32_bf16 a[144:147], v[32:35], v[64:67], a[144:147]
 ds_read_b128 v[136:139], v173 offset:38912
 v_mfma_f32_16x16x32_bf16 a[148:151], v[32:35], v[68:71], a[148:151]
 v_mfma_f32_16x16x32_bf16 v[224:227], v[32:35], v[72:75], v[224:227]
 ds_read_b64_tr_b16 v[108:109], v171 offset:33792
 buffer_load_dwordx4 v178, s[28:31], s41 offen offset:0 lds
 v_mfma_f32_16x16x32_bf16 v[228:231], v[32:35], v[76:79], v[228:231]
 v_mfma_f32_16x16x32_bf16 v[236:239], v[36:39], v[76:79], v[236:239]
 ds_read_b64_tr_b16 v[110:111], v171 offset:35840
 v_mfma_f32_16x16x32_bf16 v[232:235], v[36:39], v[72:75], v[232:235]
 v_mfma_f32_16x16x32_bf16 a[180:183], v[36:39], v[68:71], a[180:183]
 ds_read_b128 v[140:143], v173 offset:39936
 v_mfma_f32_16x16x32_bf16 a[176:179], v[36:39], v[64:67], a[176:179]
 v_mfma_f32_16x16x32_bf16 a[172:175], v[36:39], v[60:63], a[172:175]
 buffer_load_dwordx4 v179, s[32:35], s41 offen offset:1024 lds
 v_mfma_f32_16x16x32_bf16 a[168:171], v[36:39], v[56:59], a[168:171]
 v_mfma_f32_16x16x32_bf16 a[164:167], v[36:39], v[52:55], a[164:167]
 v_mfma_f32_16x16x32_bf16 a[160:163], v[36:39], v[48:51], a[160:163]
 v_mfma_f32_16x16x32_bf16 a[192:195], v[40:43], v[48:51], a[192:195]
 v_mfma_f32_16x16x32_bf16 a[196:199], v[40:43], v[52:55], a[196:199]
 v_mfma_f32_16x16x32_bf16 a[200:203], v[40:43], v[56:59], a[200:203]
 buffer_load_dwordx4 v180, s[28:31], s41 offen offset:2048 lds
 v_mfma_f32_16x16x32_bf16 a[204:207], v[40:43], v[60:63], a[204:207]
 v_mfma_f32_16x16x32_bf16 a[208:211], v[40:43], v[64:67], a[208:211]
 v_mfma_f32_16x16x32_bf16 a[212:215], v[40:43], v[68:71], a[212:215]
 v_mfma_f32_16x16x32_bf16 v[240:243], v[40:43], v[72:75], v[240:243]
 v_mfma_f32_16x16x32_bf16 v[244:247], v[40:43], v[76:79], v[244:247]
 v_mfma_f32_16x16x32_bf16 v[252:255], v[44:47], v[76:79], v[252:255]
 buffer_load_dwordx4 v181, s[32:35], s41 offen offset:3072 lds
 s_add_u32 s41, s41, s43
 v_mfma_f32_16x16x32_bf16 v[248:251], v[44:47], v[72:75], v[248:251]
 v_mfma_f32_16x16x32_bf16 a[244:247], v[44:47], v[68:71], a[244:247]
 v_mfma_f32_16x16x32_bf16 a[240:243], v[44:47], v[64:67], a[240:243]
 v_mfma_f32_16x16x32_bf16 a[236:239], v[44:47], v[60:63], a[236:239]
 v_mfma_f32_16x16x32_bf16 a[232:235], v[44:47], v[56:59], a[232:235]
 v_mfma_f32_16x16x32_bf16 a[228:231], v[44:47], v[52:55], a[228:231]
 v_mfma_f32_16x16x32_bf16 a[224:227], v[44:47], v[48:51], a[224:227]
 s_waitcnt vmcnt(16) lgkmcnt(0)
 s_barrier
 v_mfma_f32_16x16x32_bf16 a[0:3], v[80:83], v[112:115], a[0:3]
 ds_read_b64_tr_b16 v[16:17], v164 offset:0
 v_mfma_f32_16x16x32_bf16 a[4:7], v[80:83], v[116:119], a[4:7]
 ds_read_b64_tr_b16 v[18:19], v164 offset:2048
 s_add_u32 m0, s44, 98304
 v_mfma_f32_16x16x32_bf16 a[8:11], v[80:83], v[120:123], a[8:11]
 v_mfma_f32_16x16x32_bf16 a[12:15], v[80:83], v[124:127], a[12:15]
 ds_read_b128 v[48:51], v172 offset:0
 v_mfma_f32_16x16x32_bf16 a[16:19], v[80:83], v[128:131], a[16:19]
 v_mfma_f32_16x16x32_bf16 a[20:23], v[80:83], v[132:135], a[20:23]
 ds_read_b64_tr_b16 v[20:21], v166 offset:0
 v_mfma_f32_16x16x32_bf16 v[192:195], v[80:83], v[136:139], v[192:195]
 v_mfma_f32_16x16x32_bf16 v[196:199], v[80:83], v[140:143], v[196:199]
 ds_read_b64_tr_b16 v[22:23], v166 offset:2048
 buffer_load_dwordx4 v174, s[24:27], s40 offen offset:0 lds
 v_mfma_f32_16x16x32_bf16 v[204:207], v[84:87], v[140:143], v[204:207]
 v_mfma_f32_16x16x32_bf16 v[200:203], v[84:87], v[136:139], v[200:203]
 ds_read_b128 v[52:55], v172 offset:1024
 v_mfma_f32_16x16x32_bf16 a[52:55], v[84:87], v[132:135], a[52:55]
 v_mfma_f32_16x16x32_bf16 a[48:51], v[84:87], v[128:131], a[48:51]
 ds_read_b64_tr_b16 v[24:25], v168 offset:0
 v_mfma_f32_16x16x32_bf16 a[44:47], v[84:87], v[124:127], a[44:47]
 ds_read_b64_tr_b16 v[26:27], v168 offset:2048
 v_mfma_f32_16x16x32_bf16 a[40:43], v[84:87], v[120:123], a[40:43]
 buffer_load_dwordx4 v175, s[24:27], s40 offen offset:1024 lds
 v_mfma_f32_16x16x32_bf16 a[36:39], v[84:87], v[116:119], a[36:39]
 ds_read_b128 v[56:59], v172 offset:2048
 v_mfma_f32_16x16x32_bf16 a[32:35], v[84:87], v[112:115], a[32:35]
 v_mfma_f32_16x16x32_bf16 a[64:67], v[88:91], v[112:115], a[64:67]
 ds_read_b64_tr_b16 v[28:29], v170 offset:0
 v_mfma_f32_16x16x32_bf16 a[68:71], v[88:91], v[116:119], a[68:71]
 v_mfma_f32_16x16x32_bf16 a[72:75], v[88:91], v[120:123], a[72:75]
 ds_read_b64_tr_b16 v[30:31], v170 offset:2048
 v_mfma_f32_16x16x32_bf16 a[76:79], v[88:91], v[124:127], a[76:79]
 buffer_load_dwordx4 v176, s[24:27], s40 offen offset:2048 lds
 v_mfma_f32_16x16x32_bf16 a[80:83], v[88:91], v[128:131], a[80:83]
 ds_read_b128 v[60:63], v172 offset:3072
 v_mfma_f32_16x16x32_bf16 a[84:87], v[88:91], v[132:135], a[84:87]
 v_mfma_f32_16x16x32_bf16 v[208:211], v[88:91], v[136:139], v[208:211]
 ds_read_b64_tr_b16 v[32:33], v164 offset:1024
 v_mfma_f32_16x16x32_bf16 v[212:215], v[88:91], v[140:143], v[212:215]
 ds_read_b64_tr_b16 v[34:35], v164 offset:3072
 v_mfma_f32_16x16x32_bf16 v[220:223], v[92:95], v[140:143], v[220:223]
 v_mfma_f32_16x16x32_bf16 v[216:219], v[92:95], v[136:139], v[216:219]
 ds_read_b128 v[64:67], v172 offset:4096
 buffer_load_dwordx4 v177, s[24:27], s40 offen offset:3072 lds
 s_add_u32 s40, s40, 16384
 v_mfma_f32_16x16x32_bf16 a[116:119], v[92:95], v[132:135], a[116:119]
 v_mfma_f32_16x16x32_bf16 a[112:115], v[92:95], v[128:131], a[112:115]
 ds_read_b64_tr_b16 v[36:37], v166 offset:1024
 v_mfma_f32_16x16x32_bf16 a[108:111], v[92:95], v[124:127], a[108:111]
 v_mfma_f32_16x16x32_bf16 a[104:107], v[92:95], v[120:123], a[104:107]
 ds_read_b64_tr_b16 v[38:39], v166 offset:3072
 v_mfma_f32_16x16x32_bf16 a[100:103], v[92:95], v[116:119], a[100:103]
 v_mfma_f32_16x16x32_bf16 a[96:99], v[92:95], v[112:115], a[96:99]
 ds_read_b128 v[68:71], v172 offset:5120
 v_mfma_f32_16x16x32_bf16 a[128:131], v[96:99], v[112:115], a[128:131]
 s_add_u32 m0, s45, 98304
 v_mfma_f32_16x16x32_bf16 a[132:135], v[96:99], v[116:119], a[132:135]
 ds_read_b64_tr_b16 v[40:41], v168 offset:1024
 v_mfma_f32_16x16x32_bf16 a[136:139], v[96:99], v[120:123], a[136:139]
 ds_read_b64_tr_b16 v[42:43], v168 offset:3072
 v_mfma_f32_16x16x32_bf16 a[140:143], v[96:99], v[124:127], a[140:143]
 v_mfma_f32_16x16x32_bf16 a[144:147], v[96:99], v[128:131], a[144:147]
 ds_read_b128 v[72:75], v172 offset:6144
 v_mfma_f32_16x16x32_bf16 a[148:151], v[96:99], v[132:135], a[148:151]
 v_mfma_f32_16x16x32_bf16 v[224:227], v[96:99], v[136:139], v[224:227]
 ds_read_b64_tr_b16 v[44:45], v170 offset:1024
 buffer_load_dwordx4 v178, s[28:31], s41 offen offset:0 lds
 v_mfma_f32_16x16x32_bf16 v[228:231], v[96:99], v[140:143], v[228:231]
 v_mfma_f32_16x16x32_bf16 v[236:239], v[100:103], v[140:143], v[236:239]
 ds_read_b64_tr_b16 v[46:47], v170 offset:3072
 v_mfma_f32_16x16x32_bf16 v[232:235], v[100:103], v[136:139], v[232:235]
 v_mfma_f32_16x16x32_bf16 a[180:183], v[100:103], v[132:135], a[180:183]
 ds_read_b128 v[76:79], v172 offset:7168
 v_mfma_f32_16x16x32_bf16 a[176:179], v[100:103], v[128:131], a[176:179]
 v_mfma_f32_16x16x32_bf16 a[172:175], v[100:103], v[124:127], a[172:175]
 buffer_load_dwordx4 v179, s[32:35], s41 offen offset:1024 lds
 v_mfma_f32_16x16x32_bf16 a[168:171], v[100:103], v[120:123], a[168:171]
 v_mfma_f32_16x16x32_bf16 a[164:167], v[100:103], v[116:119], a[164:167]
 v_mfma_f32_16x16x32_bf16 a[160:163], v[100:103], v[112:115], a[160:163]
 v_mfma_f32_16x16x32_bf16 a[192:195], v[104:107], v[112:115], a[192:195]
 v_mfma_f32_16x16x32_bf16 a[196:199], v[104:107], v[116:119], a[196:199]
 v_mfma_f32_16x16x32_bf16 a[200:203], v[104:107], v[120:123], a[200:203]
 buffer_load_dwordx4 v180, s[28:31], s41 offen offset:2048 lds
 v_mfma_f32_16x16x32_bf16 a[204:207], v[104:107], v[124:127], a[204:207]
 v_mfma_f32_16x16x32_bf16 a[208:211], v[104:107], v[128:131], a[208:211]
 v_mfma_f32_16x16x32_bf16 a[212:215], v[104:107], v[132:135], a[212:215]
 v_mfma_f32_16x16x32_bf16 v[240:243], v[104:107], v[136:139], v[240:243]
 v_mfma_f32_16x16x32_bf16 v[244:247], v[104:107], v[140:143], v[244:247]
 v_mfma_f32_16x16x32_bf16 v[252:255], v[108:111], v[140:143], v[252:255]
 buffer_load_dwordx4 v181, s[32:35], s41 offen offset:3072 lds
 s_add_u32 s41, s41, s43
 v_mfma_f32_16x16x32_bf16 v[248:251], v[108:111], v[136:139], v[248:251]
 v_mfma_f32_16x16x32_bf16 a[244:247], v[108:111], v[132:135], a[244:247]
 v_mfma_f32_16x16x32_bf16 a[240:243], v[108:111], v[128:131], a[240:243]
 v_mfma_f32_16x16x32_bf16 a[236:239], v[108:111], v[124:127], a[236:239]
 v_mfma_f32_16x16x32_bf16 a[232:235], v[108:111], v[120:123], a[232:235]
 v_mfma_f32_16x16x32_bf16 a[228:231], v[108:111], v[116:119], a[228:231]
 v_mfma_f32_16x16x32_bf16 a[224:227], v[108:111], v[112:115], a[224:227]
 s_waitcnt vmcnt(16) lgkmcnt(0)
 s_barrier
 v_mfma_f32_16x16x32_bf16 a[0:3], v[16:19], v[48:51], a[0:3]
 ds_read_b64_tr_b16 v[80:81], v164 offset:32768
 v_mfma_f32_16x16x32_bf16 a[4:7], v[16:19], v[52:55], a[4:7]
 ds_read_b64_tr_b16 v[82:83], v164 offset:34816
 s_add_u32 m0, s44, 0
 v_mfma_f32_16x16x32_bf16 a[8:11], v[16:19], v[56:59], a[8:11]
 v_mfma_f32_16x16x32_bf16 a[12:15], v[16:19], v[60:63], a[12:15]
 ds_read_b128 v[112:115], v172 offset:32768
 v_mfma_f32_16x16x32_bf16 a[16:19], v[16:19], v[64:67], a[16:19]
 v_mfma_f32_16x16x32_bf16 a[20:23], v[16:19], v[68:71], a[20:23]
 ds_read_b64_tr_b16 v[84:85], v166 offset:32768
 v_mfma_f32_16x16x32_bf16 v[192:195], v[16:19], v[72:75], v[192:195]
 v_mfma_f32_16x16x32_bf16 v[196:199], v[16:19], v[76:79], v[196:199]
 ds_read_b64_tr_b16 v[86:87], v166 offset:34816
 buffer_load_dwordx4 v174, s[24:27], s40 offen offset:0 lds
 v_mfma_f32_16x16x32_bf16 v[204:207], v[20:23], v[76:79], v[204:207]
 v_mfma_f32_16x16x32_bf16 v[200:203], v[20:23], v[72:75], v[200:203]
 ds_read_b128 v[116:119], v172 offset:33792
 v_mfma_f32_16x16x32_bf16 a[52:55], v[20:23], v[68:71], a[52:55]
 v_mfma_f32_16x16x32_bf16 a[48:51], v[20:23], v[64:67], a[48:51]
 ds_read_b64_tr_b16 v[88:89], v168 offset:32768
 v_mfma_f32_16x16x32_bf16 a[44:47], v[20:23], v[60:63], a[44:47]
 ds_read_b64_tr_b16 v[90:91], v168 offset:34816
 v_mfma_f32_16x16x32_bf16 a[40:43], v[20:23], v[56:59], a[40:43]
 buffer_load_dwordx4 v175, s[24:27], s40 offen offset:1024 lds
 v_mfma_f32_16x16x32_bf16 a[36:39], v[20:23], v[52:55], a[36:39]
 ds_read_b128 v[120:123], v172 offset:34816
 v_mfma_f32_16x16x32_bf16 a[32:35], v[20:23], v[48:51], a[32:35]
 v_mfma_f32_16x16x32_bf16 a[64:67], v[24:27], v[48:51], a[64:67]
 ds_read_b64_tr_b16 v[92:93], v170 offset:32768
 v_mfma_f32_16x16x32_bf16 a[68:71], v[24:27], v[52:55], a[68:71]
 v_mfma_f32_16x16x32_bf16 a[72:75], v[24:27], v[56:59], a[72:75]
 ds_read_b64_tr_b16 v[94:95], v170 offset:34816
 v_mfma_f32_16x16x32_bf16 a[76:79], v[24:27], v[60:63], a[76:79]
 buffer_load_dwordx4 v176, s[24:27], s40 offen offset:2048 lds
 v_mfma_f32_16x16x32_bf16 a[80:83], v[24:27], v[64:67], a[80:83]
 ds_read_b128 v[124:127], v172 offset:35840
 v_mfma_f32_16x16x32_bf16 a[84:87], v[24:27], v[68:71], a[84:87]
 v_mfma_f32_16x16x32_bf16 v[208:211], v[24:27], v[72:75], v[208:211]
 ds_read_b64_tr_b16 v[96:97], v164 offset:33792
 v_mfma_f32_16x16x32_bf16 v[212:215], v[24:27], v[76:79], v[212:215]
 ds_read_b64_tr_b16 v[98:99], v164 offset:35840
 v_mfma_f32_16x16x32_bf16 v[220:223], v[28:31], v[76:79], v[220:223]
 v_mfma_f32_16x16x32_bf16 v[216:219], v[28:31], v[72:75], v[216:219]
 ds_read_b128 v[128:131], v172 offset:36864
 buffer_load_dwordx4 v177, s[24:27], s40 offen offset:3072 lds
 s_add_u32 s40, s40, 16384
 v_mfma_f32_16x16x32_bf16 a[116:119], v[28:31], v[68:71], a[116:119]
 v_mfma_f32_16x16x32_bf16 a[112:115], v[28:31], v[64:67], a[112:115]
 ds_read_b64_tr_b16 v[100:101], v166 offset:33792
 v_mfma_f32_16x16x32_bf16 a[108:111], v[28:31], v[60:63], a[108:111]
 v_mfma_f32_16x16x32_bf16 a[104:107], v[28:31], v[56:59], a[104:107]
 ds_read_b64_tr_b16 v[102:103], v166 offset:35840
 v_mfma_f32_16x16x32_bf16 a[100:103], v[28:31], v[52:55], a[100:103]
 v_mfma_f32_16x16x32_bf16 a[96:99], v[28:31], v[48:51], a[96:99]
 ds_read_b128 v[132:135], v172 offset:37888
 v_mfma_f32_16x16x32_bf16 a[128:131], v[32:35], v[48:51], a[128:131]
 s_add_u32 m0, s45, 0
 v_mfma_f32_16x16x32_bf16 a[132:135], v[32:35], v[52:55], a[132:135]
 ds_read_b64_tr_b16 v[104:105], v168 offset:33792
 v_mfma_f32_16x16x32_bf16 a[136:139], v[32:35], v[56:59], a[136:139]
 ds_read_b64_tr_b16 v[106:107], v168 offset:35840
 v_mfma_f32_16x16x32_bf16 a[140:143], v[32:35], v[60:63], a[140:143]
 v_mfma_f32_16x16x32_bf16 a[144:147], v[32:35], v[64:67], a[144:147]
 ds_read_b128 v[136:139], v172 offset:38912
 v_mfma_f32_16x16x32_bf16 a[148:151], v[32:35], v[68:71], a[148:151]
 v_mfma_f32_16x16x32_bf16 v[224:227], v[32:35], v[72:75], v[224:227]
 ds_read_b64_tr_b16 v[108:109], v170 offset:33792
 buffer_load_dwordx4 v178, s[28:31], s41 offen offset:0 lds
 v_mfma_f32_16x16x32_bf16 v[228:231], v[32:35], v[76:79], v[228:231]
 v_mfma_f32_16x16x32_bf16 v[236:239], v[36:39], v[76:79], v[236:239]
 ds_read_b64_tr_b16 v[110:111], v170 offset:35840
 v_mfma_f32_16x16x32_bf16 v[232:235], v[36:39], v[72:75], v[232:235]
 v_mfma_f32_16x16x32_bf16 a[180:183], v[36:39], v[68:71], a[180:183]
 ds_read_b128 v[140:143], v172 offset:39936
 v_mfma_f32_16x16x32_bf16 a[176:179], v[36:39], v[64:67], a[176:179]
 v_mfma_f32_16x16x32_bf16 a[172:175], v[36:39], v[60:63], a[172:175]
 buffer_load_dwordx4 v179, s[32:35], s41 offen offset:1024 lds
 v_mfma_f32_16x16x32_bf16 a[168:171], v[36:39], v[56:59], a[168:171]
 v_mfma_f32_16x16x32_bf16 a[164:167], v[36:39], v[52:55], a[164:167]
 v_mfma_f32_16x16x32_bf16 a[160:163], v[36:39], v[48:51], a[160:163]
 v_mfma_f32_16x16x32_bf16 a[192:195], v[40:43], v[48:51], a[192:195]
 v_mfma_f32_16x16x32_bf16 a[196:199], v[40:43], v[52:55], a[196:199]
 v_mfma_f32_16x16x32_bf16 a[200:203], v[40:43], v[56:59], a[200:203]
 buffer_load_dwordx4 v180, s[28:31], s41 offen offset:2048 lds
 v_mfma_f32_16x16x32_bf16 a[204:207], v[40:43], v[60:63], a[204:207]
 v_mfma_f32_16x16x32_bf16 a[208:211], v[40:43], v[64:67], a[208:211]
 v_mfma_f32_16x16x32_bf16 a[212:215], v[40:43], v[68:71], a[212:215]
 v_mfma_f32_16x16x32_bf16 v[240:243], v[40:43], v[72:75], v[240:243]
 v_mfma_f32_16x16x32_bf16 v[244:247], v[40:43], v[76:79], v[244:247]
 v_mfma_f32_16x16x32_bf16 v[252:255], v[44:47], v[76:79], v[252:255]
 buffer_load_dwordx4 v181, s[32:35], s41 offen offset:3072 lds
 s_add_u32 s41, s41, s43
 v_mfma_f32_16x16x32_bf16 v[248:251], v[44:47], v[72:75], v[248:251]
 v_mfma_f32_16x16x32_bf16 a[244:247], v[44:47], v[68:71], a[244:247]
 v_mfma_f32_16x16x32_bf16 a[240:243], v[44:47], v[64:67], a[240:243]
 v_mfma_f32_16x16x32_bf16 a[236:239], v[44:47], v[60:63], a[236:239]
 v_mfma_f32_16x16x32_bf16 a[232:235], v[44:47], v[56:59], a[232:235]
 v_mfma_f32_16x16x32_bf16 a[228:231], v[44:47], v[52:55], a[228:231]
 v_mfma_f32_16x16x32_bf16 a[224:227], v[44:47], v[48:51], a[224:227]
 s_add_u32 s47, s47, 1
 s_cmp_lt_u32 s47, 6
 s_cbranch_scc1 L_gemm1_kernel_lnk
 s_waitcnt vmcnt(16) lgkmcnt(0)
 s_barrier
 v_mfma_f32_16x16x32_bf16 a[0:3], v[80:83], v[112:115], a[0:3]
 ds_read_b64_tr_b16 v[16:17], v165 offset:0
 v_mfma_f32_16x16x32_bf16 a[4:7], v[80:83], v[116:119], a[4:7]
 ds_read_b64_tr_b16 v[18:19], v165 offset:2048
 s_add_u32 m0, s44, 32768
 v_mfma_f32_16x16x32_bf16 a[8:11], v[80:83], v[120:123], a[8:11]
 v_mfma_f32_16x16x32_bf16 a[12:15], v[80:83], v[124:127], a[12:15]
 ds_read_b128 v[48:51], v173 offset:0
 v_mfma_f32_16x16x32_bf16 a[16:19], v[80:83], v[128:131], a[16:19]
 v_mfma_f32_16x16x32_bf16 a[20:23], v[80:83], v[132:135], a[20:23]
 ds_read_b64_tr_b16 v[20:21], v167 offset:0
 v_mfma_f32_16x16x32_bf16 v[192:195], v[80:83], v[136:139], v[192:195]
 v_mfma_f32_16x16x32_bf16 v[196:199], v[80:83], v[140:143], v[196:199]
 ds_read_b64_tr_b16 v[22:23], v167 offset:2048
 buffer_load_dwordx4 v174, s[24:27], s40 offen offset:0 lds
 v_mfma_f32_16x16x32_bf16 v[204:207], v[84:87], v[140:143], v[204:207]
 v_mfma_f32_16x16x32_bf16 v[200:203], v[84:87], v[136:139], v[200:203]
 ds_read_b128 v[52:55], v173 offset:1024
 v_mfma_f32_16x16x32_bf16 a[52:55], v[84:87], v[132:135], a[52:55]
 v_mfma_f32_16x16x32_bf16 a[48:51], v[84:87], v[128:131], a[48:51]
 ds_read_b64_tr_b16 v[24:25], v169 offset:0
 v_mfma_f32_16x16x32_bf16 a[44:47], v[84:87], v[124:127], a[44:47]
 ds_read_b64_tr_b16 v[26:27], v169 offset:2048
 v_mfma_f32_16x16x32_bf16 a[40:43], v[84:87], v[120:123], a[40:43]
 buffer_load_dwordx4 v175, s[24:27], s40 offen offset:1024 lds
 v_mfma_f32_16x16x32_bf16 a[36:39], v[84:87], v[116:119], a[36:39]
 ds_read_b128 v[56:59], v173 offset:2048
 v_mfma_f32_16x16x32_bf16 a[32:35], v[84:87], v[112:115], a[32:35]
 v_mfma_f32_16x16x32_bf16 a[64:67], v[88:91], v[112:115], a[64:67]
 ds_read_b64_tr_b16 v[28:29], v171 offset:0
 v_mfma_f32_16x16x32_bf16 a[68:71], v[88:91], v[116:119], a[68:71]
 v_mfma_f32_16x16x32_bf16 a[72:75], v[88:91], v[120:123], a[72:75]
 ds_read_b64_tr_b16 v[30:31], v171 offset:2048
 v_mfma_f32_16x16x32_bf16 a[76:79], v[88:91], v[124:127], a[76:79]
 buffer_load_dwordx4 v176, s[24:27], s40 offen offset:2048 lds
 v_mfma_f32_16x16x32_bf16 a[80:83], v[88:91], v[128:131], a[80:83]
 ds_read_b128 v[60:63], v173 offset:3072
 v_mfma_f32_16x16x32_bf16 a[84:87], v[88:91], v[132:135], a[84:87]
 v_mfma_f32_16x16x32_bf16 v[208:211], v[88:91], v[136:139], v[208:211]
 ds_read_b64_tr_b16 v[32:33], v165 offset:1024
 v_mfma_f32_16x16x32_bf16 v[212:215], v[88:91], v[140:143], v[212:215]
 ds_read_b64_tr_b16 v[34:35], v165 offset:3072
 v_mfma_f32_16x16x32_bf16 v[220:223], v[92:95], v[140:143], v[220:223]
 v_mfma_f32_16x16x32_bf16 v[216:219], v[92:95], v[136:139], v[216:219]
 ds_read_b128 v[64:67], v173 offset:4096
 buffer_load_dwordx4 v177, s[24:27], s40 offen offset:3072 lds
 s_add_u32 s40, s40, 16384
 v_mfma_f32_16x16x32_bf16 a[116:119], v[92:95], v[132:135], a[116:119]
 v_mfma_f32_16x16x32_bf16 a[112:115], v[92:95], v[128:131], a[112:115]
 ds_read_b64_tr_b16 v[36:37], v167 offset:1024
 v_mfma_f32_16x16x32_bf16 a[108:111], v[92:95], v[124:127], a[108:111]
 v_mfma_f32_16x16x32_bf16 a[104:107], v[92:95], v[120:123], a[104:107]
 ds_read_b64_tr_b16 v[38:39], v167 offset:3072
 v_mfma_f32_16x16x32_bf16 a[100:103], v[92:95], v[116:119], a[100:103]
 v_mfma_f32_16x16x32_bf16 a[96:99], v[92:95], v[112:115], a[96:99]
 ds_read_b128 v[68:71], v173 offset:5120
 v_mfma_f32_16x16x32_bf16 a[128:131], v[96:99], v[112:115], a[128:131]
 s_add_u32 m0, s45, 32768
 v_mfma_f32_16x16x32_bf16 a[132:135], v[96:99], v[116:119], a[132:135]
 ds_read_b64_tr_b16 v[40:41], v169 offset:1024
 v_mfma_f32_16x16x32_bf16 a[136:139], v[96:99], v[120:123], a[136:139]
 ds_read_b64_tr_b16 v[42:43], v169 offset:3072
 v_mfma_f32_16x16x32_bf16 a[140:143], v[96:99], v[124:127], a[140:143]
 v_mfma_f32_16x16x32_bf16 a[144:147], v[96:99], v[128:131], a[144:147]
 ds_read_b128 v[72:75], v173 offset:6144
 v_mfma_f32_16x16x32_bf16 a[148:151], v[96:99], v[132:135], a[148:151]
 v_mfma_f32_16x16x32_bf16 v[224:227], v[96:99], v[136:139], v[224:227]
 ds_read_b64_tr_b16 v[44:45], v171 offset:1024
 buffer_load_dwordx4 v178, s[28:31], s41 offen offset:0 lds
 v_mfma_f32_16x16x32_bf16 v[228:231], v[96:99], v[140:143], v[228:231]
 v_mfma_f32_16x16x32_bf16 v[236:239], v[100:103], v[140:143], v[236:239]
 ds_read_b64_tr_b16 v[46:47], v171 offset:3072
 v_mfma_f32_16x16x32_bf16 v[232:235], v[100:103], v[136:139], v[232:235]
 v_mfma_f32_16x16x32_bf16 a[180:183], v[100:103], v[132:135], a[180:183]
 ds_read_b128 v[76:79], v173 offset:7168
 v_mfma_f32_16x16x32_bf16 a[176:179], v[100:103], v[128:131], a[176:179]
 v_mfma_f32_16x16x32_bf16 a[172:175], v[100:103], v[124:127], a[172:175]
 buffer_load_dwordx4 v179, s[32:35], s41 offen offset:1024 lds
 v_mfma_f32_16x16x32_bf16 a[168:171], v[100:103], v[120:123], a[168:171]
 v_mfma_f32_16x16x32_bf16 a[164:167], v[100:103], v[116:119], a[164:167]
 v_mfma_f32_16x16x32_bf16 a[160:163], v[100:103], v[112:115], a[160:163]
 v_mfma_f32_16x16x32_bf16 a[192:195], v[104:107], v[112:115], a[192:195]
 v_mfma_f32_16x16x32_bf16 a[196:199], v[104:107], v[116:119], a[196:199]
 v_mfma_f32_16x16x32_bf16 a[200:203], v[104:107], v[120:123], a[200:203]
 buffer_load_dwordx4 v180, s[28:31], s41 offen offset:2048 lds
 v_mfma_f32_16x16x32_bf16 a[204:207], v[104:107], v[124:127], a[204:207]
 v_mfma_f32_16x16x32_bf16 a[208:211], v[104:107], v[128:131], a[208:211]
 v_mfma_f32_16x16x32_bf16 a[212:215], v[104:107], v[132:135], a[212:215]
 v_mfma_f32_16x16x32_bf16 v[240:243], v[104:107], v[136:139], v[240:243]
 v_mfma_f32_16x16x32_bf16 v[244:247], v[104:107], v[140:143], v[244:247]
 v_mfma_f32_16x16x32_bf16 v[252:255], v[108:111], v[140:143], v[252:255]
 buffer_load_dwordx4 v181, s[32:35], s41 offen offset:3072 lds
 s_add_u32 s41, s41, s43
 v_mfma_f32_16x16x32_bf16 v[248:251], v[108:111], v[136:139], v[248:251]
 v_mfma_f32_16x16x32_bf16 a[244:247], v[108:111], v[132:135], a[244:247]
 v_mfma_f32_16x16x32_bf16 a[240:243], v[108:111], v[128:131], a[240:243]
 v_mfma_f32_16x16x32_bf16 a[236:239], v[108:111], v[124:127], a[236:239]
 v_mfma_f32_16x16x32_bf16 a[232:235], v[108:111], v[120:123], a[232:235]
 v_mfma_f32_16x16x32_bf16 a[228:231], v[108:111], v[116:119], a[228:231]
 v_mfma_f32_16x16x32_bf16 a[224:227], v[108:111], v[112:115], a[224:227]
 s_waitcnt vmcnt(16) lgkmcnt(0)
 s_barrier
 v_mfma_f32_16x16x32_bf16 a[0:3], v[16:19], v[48:51], a[0:3]
 ds_read_b64_tr_b16 v[80:81], v165 offset:32768
 v_mfma_f32_16x16x32_bf16 a[4:7], v[16:19], v[52:55], a[4:7]
 ds_read_b64_tr_b16 v[82:83], v165 offset:34816
 s_add_u32 m0, s44, 65536
 v_mfma_f32_16x16x32_bf16 a[8:11], v[16:19], v[56:59], a[8:11]
 v_mfma_f32_16x16x32_bf16 a[12:15], v[16:19], v[60:63], a[12:15]
 ds_read_b128 v[112:115], v173 offset:32768
 v_mfma_f32_16x16x32_bf16 a[16:19], v[16:19], v[64:67], a[16:19]
 v_mfma_f32_16x16x32_bf16 a[20:23], v[16:19], v[68:71], a[20:23]
 ds_read_b64_tr_b16 v[84:85], v167 offset:32768
 v_mfma_f32_16x16x32_bf16 v[192:195], v[16:19], v[72:75], v[192:195]
 v_mfma_f32_16x16x32_bf16 v[196:199], v[16:19], v[76:79], v[196:199]
 ds_read_b64_tr_b16 v[86:87], v167 offset:34816
 buffer_load_dwordx4 v174, s[24:27], s40 offen offset:0 lds
 v_mfma_f32_16x16x32_bf16 v[204:207], v[20:23], v[76:79], v[204:207]
 v_mfma_f32_16x16x32_bf16 v[200:203], v[20:23], v[72:75], v[200:203]
 ds_read_b128 v[116:119], v173 offset:33792
 v_mfma_f32_16x16x32_bf16 a[52:55], v[20:23], v[68:71], a[52:55]
 v_mfma_f32_16x16x32_bf16 a[48:51], v[20:23], v[64:67], a[48:51]
 ds_read_b64_tr_b16 v[88:89], v169 offset:32768
 v_mfma_f32_16x16x32_bf16 a[44:47], v[20:23], v[60:63], a[44:47]
 ds_read_b64_tr_b16 v[90:91], v169 offset:34816
 v_mfma_f32_16x16x32_bf16 a[40:43], v[20:23], v[56:59], a[40:43]
 buffer_load_dwordx4 v175, s[24:27], s40 offen offset:1024 lds
 v_mfma_f32_16x16x32_bf16 a[36:39], v[20:23], v[52:55], a[36:39]
 ds_read_b128 v[120:123], v173 offset:34816
 v_mfma_f32_16x16x32_bf16 a[32:35], v[20:23], v[48:51], a[32:35]
 v_mfma_f32_16x16x32_bf16 a[64:67], v[24:27], v[48:51], a[64:67]
 ds_read_b64_tr_b16 v[92:93], v171 offset:32768
 v_mfma_f32_16x16x32_bf16 a[68:71], v[24:27], v[52:55], a[68:71]
 v_mfma_f32_16x16x32_bf16 a[72:75], v[24:27], v[56:59], a[72:75]
 ds_read_b64_tr_b16 v[94:95], v171 offset:34816
 v_mfma_f32_16x16x32_bf16 a[76:79], v[24:27], v[60:63], a[76:79]
 buffer_load_dwordx4 v176, s[24:27], s40 offen offset:2048 lds
 v_mfma_f32_16x16x32_bf16 a[80:83], v[24:27], v[64:67], a[80:83]
 ds_read_b128 v[124:127], v173 offset:35840
 v_mfma_f32_16x16x32_bf16 a[84:87], v[24:27], v[68:71], a[84:87]
 v_mfma_f32_16x16x32_bf16 v[208:211], v[24:27], v[72:75], v[208:211]
 ds_read_b64_tr_b16 v[96:97], v165 offset:33792
 v_mfma_f32_16x16x32_bf16 v[212:215], v[24:27], v[76:79], v[212:215]
 ds_read_b64_tr_b16 v[98:99], v165 offset:35840
 v_mfma_f32_16x16x32_bf16 v[220:223], v[28:31], v[76:79], v[220:223]
 v_mfma_f32_16x16x32_bf16 v[216:219], v[28:31], v[72:75], v[216:219]
 ds_read_b128 v[128:131], v173 offset:36864
 buffer_load_dwordx4 v177, s[24:27], s40 offen offset:3072 lds
 s_add_u32 s40, s40, 16384
 v_mfma_f32_16x16x32_bf16 a[116:119], v[28:31], v[68:71], a[116:119]
 v_mfma_f32_16x16x32_bf16 a[112:115], v[28:31], v[64:67], a[112:115]
 ds_read_b64_tr_b16 v[100:101], v167 offset:33792
 v_mfma_f32_16x16x32_bf16 a[108:111], v[28:31], v[60:63], a[108:111]
 v_mfma_f32_16x16x32_bf16 a[104:107], v[28:31], v[56:59], a[104:107]
 ds_read_b64_tr_b16 v[102:103], v167 offset:35840
 v_mfma_f32_16x16x32_bf16 a[100:103], v[28:31], v[52:55], a[100:103]
 v_mfma_f32_16x16x32_bf16 a[96:99], v[28:31], v[48:51], a[96:99]
 ds_read_b128 v[132:135], v173 offset:37888
 v_mfma_f32_16x16x32_bf16 a[128:131], v[32:35], v[48:51], a[128:131]
 s_add_u32 m0, s45, 65536
 v_mfma_f32_16x16x32_bf16 a[132:135], v[32:35], v[52:55], a[132:135]
 ds_read_b64_tr_b16 v[104:105], v169 offset:33792
 v_mfma_f32_16x16x32_bf16 a[136:139], v[32:35], v[56:59], a[136:139]
 ds_read_b64_tr_b16 v[106:107], v169 offset:35840
 v_mfma_f32_16x16x32_bf16 a[140:143], v[32:35], v[60:63], a[140:143]
 v_mfma_f32_16x16x32_bf16 a[144:147], v[32:35], v[64:67], a[144:147]
 ds_read_b128 v[136:139], v173 offset:38912
 v_mfma_f32_16x16x32_bf16 a[148:151], v[32:35], v[68:71], a[148:151]
 v_mfma_f32_16x16x32_bf16 v[224:227], v[32:35], v[72:75], v[224:227]
 ds_read_b64_tr_b16 v[108:109], v171 offset:33792
 buffer_load_dwordx4 v178, s[28:31], s41 offen offset:0 lds
 v_mfma_f32_16x16x32_bf16 v[228:231], v[32:35], v[76:79], v[228:231]
 v_mfma_f32_16x16x32_bf16 v[236:239], v[36:39], v[76:79], v[236:239]
 ds_read_b64_tr_b16 v[110:111], v171 offset:35840
 v_mfma_f32_16x16x32_bf16 v[232:235], v[36:39], v[72:75], v[232:235]
 v_mfma_f32_16x16x32_bf16 a[180:183], v[36:39], v[68:71], a[180:183]
 ds_read_b128 v[140:143], v173 offset:39936
 v_mfma_f32_16x16x32_bf16 a[176:179], v[36:39], v[64:67], a[176:179]
 v_mfma_f32_16x16x32_bf16 a[172:175], v[36:39], v[60:63], a[172:175]
 buffer_load_dwordx4 v179, s[32:35], s41 offen offset:1024 lds
 v_mfma_f32_16x16x32_bf16 a[168:171], v[36:39], v[56:59], a[168:171]
 v_mfma_f32_16x16x32_bf16 a[164:167], v[36:39], v[52:55], a[164:167]
 v_mfma_f32_16x16x32_bf16 a[160:163], v[36:39], v[48:51], a[160:163]
 v_mfma_f32_16x16x32_bf16 a[192:195], v[40:43], v[48:51], a[192:195]
 v_mfma_f32_16x16x32_bf16 a[196:199], v[40:43], v[52:55], a[196:199]
 v_mfma_f32_16x16x32_bf16 a[200:203], v[40:43], v[56:59], a[200:203]
 buffer_load_dwordx4 v180, s[28:31], s41 offen offset:2048 lds
 v_mfma_f32_16x16x32_bf16 a[204:207], v[40:43], v[60:63], a[204:207]
 v_mfma_f32_16x16x32_bf16 a[208:211], v[40:43], v[64:67], a[208:211]
 v_mfma_f32_16x16x32_bf16 a[212:215], v[40:43], v[68:71], a[212:215]
 v_mfma_f32_16x16x32_bf16 v[240:243], v[40:43], v[72:75], v[240:243]
 v_mfma_f32_16x16x32_bf16 v[244:247], v[40:43], v[76:79], v[244:247]
 v_mfma_f32_16x16x32_bf16 v[252:255], v[44:47], v[76:79], v[252:255]
 buffer_load_dwordx4 v181, s[32:35], s41 offen offset:3072 lds
 s_add_u32 s41, s41, s43
 v_mfma_f32_16x16x32_bf16 v[248:251], v[44:47], v[72:75], v[248:251]
 v_mfma_f32_16x16x32_bf16 a[244:247], v[44:47], v[68:71], a[244:247]
 v_mfma_f32_16x16x32_bf16 a[240:243], v[44:47], v[64:67], a[240:243]
 v_mfma_f32_16x16x32_bf16 a[236:239], v[44:47], v[60:63], a[236:239]
 v_mfma_f32_16x16x32_bf16 a[232:235], v[44:47], v[56:59], a[232:235]
 v_mfma_f32_16x16x32_bf16 a[228:231], v[44:47], v[52:55], a[228:231]
 v_mfma_f32_16x16x32_bf16 a[224:227], v[44:47], v[48:51], a[224:227]
 s_waitcnt vmcnt(16) lgkmcnt(0)
 s_barrier
 v_mfma_f32_16x16x32_bf16 a[0:3], v[80:83], v[112:115], a[0:3]
 ds_read_b64_tr_b16 v[16:17], v164 offset:0
 v_mfma_f32_16x16x32_bf16 a[4:7], v[80:83], v[116:119], a[4:7]
 ds_read_b64_tr_b16 v[18:19], v164 offset:2048
 s_add_u32 m0, s44, 98304
 v_mfma_f32_16x16x32_bf16 a[8:11], v[80:83], v[120:123], a[8:11]
 v_mfma_f32_16x16x32_bf16 a[12:15], v[80:83], v[124:127], a[12:15]
 ds_read_b128 v[48:51], v172 offset:0
 v_mfma_f32_16x16x32_bf16 a[16:19], v[80:83], v[128:131], a[16:19]
 v_mfma_f32_16x16x32_bf16 a[20:23], v[80:83], v[132:135], a[20:23]
 ds_read_b64_tr_b16 v[20:21], v166 offset:0
 v_mfma_f32_16x16x32_bf16 v[192:195], v[80:83], v[136:139], v[192:195]
 v_mfma_f32_16x16x32_bf16 v[196:199], v[80:83], v[140:143], v[196:199]
 ds_read_b64_tr_b16 v[22:23], v166 offset:2048
 buffer_load_dwordx4 v174, s[24:27], s40 offen offset:0 lds
 v_mfma_f32_16x16x32_bf16 v[204:207], v[84:87], v[140:143], v[204:207]
 v_mfma_f32_16x16x32_bf16 v[200:203], v[84:87], v[136:139], v[200:203]
 ds_read_b128 v[52:55], v172 offset:1024
 v_mfma_f32_16x16x32_bf16 a[52:55], v[84:87], v[132:135], a[52:55]
 v_mfma_f32_16x16x32_bf16 a[48:51], v[84:87], v[128:131], a[48:51]
 ds_read_b64_tr_b16 v[24:25], v168 offset:0
 v_mfma_f32_16x16x32_bf16 a[44:47], v[84:87], v[124:127], a[44:47]
 ds_read_b64_tr_b16 v[26:27], v168 offset:2048
 v_mfma_f32_16x16x32_bf16 a[40:43], v[84:87], v[120:123], a[40:43]
 buffer_load_dwordx4 v175, s[24:27], s40 offen offset:1024 lds
 v_mfma_f32_16x16x32_bf16 a[36:39], v[84:87], v[116:119], a[36:39]
 ds_read_b128 v[56:59], v172 offset:2048
 v_mfma_f32_16x16x32_bf16 a[32:35], v[84:87], v[112:115], a[32:35]
 v_mfma_f32_16x16x32_bf16 a[64:67], v[88:91], v[112:115], a[64:67]
 ds_read_b64_tr_b16 v[28:29], v170 offset:0
 v_mfma_f32_16x16x32_bf16 a[68:71], v[88:91], v[116:119], a[68:71]
 v_mfma_f32_16x16x32_bf16 a[72:75], v[88:91], v[120:123], a[72:75]
 ds_read_b64_tr_b16 v[30:31], v170 offset:2048
 v_mfma_f32_16x16x32_bf16 a[76:79], v[88:91], v[124:127], a[76:79]
 buffer_load_dwordx4 v176, s[24:27], s40 offen offset:2048 lds
 v_mfma_f32_16x16x32_bf16 a[80:83], v[88:91], v[128:131], a[80:83]
 ds_read_b128 v[60:63], v172 offset:3072
 v_mfma_f32_16x16x32_bf16 a[84:87], v[88:91], v[132:135], a[84:87]
 v_mfma_f32_16x16x32_bf16 v[208:211], v[88:91], v[136:139], v[208:211]
 ds_read_b64_tr_b16 v[32:33], v164 offset:1024
 v_mfma_f32_16x16x32_bf16 v[212:215], v[88:91], v[140:143], v[212:215]
 ds_read_b64_tr_b16 v[34:35], v164 offset:3072
 v_mfma_f32_16x16x32_bf16 v[220:223], v[92:95], v[140:143], v[220:223]
 v_mfma_f32_16x16x32_bf16 v[216:219], v[92:95], v[136:139], v[216:219]
 ds_read_b128 v[64:67], v172 offset:4096
 buffer_load_dwordx4 v177, s[24:27], s40 offen offset:3072 lds
 s_add_u32 s40, s40, 16384
 v_mfma_f32_16x16x32_bf16 a[116:119], v[92:95], v[132:135], a[116:119]
 v_mfma_f32_16x16x32_bf16 a[112:115], v[92:95], v[128:131], a[112:115]
 ds_read_b64_tr_b16 v[36:37], v166 offset:1024
 v_mfma_f32_16x16x32_bf16 a[108:111], v[92:95], v[124:127], a[108:111]
 v_mfma_f32_16x16x32_bf16 a[104:107], v[92:95], v[120:123], a[104:107]
 ds_read_b64_tr_b16 v[38:39], v166 offset:3072
 v_mfma_f32_16x16x32_bf16 a[100:103], v[92:95], v[116:119], a[100:103]
 v_mfma_f32_16x16x32_bf16 a[96:99], v[92:95], v[112:115], a[96:99]
 ds_read_b128 v[68:71], v172 offset:5120
 v_mfma_f32_16x16x32_bf16 a[128:131], v[96:99], v[112:115], a[128:131]
 s_add_u32 m0, s45, 98304
 v_mfma_f32_16x16x32_bf16 a[132:135], v[96:99], v[116:119], a[132:135]
 ds_read_b64_tr_b16 v[40:41], v168 offset:1024
 v_mfma_f32_16x16x32_bf16 a[136:139], v[96:99], v[120:123], a[136:139]
 ds_read_b64_tr_b16 v[42:43], v168 offset:3072
 v_mfma_f32_16x16x32_bf16 a[140:143], v[96:99], v[124:127], a[140:143]
 v_mfma_f32_16x16x32_bf16 a[144:147], v[96:99], v[128:131], a[144:147]
 ds_read_b128 v[72:75], v172 offset:6144
 v_mfma_f32_16x16x32_bf16 a[148:151], v[96:99], v[132:135], a[148:151]
 v_mfma_f32_16x16x32_bf16 v[224:227], v[96:99], v[136:139], v[224:227]
 ds_read_b64_tr_b16 v[44:45], v170 offset:1024
 buffer_load_dwordx4 v178, s[28:31], s41 offen offset:0 lds
 v_mfma_f32_16x16x32_bf16 v[228:231], v[96:99], v[140:143], v[228:231]
 v_mfma_f32_16x16x32_bf16 v[236:239], v[100:103], v[140:143], v[236:239]
 ds_read_b64_tr_b16 v[46:47], v170 offset:3072
 v_mfma_f32_16x16x32_bf16 v[232:235], v[100:103], v[136:139], v[232:235]
 v_mfma_f32_16x16x32_bf16 a[180:183], v[100:103], v[132:135], a[180:183]
 ds_read_b128 v[76:79], v172 offset:7168
 v_mfma_f32_16x16x32_bf16 a[176:179], v[100:103], v[128:131], a[176:179]
 v_mfma_f32_16x16x32_bf16 a[172:175], v[100:103], v[124:127], a[172:175]
 buffer_load_dwordx4 v179, s[32:35], s41 offen offset:1024 lds
 v_mfma_f32_16x16x32_bf16 a[168:171], v[100:103], v[120:123], a[168:171]
 v_mfma_f32_16x16x32_bf16 a[164:167], v[100:103], v[116:119], a[164:167]
 v_mfma_f32_16x16x32_bf16 a[160:163], v[100:103], v[112:115], a[160:163]
 v_mfma_f32_16x16x32_bf16 a[192:195], v[104:107], v[112:115], a[192:195]
 v_mfma_f32_16x16x32_bf16 a[196:199], v[104:107], v[116:119], a[196:199]
 v_mfma_f32_16x16x32_bf16 a[200:203], v[104:107], v[120:123], a[200:203]
 buffer_load_dwordx4 v180, s[28:31], s41 offen offset:2048 lds
 v_mfma_f32_16x16x32_bf16 a[204:207], v[104:107], v[124:127], a[204:207]
 v_mfma_f32_16x16x32_bf16 a[208:211], v[104:107], v[128:131], a[208:211]
 v_mfma_f32_16x16x32_bf16 a[212:215], v[104:107], v[132:135], a[212:215]
 v_mfma_f32_16x16x32_bf16 v[240:243], v[104:107], v[136:139], v[240:243]
 v_mfma_f32_16x16x32_bf16 v[244:247], v[104:107], v[140:143], v[244:247]
 v_mfma_f32_16x16x32_bf16 v[252:255], v[108:111], v[140:143], v[252:255]
 buffer_load_dwordx4 v181, s[32:35], s41 offen offset:3072 lds
 s_add_u32 s41, s41, s43
 v_mfma_f32_16x16x32_bf16 v[248:251], v[108:111], v[136:139], v[248:251]
 v_mfma_f32_16x16x32_bf16 a[244:247], v[108:111], v[132:135], a[244:247]
 v_mfma_f32_16x16x32_bf16 a[240:243], v[108:111], v[128:131], a[240:243]
 v_mfma_f32_16x16x32_bf16 a[236:239], v[108:111], v[124:127], a[236:239]
 v_mfma_f32_16x16x32_bf16 a[232:235], v[108:111], v[120:123], a[232:235]
 v_mfma_f32_16x16x32_bf16 a[228:231], v[108:111], v[116:119], a[228:231]
 v_mfma_f32_16x16x32_bf16 a[224:227], v[108:111], v[112:115], a[224:227]
 s_waitcnt vmcnt(16) lgkmcnt(0)
 s_barrier
 v_mfma_f32_16x16x32_bf16 a[0:3], v[16:19], v[48:51], a[0:3]
 ds_read_b64_tr_b16 v[80:81], v164 offset:32768
 v_mfma_f32_16x16x32_bf16 a[4:7], v[16:19], v[52:55], a[4:7]
 ds_read_b64_tr_b16 v[82:83], v164 offset:34816
 v_mfma_f32_16x16x32_bf16 a[8:11], v[16:19], v[56:59], a[8:11]
 v_mfma_f32_16x16x32_bf16 a[12:15], v[16:19], v[60:63], a[12:15]
 ds_read_b128 v[112:115], v172 offset:32768
 v_mfma_f32_16x16x32_bf16 a[16:19], v[16:19], v[64:67], a[16:19]
 v_mfma_f32_16x16x32_bf16 a[20:23], v[16:19], v[68:71], a[20:23]
 ds_read_b64_tr_b16 v[84:85], v166 offset:32768
 v_mfma_f32_16x16x32_bf16 v[192:195], v[16:19], v[72:75], v[192:195]
 v_mfma_f32_16x16x32_bf16 v[196:199], v[16:19], v[76:79], v[196:199]
 ds_read_b64_tr_b16 v[86:87], v166 offset:34816
 v_mfma_f32_16x16x32_bf16 v[204:207], v[20:23], v[76:79], v[204:207]
 v_mfma_f32_16x16x32_bf16 v[200:203], v[20:23], v[72:75], v[200:203]
 ds_read_b128 v[116:119], v172 offset:33792
 v_mfma_f32_16x16x32_bf16 a[52:55], v[20:23], v[68:71], a[52:55]
 v_mfma_f32_16x16x32_bf16 a[48:51], v[20:23], v[64:67], a[48:51]
 ds_read_b64_tr_b16 v[88:89], v168 offset:32768
 v_mfma_f32_16x16x32_bf16 a[44:47], v[20:23], v[60:63], a[44:47]
 ds_read_b64_tr_b16 v[90:91], v168 offset:34816
 v_mfma_f32_16x16x32_bf16 a[40:43], v[20:23], v[56:59], a[40:43]
 v_mfma_f32_16x16x32_bf16 a[36:39], v[20:23], v[52:55], a[36:39]
 ds_read_b128 v[120:123], v172 offset:34816
 v_mfma_f32_16x16x32_bf16 a[32:35], v[20:23], v[48:51], a[32:35]
 v_mfma_f32_16x16x32_bf16 a[64:67], v[24:27], v[48:51], a[64:67]
 ds_read_b64_tr_b16 v[92:93], v170 offset:32768
 v_mfma_f32_16x16x32_bf16 a[68:71], v[24:27], v[52:55], a[68:71]
 v_mfma_f32_16x16x32_bf16 a[72:75], v[24:27], v[56:59], a[72:75]
 ds_read_b64_tr_b16 v[94:95], v170 offset:34816
 v_mfma_f32_16x16x32_bf16 a[76:79], v[24:27], v[60:63], a[76:79]
 v_mfma_f32_16x16x32_bf16 a[80:83], v[24:27], v[64:67], a[80:83]
 ds_read_b128 v[124:127], v172 offset:35840
 v_mfma_f32_16x16x32_bf16 a[84:87], v[24:27], v[68:71], a[84:87]
 v_mfma_f32_16x16x32_bf16 v[208:211], v[24:27], v[72:75], v[208:211]
 ds_read_b64_tr_b16 v[96:97], v164 offset:33792
 v_mfma_f32_16x16x32_bf16 v[212:215], v[24:27], v[76:79], v[212:215]
 ds_read_b64_tr_b16 v[98:99], v164 offset:35840
 v_mfma_f32_16x16x32_bf16 v[220:223], v[28:31], v[76:79], v[220:223]
 v_mfma_f32_16x16x32_bf16 v[216:219], v[28:31], v[72:75], v[216:219]
 ds_read_b128 v[128:131], v172 offset:36864
 v_mfma_f32_16x16x32_bf16 a[116:119], v[28:31], v[68:71], a[116:119]
 v_mfma_f32_16x16x32_bf16 a[112:115], v[28:31], v[64:67], a[112:115]
 ds_read_b64_tr_b16 v[100:101], v166 offset:33792
 v_mfma_f32_16x16x32_bf16 a[108:111], v[28:31], v[60:63], a[108:111]
 v_mfma_f32_16x16x32_bf16 a[104:107], v[28:31], v[56:59], a[104:107]
 ds_read_b64_tr_b16 v[102:103], v166 offset:35840
 v_mfma_f32_16x16x32_bf16 a[100:103], v[28:31], v[52:55], a[100:103]
 v_mfma_f32_16x16x32_bf16 a[96:99], v[28:31], v[48:51], a[96:99]
 ds_read_b128 v[132:135], v172 offset:37888
 v_mfma_f32_16x16x32_bf16 a[128:131], v[32:35], v[48:51], a[128:131]
 v_mfma_f32_16x16x32_bf16 a[132:135], v[32:35], v[52:55], a[132:135]
 ds_read_b64_tr_b16 v[104:105], v168 offset:33792
 v_mfma_f32_16x16x32_bf16 a[136:139], v[32:35], v[56:59], a[136:139]
 ds_read_b64_tr_b16 v[106:107], v168 offset:35840
 v_mfma_f32_16x16x32_bf16 a[140:143], v[32:35], v[60:63], a[140:143]
 v_mfma_f32_16x16x32_bf16 a[144:147], v[32:35], v[64:67], a[144:147]
 ds_read_b128 v[136:139], v172 offset:38912
 v_mfma_f32_16x16x32_bf16 a[148:151], v[32:35], v[68:71], a[148:151]
 v_mfma_f32_16x16x32_bf16 v[224:227], v[32:35], v[72:75], v[224:227]
 ds_read_b64_tr_b16 v[108:109], v170 offset:33792
 v_mfma_f32_16x16x32_bf16 v[228:231], v[32:35], v[76:79], v[228:231]
 v_mfma_f32_16x16x32_bf16 v[236:239], v[36:39], v[76:79], v[236:239]
 ds_read_b64_tr_b16 v[110:111], v170 offset:35840
 v_mfma_f32_16x16x32_bf16 v[232:235], v[36:39], v[72:75], v[232:235]
 v_mfma_f32_16x16x32_bf16 a[180:183], v[36:39], v[68:71], a[180:183]
 ds_read_b128 v[140:143], v172 offset:39936
 v_mfma_f32_16x16x32_bf16 a[176:179], v[36:39], v[64:67], a[176:179]
 v_mfma_f32_16x16x32_bf16 a[172:175], v[36:39], v[60:63], a[172:175]
 v_mfma_f32_16x16x32_bf16 a[168:171], v[36:39], v[56:59], a[168:171]
 v_mfma_f32_16x16x32_bf16 a[164:167], v[36:39], v[52:55], a[164:167]
 v_mfma_f32_16x16x32_bf16 a[160:163], v[36:39], v[48:51], a[160:163]
 v_mfma_f32_16x16x32_bf16 a[192:195], v[40:43], v[48:51], a[192:195]
 v_mfma_f32_16x16x32_bf16 a[196:199], v[40:43], v[52:55], a[196:199]
 v_mfma_f32_16x16x32_bf16 a[200:203], v[40:43], v[56:59], a[200:203]
 v_mfma_f32_16x16x32_bf16 a[204:207], v[40:43], v[60:63], a[204:207]
 v_mfma_f32_16x16x32_bf16 a[208:211], v[40:43], v[64:67], a[208:211]
 v_mfma_f32_16x16x32_bf16 a[212:215], v[40:43], v[68:71], a[212:215]
 v_mfma_f32_16x16x32_bf16 v[240:243], v[40:43], v[72:75], v[240:243]
 v_mfma_f32_16x16x32_bf16 v[244:247], v[40:43], v[76:79], v[244:247]
 v_mfma_f32_16x16x32_bf16 v[252:255], v[44:47], v[76:79], v[252:255]
 v_mfma_f32_16x16x32_bf16 v[248:251], v[44:47], v[72:75], v[248:251]
 v_mfma_f32_16x16x32_bf16 a[244:247], v[44:47], v[68:71], a[244:247]
 v_mfma_f32_16x16x32_bf16 a[240:243], v[44:47], v[64:67], a[240:243]
 v_mfma_f32_16x16x32_bf16 a[236:239], v[44:47], v[60:63], a[236:239]
 v_mfma_f32_16x16x32_bf16 a[232:235], v[44:47], v[56:59], a[232:235]
 v_mfma_f32_16x16x32_bf16 a[228:231], v[44:47], v[52:55], a[228:231]
 v_mfma_f32_16x16x32_bf16 a[224:227], v[44:47], v[48:51], a[224:227]
 s_waitcnt vmcnt(8) lgkmcnt(0)
 s_barrier
 v_mfma_f32_16x16x32_bf16 a[0:3], v[80:83], v[112:115], a[0:3]
 ds_read_b64_tr_b16 v[16:17], v165 offset:0
 s_mov_b32 s64, s92
 s_and_b32 s65, s93, 0xffff
 s_mov_b32 s66, 7340032
 s_mov_b32 s67, 0x20000
 s_mov_b32 s52, 0
 buffer_load_dword v3, v1, s[64:67], s52 offen
 v_mfma_f32_16x16x32_bf16 a[4:7], v[80:83], v[116:119], a[4:7]
 ds_read_b64_tr_b16 v[18:19], v165 offset:2048
 v_mfma_f32_16x16x32_bf16 a[8:11], v[80:83], v[120:123], a[8:11]
 v_mfma_f32_16x16x32_bf16 a[12:15], v[80:83], v[124:127], a[12:15]
 ds_read_b128 v[48:51], v173 offset:0
 v_mfma_f32_16x16x32_bf16 a[16:19], v[80:83], v[128:131], a[16:19]
 v_mfma_f32_16x16x32_bf16 a[20:23], v[80:83], v[132:135], a[20:23]
 ds_read_b64_tr_b16 v[20:21], v167 offset:0
 v_mfma_f32_16x16x32_bf16 v[192:195], v[80:83], v[136:139], v[192:195]
 v_mfma_f32_16x16x32_bf16 v[196:199], v[80:83], v[140:143], v[196:199]
 ds_read_b64_tr_b16 v[22:23], v167 offset:2048
 v_mfma_f32_16x16x32_bf16 v[204:207], v[84:87], v[140:143], v[204:207]
 v_mfma_f32_16x16x32_bf16 v[200:203], v[84:87], v[136:139], v[200:203]
 ds_read_b128 v[52:55], v173 offset:1024
 v_mfma_f32_16x16x32_bf16 a[52:55], v[84:87], v[132:135], a[52:55]
 v_mfma_f32_16x16x32_bf16 a[48:51], v[84:87], v[128:131], a[48:51]
 ds_read_b64_tr_b16 v[24:25], v169 offset:0
 v_mfma_f32_16x16x32_bf16 a[44:47], v[84:87], v[124:127], a[44:47]
 ds_read_b64_tr_b16 v[26:27], v169 offset:2048
 v_mfma_f32_16x16x32_bf16 a[40:43], v[84:87], v[120:123], a[40:43]
 v_mfma_f32_16x16x32_bf16 a[36:39], v[84:87], v[116:119], a[36:39]
 ds_read_b128 v[56:59], v173 offset:2048
 v_mfma_f32_16x16x32_bf16 a[32:35], v[84:87], v[112:115], a[32:35]
 v_mfma_f32_16x16x32_bf16 a[64:67], v[88:91], v[112:115], a[64:67]
 ds_read_b64_tr_b16 v[28:29], v171 offset:0
 v_mfma_f32_16x16x32_bf16 a[68:71], v[88:91], v[116:119], a[68:71]
 v_mfma_f32_16x16x32_bf16 a[72:75], v[88:91], v[120:123], a[72:75]
 ds_read_b64_tr_b16 v[30:31], v171 offset:2048
 v_mfma_f32_16x16x32_bf16 a[76:79], v[88:91], v[124:127], a[76:79]
 v_mfma_f32_16x16x32_bf16 a[80:83], v[88:91], v[128:131], a[80:83]
 ds_read_b128 v[60:63], v173 offset:3072
 v_mfma_f32_16x16x32_bf16 a[84:87], v[88:91], v[132:135], a[84:87]
 v_mfma_f32_16x16x32_bf16 v[208:211], v[88:91], v[136:139], v[208:211]
 ds_read_b64_tr_b16 v[32:33], v165 offset:1024
 v_mfma_f32_16x16x32_bf16 v[212:215], v[88:91], v[140:143], v[212:215]
 ds_read_b64_tr_b16 v[34:35], v165 offset:3072
 v_mfma_f32_16x16x32_bf16 v[220:223], v[92:95], v[140:143], v[220:223]
 v_mfma_f32_16x16x32_bf16 v[216:219], v[92:95], v[136:139], v[216:219]
 ds_read_b128 v[64:67], v173 offset:4096
 v_mfma_f32_16x16x32_bf16 a[116:119], v[92:95], v[132:135], a[116:119]
 v_mfma_f32_16x16x32_bf16 a[112:115], v[92:95], v[128:131], a[112:115]
 ds_read_b64_tr_b16 v[36:37], v167 offset:1024
 v_mfma_f32_16x16x32_bf16 a[108:111], v[92:95], v[124:127], a[108:111]
 v_mfma_f32_16x16x32_bf16 a[104:107], v[92:95], v[120:123], a[104:107]
 ds_read_b64_tr_b16 v[38:39], v167 offset:3072
 v_mfma_f32_16x16x32_bf16 a[100:103], v[92:95], v[116:119], a[100:103]
 v_mfma_f32_16x16x32_bf16 a[96:99], v[92:95], v[112:115], a[96:99]
 ds_read_b128 v[68:71], v173 offset:5120
 v_mfma_f32_16x16x32_bf16 a[128:131], v[96:99], v[112:115], a[128:131]
 v_mfma_f32_16x16x32_bf16 a[132:135], v[96:99], v[116:119], a[132:135]
 ds_read_b64_tr_b16 v[40:41], v169 offset:1024
 v_mfma_f32_16x16x32_bf16 a[136:139], v[96:99], v[120:123], a[136:139]
 ds_read_b64_tr_b16 v[42:43], v169 offset:3072
 v_mfma_f32_16x16x32_bf16 a[140:143], v[96:99], v[124:127], a[140:143]
 v_mfma_f32_16x16x32_bf16 a[144:147], v[96:99], v[128:131], a[144:147]
 ds_read_b128 v[72:75], v173 offset:6144
 v_mfma_f32_16x16x32_bf16 a[148:151], v[96:99], v[132:135], a[148:151]
 v_mfma_f32_16x16x32_bf16 v[224:227], v[96:99], v[136:139], v[224:227]
 ds_read_b64_tr_b16 v[44:45], v171 offset:1024
 v_mfma_f32_16x16x32_bf16 v[228:231], v[96:99], v[140:143], v[228:231]
 v_mfma_f32_16x16x32_bf16 v[236:239], v[100:103], v[140:143], v[236:239]
 ds_read_b64_tr_b16 v[46:47], v171 offset:3072
 v_mfma_f32_16x16x32_bf16 v[232:235], v[100:103], v[136:139], v[232:235]
 v_mfma_f32_16x16x32_bf16 a[180:183], v[100:103], v[132:135], a[180:183]
 ds_read_b128 v[76:79], v173 offset:7168
 v_mfma_f32_16x16x32_bf16 a[176:179], v[100:103], v[128:131], a[176:179]
 v_mfma_f32_16x16x32_bf16 a[172:175], v[100:103], v[124:127], a[172:175]
 v_mfma_f32_16x16x32_bf16 a[168:171], v[100:103], v[120:123], a[168:171]
 v_mfma_f32_16x16x32_bf16 a[164:167], v[100:103], v[116:119], a[164:167]
 v_mfma_f32_16x16x32_bf16 a[160:163], v[100:103], v[112:115], a[160:163]
 v_mfma_f32_16x16x32_bf16 a[192:195], v[104:107], v[112:115], a[192:195]
 v_mfma_f32_16x16x32_bf16 a[196:199], v[104:107], v[116:119], a[196:199]
 v_mfma_f32_16x16x32_bf16 a[200:203], v[104:107], v[120:123], a[200:203]
 v_mfma_f32_16x16x32_bf16 a[204:207], v[104:107], v[124:127], a[204:207]
 v_mfma_f32_16x16x32_bf16 a[208:211], v[104:107], v[128:131], a[208:211]
 v_mfma_f32_16x16x32_bf16 a[212:215], v[104:107], v[132:135], a[212:215]
 v_mfma_f32_16x16x32_bf16 v[240:243], v[104:107], v[136:139], v[240:243]
 v_mfma_f32_16x16x32_bf16 v[244:247], v[104:107], v[140:143], v[244:247]
 v_mfma_f32_16x16x32_bf16 v[252:255], v[108:111], v[140:143], v[252:255]
 v_mfma_f32_16x16x32_bf16 v[248:251], v[108:111], v[136:139], v[248:251]
 v_mfma_f32_16x16x32_bf16 a[244:247], v[108:111], v[132:135], a[244:247]
 v_mfma_f32_16x16x32_bf16 a[240:243], v[108:111], v[128:131], a[240:243]
 v_mfma_f32_16x16x32_bf16 a[236:239], v[108:111], v[124:127], a[236:239]
 v_mfma_f32_16x16x32_bf16 a[232:235], v[108:111], v[120:123], a[232:235]
 v_mfma_f32_16x16x32_bf16 a[228:231], v[108:111], v[116:119], a[228:231]
 v_mfma_f32_16x16x32_bf16 a[224:227], v[108:111], v[112:115], a[224:227]
 s_waitcnt vmcnt(1) lgkmcnt(0)
 s_barrier
 v_mfma_f32_16x16x32_bf16 a[0:3], v[16:19], v[48:51], a[0:3]
 ds_read_b64_tr_b16 v[80:81], v165 offset:32768
 s_mov_b32 s64, s90
 s_and_b32 s65, s91, 0xffff
 s_mov_b32 s66, 2097152
 s_mov_b32 s67, 0x20000
 s_mov_b32 s52, 0
 buffer_load_dword v3, v1, s[64:67], s52 offen
 v_mfma_f32_16x16x32_bf16 a[4:7], v[16:19], v[52:55], a[4:7]
 ds_read_b64_tr_b16 v[82:83], v165 offset:34816
 v_mfma_f32_16x16x32_bf16 a[8:11], v[16:19], v[56:59], a[8:11]
 v_mfma_f32_16x16x32_bf16 a[12:15], v[16:19], v[60:63], a[12:15]
 ds_read_b128 v[112:115], v173 offset:32768
 v_mfma_f32_16x16x32_bf16 a[16:19], v[16:19], v[64:67], a[16:19]
 v_mfma_f32_16x16x32_bf16 a[20:23], v[16:19], v[68:71], a[20:23]
 ds_read_b64_tr_b16 v[84:85], v167 offset:32768
 v_mfma_f32_16x16x32_bf16 v[192:195], v[16:19], v[72:75], v[192:195]
 v_mfma_f32_16x16x32_bf16 v[196:199], v[16:19], v[76:79], v[196:199]
 ds_read_b64_tr_b16 v[86:87], v167 offset:34816
 v_mfma_f32_16x16x32_bf16 v[204:207], v[20:23], v[76:79], v[204:207]
 v_mfma_f32_16x16x32_bf16 v[200:203], v[20:23], v[72:75], v[200:203]
 ds_read_b128 v[116:119], v173 offset:33792
 v_mfma_f32_16x16x32_bf16 a[52:55], v[20:23], v[68:71], a[52:55]
 v_mfma_f32_16x16x32_bf16 a[48:51], v[20:23], v[64:67], a[48:51]
 ds_read_b64_tr_b16 v[88:89], v169 offset:32768
 v_mfma_f32_16x16x32_bf16 a[44:47], v[20:23], v[60:63], a[44:47]
 ds_read_b64_tr_b16 v[90:91], v169 offset:34816
 v_mfma_f32_16x16x32_bf16 a[40:43], v[20:23], v[56:59], a[40:43]
 v_mfma_f32_16x16x32_bf16 a[36:39], v[20:23], v[52:55], a[36:39]
 ds_read_b128 v[120:123], v173 offset:34816
 v_mfma_f32_16x16x32_bf16 a[32:35], v[20:23], v[48:51], a[32:35]
 v_mfma_f32_16x16x32_bf16 a[64:67], v[24:27], v[48:51], a[64:67]
 ds_read_b64_tr_b16 v[92:93], v171 offset:32768
 v_mfma_f32_16x16x32_bf16 a[68:71], v[24:27], v[52:55], a[68:71]
 v_mfma_f32_16x16x32_bf16 a[72:75], v[24:27], v[56:59], a[72:75]
 ds_read_b64_tr_b16 v[94:95], v171 offset:34816
 v_mfma_f32_16x16x32_bf16 a[76:79], v[24:27], v[60:63], a[76:79]
 v_mfma_f32_16x16x32_bf16 a[80:83], v[24:27], v[64:67], a[80:83]
 ds_read_b128 v[124:127], v173 offset:35840
 v_mfma_f32_16x16x32_bf16 a[84:87], v[24:27], v[68:71], a[84:87]
 v_mfma_f32_16x16x32_bf16 v[208:211], v[24:27], v[72:75], v[208:211]
 ds_read_b64_tr_b16 v[96:97], v165 offset:33792
 v_mfma_f32_16x16x32_bf16 v[212:215], v[24:27], v[76:79], v[212:215]
 ds_read_b64_tr_b16 v[98:99], v165 offset:35840
 v_mfma_f32_16x16x32_bf16 v[220:223], v[28:31], v[76:79], v[220:223]
 v_mfma_f32_16x16x32_bf16 v[216:219], v[28:31], v[72:75], v[216:219]
 ds_read_b128 v[128:131], v173 offset:36864
 v_mfma_f32_16x16x32_bf16 a[116:119], v[28:31], v[68:71], a[116:119]
 v_mfma_f32_16x16x32_bf16 a[112:115], v[28:31], v[64:67], a[112:115]
 ds_read_b64_tr_b16 v[100:101], v167 offset:33792
 v_mfma_f32_16x16x32_bf16 a[108:111], v[28:31], v[60:63], a[108:111]
 v_mfma_f32_16x16x32_bf16 a[104:107], v[28:31], v[56:59], a[104:107]
 ds_read_b64_tr_b16 v[102:103], v167 offset:35840
 v_mfma_f32_16x16x32_bf16 a[100:103], v[28:31], v[52:55], a[100:103]
 v_mfma_f32_16x16x32_bf16 a[96:99], v[28:31], v[48:51], a[96:99]
 ds_read_b128 v[132:135], v173 offset:37888
 v_mfma_f32_16x16x32_bf16 a[128:131], v[32:35], v[48:51], a[128:131]
 v_mfma_f32_16x16x32_bf16 a[132:135], v[32:35], v[52:55], a[132:135]
 ds_read_b64_tr_b16 v[104:105], v169 offset:33792
 v_mfma_f32_16x16x32_bf16 a[136:139], v[32:35], v[56:59], a[136:139]
 ds_read_b64_tr_b16 v[106:107], v169 offset:35840
 v_mfma_f32_16x16x32_bf16 a[140:143], v[32:35], v[60:63], a[140:143]
 v_mfma_f32_16x16x32_bf16 a[144:147], v[32:35], v[64:67], a[144:147]
 ds_read_b128 v[136:139], v173 offset:38912
 v_mfma_f32_16x16x32_bf16 a[148:151], v[32:35], v[68:71], a[148:151]
 v_mfma_f32_16x16x32_bf16 v[224:227], v[32:35], v[72:75], v[224:227]
 ds_read_b64_tr_b16 v[108:109], v171 offset:33792
 v_mfma_f32_16x16x32_bf16 v[228:231], v[32:35], v[76:79], v[228:231]
 v_mfma_f32_16x16x32_bf16 v[236:239], v[36:39], v[76:79], v[236:239]
 ds_read_b64_tr_b16 v[110:111], v171 offset:35840
 v_mfma_f32_16x16x32_bf16 v[232:235], v[36:39], v[72:75], v[232:235]
 v_mfma_f32_16x16x32_bf16 a[180:183], v[36:39], v[68:71], a[180:183]
 ds_read_b128 v[140:143], v173 offset:39936
 v_mfma_f32_16x16x32_bf16 a[176:179], v[36:39], v[64:67], a[176:179]
 v_mfma_f32_16x16x32_bf16 a[172:175], v[36:39], v[60:63], a[172:175]
 v_mfma_f32_16x16x32_bf16 a[168:171], v[36:39], v[56:59], a[168:171]
 v_mfma_f32_16x16x32_bf16 a[164:167], v[36:39], v[52:55], a[164:167]
 v_mfma_f32_16x16x32_bf16 a[160:163], v[36:39], v[48:51], a[160:163]
 v_mfma_f32_16x16x32_bf16 a[192:195], v[40:43], v[48:51], a[192:195]
 v_mfma_f32_16x16x32_bf16 a[196:199], v[40:43], v[52:55], a[196:199]
 v_mfma_f32_16x16x32_bf16 a[200:203], v[40:43], v[56:59], a[200:203]
 v_mfma_f32_16x16x32_bf16 a[204:207], v[40:43], v[60:63], a[204:207]
 v_mfma_f32_16x16x32_bf16 a[208:211], v[40:43], v[64:67], a[208:211]
 v_mfma_f32_16x16x32_bf16 a[212:215], v[40:43], v[68:71], a[212:215]
 v_mfma_f32_16x16x32_bf16 v[240:243], v[40:43], v[72:75], v[240:243]
 v_mfma_f32_16x16x32_bf16 v[244:247], v[40:43], v[76:79], v[244:247]
 v_mfma_f32_16x16x32_bf16 v[252:255], v[44:47], v[76:79], v[252:255]
 v_mfma_f32_16x16x32_bf16 v[248:251], v[44:47], v[72:75], v[248:251]
 v_mfma_f32_16x16x32_bf16 a[244:247], v[44:47], v[68:71], a[244:247]
 v_mfma_f32_16x16x32_bf16 a[240:243], v[44:47], v[64:67], a[240:243]
 v_mfma_f32_16x16x32_bf16 a[236:239], v[44:47], v[60:63], a[236:239]
 v_mfma_f32_16x16x32_bf16 a[232:235], v[44:47], v[56:59], a[232:235]
 v_mfma_f32_16x16x32_bf16 a[228:231], v[44:47], v[52:55], a[228:231]
 v_mfma_f32_16x16x32_bf16 a[224:227], v[44:47], v[48:51], a[224:227]
 s_waitcnt vmcnt(63) lgkmcnt(0)
 s_barrier
 v_mfma_f32_16x16x32_bf16 a[0:3], v[80:83], v[112:115], a[0:3]
 v_mfma_f32_16x16x32_bf16 a[4:7], v[80:83], v[116:119], a[4:7]
 v_mfma_f32_16x16x32_bf16 a[8:11], v[80:83], v[120:123], a[8:11]
 v_mfma_f32_16x16x32_bf16 a[12:15], v[80:83], v[124:127], a[12:15]
 v_mfma_f32_16x16x32_bf16 a[16:19], v[80:83], v[128:131], a[16:19]
 v_mfma_f32_16x16x32_bf16 a[20:23], v[80:83], v[132:135], a[20:23]
 v_mfma_f32_16x16x32_bf16 v[192:195], v[80:83], v[136:139], v[192:195]
 v_mfma_f32_16x16x32_bf16 v[196:199], v[80:83], v[140:143], v[196:199]
 v_mfma_f32_16x16x32_bf16 v[204:207], v[84:87], v[140:143], v[204:207]
 v_mfma_f32_16x16x32_bf16 v[200:203], v[84:87], v[136:139], v[200:203]
 v_mfma_f32_16x16x32_bf16 a[52:55], v[84:87], v[132:135], a[52:55]
 v_mfma_f32_16x16x32_bf16 a[48:51], v[84:87], v[128:131], a[48:51]
 v_mfma_f32_16x16x32_bf16 a[44:47], v[84:87], v[124:127], a[44:47]
 v_mfma_f32_16x16x32_bf16 a[40:43], v[84:87], v[120:123], a[40:43]
 v_mfma_f32_16x16x32_bf16 a[36:39], v[84:87], v[116:119], a[36:39]
 v_mfma_f32_16x16x32_bf16 a[32:35], v[84:87], v[112:115], a[32:35]
 v_mfma_f32_16x16x32_bf16 a[64:67], v[88:91], v[112:115], a[64:67]
 v_mfma_f32_16x16x32_bf16 a[68:71], v[88:91], v[116:119], a[68:71]
 v_mfma_f32_16x16x32_bf16 a[72:75], v[88:91], v[120:123], a[72:75]
 v_mfma_f32_16x16x32_bf16 a[76:79], v[88:91], v[124:127], a[76:79]
 v_mfma_f32_16x16x32_bf16 a[80:83], v[88:91], v[128:131], a[80:83]
 v_mfma_f32_16x16x32_bf16 a[84:87], v[88:91], v[132:135], a[84:87]
 v_mfma_f32_16x16x32_bf16 v[208:211], v[88:91], v[136:139], v[208:211]
 v_mfma_f32_16x16x32_bf16 v[212:215], v[88:91], v[140:143], v[212:215]
 v_mfma_f32_16x16x32_bf16 v[220:223], v[92:95], v[140:143], v[220:223]
 v_mfma_f32_16x16x32_bf16 v[216:219], v[92:95], v[136:139], v[216:219]
 v_mfma_f32_16x16x32_bf16 a[116:119], v[92:95], v[132:135], a[116:119]
 v_mfma_f32_16x16x32_bf16 a[112:115], v[92:95], v[128:131], a[112:115]
 v_mfma_f32_16x16x32_bf16 a[108:111], v[92:95], v[124:127], a[108:111]
 v_mfma_f32_16x16x32_bf16 a[104:107], v[92:95], v[120:123], a[104:107]
 v_mfma_f32_16x16x32_bf16 a[100:103], v[92:95], v[116:119], a[100:103]
 v_mfma_f32_16x16x32_bf16 a[96:99], v[92:95], v[112:115], a[96:99]
 v_mfma_f32_16x16x32_bf16 a[128:131], v[96:99], v[112:115], a[128:131]
 v_mfma_f32_16x16x32_bf16 a[132:135], v[96:99], v[116:119], a[132:135]
 v_mfma_f32_16x16x32_bf16 a[136:139], v[96:99], v[120:123], a[136:139]
 v_mfma_f32_16x16x32_bf16 a[140:143], v[96:99], v[124:127], a[140:143]
 v_mfma_f32_16x16x32_bf16 a[144:147], v[96:99], v[128:131], a[144:147]
 v_mfma_f32_16x16x32_bf16 a[148:151], v[96:99], v[132:135], a[148:151]
 v_mfma_f32_16x16x32_bf16 v[224:227], v[96:99], v[136:139], v[224:227]
 v_mfma_f32_16x16x32_bf16 v[228:231], v[96:99], v[140:143], v[228:231]
 v_mfma_f32_16x16x32_bf16 v[236:239], v[100:103], v[140:143], v[236:239]
 v_mfma_f32_16x16x32_bf16 v[232:235], v[100:103], v[136:139], v[232:235]
 v_mfma_f32_16x16x32_bf16 a[180:183], v[100:103], v[132:135], a[180:183]
 v_mfma_f32_16x16x32_bf16 a[176:179], v[100:103], v[128:131], a[176:179]
 v_mfma_f32_16x16x32_bf16 a[172:175], v[100:103], v[124:127], a[172:175]
 v_mfma_f32_16x16x32_bf16 a[168:171], v[100:103], v[120:123], a[168:171]
 v_mfma_f32_16x16x32_bf16 a[164:167], v[100:103], v[116:119], a[164:167]
 v_mfma_f32_16x16x32_bf16 a[160:163], v[100:103], v[112:115], a[160:163]
 v_mfma_f32_16x16x32_bf16 a[192:195], v[104:107], v[112:115], a[192:195]
 v_mfma_f32_16x16x32_bf16 a[196:199], v[104:107], v[116:119], a[196:199]
 v_mfma_f32_16x16x32_bf16 a[200:203], v[104:107], v[120:123], a[200:203]
 v_mfma_f32_16x16x32_bf16 a[204:207], v[104:107], v[124:127], a[204:207]
 v_mfma_f32_16x16x32_bf16 a[208:211], v[104:107], v[128:131], a[208:211]
 v_mfma_f32_16x16x32_bf16 a[212:215], v[104:107], v[132:135], a[212:215]
 v_mfma_f32_16x16x32_bf16 v[240:243], v[104:107], v[136:139], v[240:243]
 v_mfma_f32_16x16x32_bf16 v[244:247], v[104:107], v[140:143], v[244:247]
 v_mfma_f32_16x16x32_bf16 v[252:255], v[108:111], v[140:143], v[252:255]
 v_mfma_f32_16x16x32_bf16 v[248:251], v[108:111], v[136:139], v[248:251]
 v_mfma_f32_16x16x32_bf16 a[244:247], v[108:111], v[132:135], a[244:247]
 v_mfma_f32_16x16x32_bf16 a[240:243], v[108:111], v[128:131], a[240:243]
 v_mfma_f32_16x16x32_bf16 a[236:239], v[108:111], v[124:127], a[236:239]
 v_mfma_f32_16x16x32_bf16 a[232:235], v[108:111], v[120:123], a[232:235]
 v_mfma_f32_16x16x32_bf16 a[228:231], v[108:111], v[116:119], a[228:231]
 v_mfma_f32_16x16x32_bf16 a[224:227], v[108:111], v[112:115], a[224:227]
 s_nop 15
 s_nop 3
L_gemm1_kernel_sel:
 s_cmp_lt_u32 s22, 4
 s_cbranch_scc0 L_gemm1_kernel_gu
 s_lshl_b32 s52, s21, 3
 s_lshl_b32 s53, s50, 2
 s_add_u32 s52, s52, s53
 s_lshl_b32 s52, s52, 11
 s_lshl_b32 s53, s22, 20
 s_add_u32 s52, s52, s53
 s_lshl_b32 s53, s49, 18
 s_add_u32 s52, s52, s53
 s_add_u32 s52, s52, 4194304
 s_add_u32 s24, s4, s52
 s_addc_u32 s25, s5, 0
 s_and_b32 s25, s25, 0xffff
 s_mov_b32 s26, 786432
 s_mov_b32 s27, 0x20000
 v_lshlrev_b32 v186, 4, v0
 s_mov_b32 s54, 0x3e8293ee
 v_accvgpr_read_b32 v16, a0
 v_accvgpr_read_b32 v17, a1
 v_accvgpr_read_b32 v18, a2
 v_accvgpr_read_b32 v19, a3
 v_accvgpr_read_b32 v20, a32
 v_accvgpr_read_b32 v21, a33
 v_accvgpr_read_b32 v22, a34
 v_accvgpr_read_b32 v23, a35
 v_accvgpr_read_b32 v24, a4
 v_accvgpr_read_b32 v25, a5
 v_accvgpr_read_b32 v26, a6
 v_accvgpr_read_b32 v27, a7
 v_accvgpr_read_b32 v28, a36
 v_accvgpr_read_b32 v29, a37
 v_accvgpr_read_b32 v30, a38
 v_accvgpr_read_b32 v31, a39
 v_mul_f32 v32, s54, v16
 v_mul_f32 v33, s54, v17
 v_mul_f32 v34, s54, v18
 v_mul_f32 v35, s54, v19
 v_mul_f32 v36, s54, v20
 v_mul_f32 v37, s54, v21
 v_mul_f32 v38, s54, v22
 v_mul_f32 v39, s54, v23
 v_mul_f32 v40, s54, v24
 v_mul_f32 v41, s54, v25
 v_mul_f32 v42, s54, v26
 v_mul_f32 v43, s54, v27
 v_mul_f32 v44, s54, v28
 v_mul_f32 v45, s54, v29
 v_mul_f32 v46, s54, v30
 v_mul_f32 v47, s54, v31
 v_cvt_pk_bf16_f32 v64, v32, v33
 v_cvt_pk_bf16_f32 v65, v34, v35
 v_cvt_pk_bf16_f32 v66, v36, v37
 v_cvt_pk_bf16_f32 v67, v38, v39
 v_cvt_pk_bf16_f32 v68, v40, v41
 v_cvt_pk_bf16_f32 v69, v42, v43
 v_cvt_pk_bf16_f32 v70, v44, v45
 v_cvt_pk_bf16_f32 v71, v46, v47
 s_mov_b32 s55, 0
 buffer_store_dwordx4 v[64:67], v186, s[24:27], s55 offen sc1
 buffer_store_dwordx4 v[68:71], v186, s[24:27], s55 offen offset:1024 sc1
 v_accvgpr_read_b32 v16, a64
 v_accvgpr_read_b32 v17, a65
 v_accvgpr_read_b32 v18, a66
 v_accvgpr_read_b32 v19, a67
 v_accvgpr_read_b32 v20, a96
 v_accvgpr_read_b32 v21, a97
 v_accvgpr_read_b32 v22, a98
 v_accvgpr_read_b32 v23, a99
 v_accvgpr_read_b32 v24, a68
 v_accvgpr_read_b32 v25, a69
 v_accvgpr_read_b32 v26, a70
 v_accvgpr_read_b32 v27, a71
 v_accvgpr_read_b32 v28, a100
 v_accvgpr_read_b32 v29, a101
 v_accvgpr_read_b32 v30, a102
 v_accvgpr_read_b32 v31, a103
 v_mul_f32 v32, s54, v16
 v_mul_f32 v33, s54, v17
 v_mul_f32 v34, s54, v18
 v_mul_f32 v35, s54, v19
 v_mul_f32 v36, s54, v20
 v_mul_f32 v37, s54, v21
 v_mul_f32 v38, s54, v22
 v_mul_f32 v39, s54, v23
 v_mul_f32 v40, s54, v24
 v_mul_f32 v41, s54, v25
 v_mul_f32 v42, s54, v26
 v_mul_f32 v43, s54, v27
 v_mul_f32 v44, s54, v28
 v_mul_f32 v45, s54, v29
 v_mul_f32 v46, s54, v30
 v_mul_f32 v47, s54, v31
 v_cvt_pk_bf16_f32 v72, v32, v33
 v_cvt_pk_bf16_f32 v73, v34, v35
 v_cvt_pk_bf16_f32 v74, v36, v37
 v_cvt_pk_bf16_f32 v75, v38, v39
 v_cvt_pk_bf16_f32 v76, v40, v41
 v_cvt_pk_bf16_f32 v77, v42, v43
 v_cvt_pk_bf16_f32 v78, v44, v45
 v_cvt_pk_bf16_f32 v79, v46, v47
 s_mov_b32 s55, 131072
 buffer_store_dwordx4 v[72:75], v186, s[24:27], s55 offen sc1
 buffer_store_dwordx4 v[76:79], v186, s[24:27], s55 offen offset:1024 sc1
 v_accvgpr_read_b32 v16, a128
 v_accvgpr_read_b32 v17, a129
 v_accvgpr_read_b32 v18, a130
 v_accvgpr_read_b32 v19, a131
 v_accvgpr_read_b32 v20, a160
 v_accvgpr_read_b32 v21, a161
 v_accvgpr_read_b32 v22, a162
 v_accvgpr_read_b32 v23, a163
 v_accvgpr_read_b32 v24, a132
 v_accvgpr_read_b32 v25, a133
 v_accvgpr_read_b32 v26, a134
 v_accvgpr_read_b32 v27, a135
 v_accvgpr_read_b32 v28, a164
 v_accvgpr_read_b32 v29, a165
 v_accvgpr_read_b32 v30, a166
 v_accvgpr_read_b32 v31, a167
 v_mul_f32 v32, s54, v16
 v_mul_f32 v33, s54, v17
 v_mul_f32 v34, s54, v18
 v_mul_f32 v35, s54, v19
 v_mul_f32 v36, s54, v20
 v_mul_f32 v37, s54, v21
 v_mul_f32 v38, s54, v22
 v_mul_f32 v39, s54, v23
 v_mul_f32 v40, s54, v24
 v_mul_f32 v41, s54, v25
 v_mul_f32 v42, s54, v26
 v_mul_f32 v43, s54, v27
 v_mul_f32 v44, s54, v28
 v_mul_f32 v45, s54, v29
 v_mul_f32 v46, s54, v30
 v_mul_f32 v47, s54, v31
 v_cvt_pk_bf16_f32 v64, v32, v33
 v_cvt_pk_bf16_f32 v65, v34, v35
 v_cvt_pk_bf16_f32 v66, v36, v37
 v_cvt_pk_bf16_f32 v67, v38, v39
 v_cvt_pk_bf16_f32 v68, v40, v41
 v_cvt_pk_bf16_f32 v69, v42, v43
 v_cvt_pk_bf16_f32 v70, v44, v45
 v_cvt_pk_bf16_f32 v71, v46, v47
 s_mov_b32 s55, 524288
 buffer_store_dwordx4 v[64:67], v186, s[24:27], s55 offen sc1
 buffer_store_dwordx4 v[68:71], v186, s[24:27], s55 offen offset:1024 sc1
 v_accvgpr_read_b32 v16, a192
 v_accvgpr_read_b32 v17, a193
 v_accvgpr_read_b32 v18, a194
 v_accvgpr_read_b32 v19, a195
 v_accvgpr_read_b32 v20, a224
 v_accvgpr_read_b32 v21, a225
 v_accvgpr_read_b32 v22, a226
 v_accvgpr_read_b32 v23, a227
 v_accvgpr_read_b32 v24, a196
 v_accvgpr_read_b32 v25, a197
 v_accvgpr_read_b32 v26, a198
 v_accvgpr_read_b32 v27, a199
 v_accvgpr_read_b32 v28, a228
 v_accvgpr_read_b32 v29, a229
 v_accvgpr_read_b32 v30, a230
 v_accvgpr_read_b32 v31, a231
 v_mul_f32 v32, s54, v16
 v_mul_f32 v33, s54, v17
 v_mul_f32 v34, s54, v18
 v_mul_f32 v35, s54, v19
 v_mul_f32 v36, s54, v20
 v_mul_f32 v37, s54, v21
 v_mul_f32 v38, s54, v22
 v_mul_f32 v39, s54, v23
 v_mul_f32 v40, s54, v24
 v_mul_f32 v41, s54, v25
 v_mul_f32 v42, s54, v26
 v_mul_f32 v43, s54, v27
 v_mul_f32 v44, s54, v28
 v_mul_f32 v45, s54, v29
 v_mul_f32 v46, s54, v30
 v_mul_f32 v47, s54, v31
 v_cvt_pk_bf16_f32 v72, v32, v33
 v_cvt_pk_bf16_f32 v73, v34, v35
 v_cvt_pk_bf16_f32 v74, v36, v37
 v_cvt_pk_bf16_f32 v75, v38, v39
 v_cvt_pk_bf16_f32 v76, v40, v41
 v_cvt_pk_bf16_f32 v77, v42, v43
 v_cvt_pk_bf16_f32 v78, v44, v45
 v_cvt_pk_bf16_f32 v79, v46, v47
 s_mov_b32 s55, 655360
 buffer_store_dwordx4 v[72:75], v186, s[24:27], s55 offen sc1
 buffer_store_dwordx4 v[76:79], v186, s[24:27], s55 offen offset:1024 sc1
 v_accvgpr_read_b32 v16, a8
 v_accvgpr_read_b32 v17, a9
 v_accvgpr_read_b32 v18, a10
 v_accvgpr_read_b32 v19, a11
 v_accvgpr_read_b32 v20, a40
 v_accvgpr_read_b32 v21, a41
 v_accvgpr_read_b32 v22, a42
 v_accvgpr_read_b32 v23, a43
 v_accvgpr_read_b32 v24, a12
 v_accvgpr_read_b32 v25, a13
 v_accvgpr_read_b32 v26, a14
 v_accvgpr_read_b32 v27, a15
 v_accvgpr_read_b32 v28, a44
 v_accvgpr_read_b32 v29, a45
 v_accvgpr_read_b32 v30, a46
 v_accvgpr_read_b32 v31, a47
 v_mul_f32 v32, s54, v16
 v_mul_f32 v33, s54, v17
 v_mul_f32 v34, s54, v18
 v_mul_f32 v35, s54, v19
 v_mul_f32 v36, s54, v20
 v_mul_f32 v37, s54, v21
 v_mul_f32 v38, s54, v22
 v_mul_f32 v39, s54, v23
 v_mul_f32 v40, s54, v24
 v_mul_f32 v41, s54, v25
 v_mul_f32 v42, s54, v26
 v_mul_f32 v43, s54, v27
 v_mul_f32 v44, s54, v28
 v_mul_f32 v45, s54, v29
 v_mul_f32 v46, s54, v30
 v_mul_f32 v47, s54, v31
 v_cvt_pk_bf16_f32 v64, v32, v33
 v_cvt_pk_bf16_f32 v65, v34, v35
 v_cvt_pk_bf16_f32 v66, v36, v37
 v_cvt_pk_bf16_f32 v67, v38, v39
 v_cvt_pk_bf16_f32 v68, v40, v41
 v_cvt_pk_bf16_f32 v69, v42, v43
 v_cvt_pk_bf16_f32 v70, v44, v45
 v_cvt_pk_bf16_f32 v71, v46, v47
 s_mov_b32 s55, 2048
 buffer_store_dwordx4 v[64:67], v186, s[24:27], s55 offen sc1
 buffer_store_dwordx4 v[68:71], v186, s[24:27], s55 offen offset:1024 sc1
 v_accvgpr_read_b32 v16, a72
 v_accvgpr_read_b32 v17, a73
 v_accvgpr_read_b32 v18, a74
 v_accvgpr_read_b32 v19, a75
 v_accvgpr_read_b32 v20, a104
 v_accvgpr_read_b32 v21, a105
 v_accvgpr_read_b32 v22, a106
 v_accvgpr_read_b32 v23, a107
 v_accvgpr_read_b32 v24, a76
 v_accvgpr_read_b32 v25, a77
 v_accvgpr_read_b32 v26, a78
 v_accvgpr_read_b32 v27, a79
 v_accvgpr_read_b32 v28, a108
 v_accvgpr_read_b32 v29, a109
 v_accvgpr_read_b32 v30, a110
 v_accvgpr_read_b32 v31, a111
 v_mul_f32 v32, s54, v16
 v_mul_f32 v33, s54, v17
 v_mul_f32 v34, s54, v18
 v_mul_f32 v35, s54, v19
 v_mul_f32 v36, s54, v20
 v_mul_f32 v37, s54, v21
 v_mul_f32 v38, s54, v22
 v_mul_f32 v39, s54, v23
 v_mul_f32 v40, s54, v24
 v_mul_f32 v41, s54, v25
 v_mul_f32 v42, s54, v26
 v_mul_f32 v43, s54, v27
 v_mul_f32 v44, s54, v28
 v_mul_f32 v45, s54, v29
 v_mul_f32 v46, s54, v30
 v_mul_f32 v47, s54, v31
 v_cvt_pk_bf16_f32 v72, v32, v33
 v_cvt_pk_bf16_f32 v73, v34, v35
 v_cvt_pk_bf16_f32 v74, v36, v37
 v_cvt_pk_bf16_f32 v75, v38, v39
 v_cvt_pk_bf16_f32 v76, v40, v41
 v_cvt_pk_bf16_f32 v77, v42, v43
 v_cvt_pk_bf16_f32 v78, v44, v45
 v_cvt_pk_bf16_f32 v79, v46, v47
 s_mov_b32 s55, 133120
 buffer_store_dwordx4 v[72:75], v186, s[24:27], s55 offen sc1
 buffer_store_dwordx4 v[76:79], v186, s[24:27], s55 offen offset:1024 sc1
 v_accvgpr_read_b32 v16, a136
 v_accvgpr_read_b32 v17, a137
 v_accvgpr_read_b32 v18, a138
 v_accvgpr_read_b32 v19, a139
 v_accvgpr_read_b32 v20, a168
 v_accvgpr_read_b32 v21, a169
 v_accvgpr_read_b32 v22, a170
 v_accvgpr_read_b32 v23, a171
 v_accvgpr_read_b32 v24, a140
 v_accvgpr_read_b32 v25, a141
 v_accvgpr_read_b32 v26, a142
 v_accvgpr_read_b32 v27, a143
 v_accvgpr_read_b32 v28, a172
 v_accvgpr_read_b32 v29, a173
 v_accvgpr_read_b32 v30, a174
 v_accvgpr_read_b32 v31, a175
 v_mul_f32 v32, s54, v16
 v_mul_f32 v33, s54, v17
 v_mul_f32 v34, s54, v18
 v_mul_f32 v35, s54, v19
 v_mul_f32 v36, s54, v20
 v_mul_f32 v37, s54, v21
 v_mul_f32 v38, s54, v22
 v_mul_f32 v39, s54, v23
 v_mul_f32 v40, s54, v24
 v_mul_f32 v41, s54, v25
 v_mul_f32 v42, s54, v26
 v_mul_f32 v43, s54, v27
 v_mul_f32 v44, s54, v28
 v_mul_f32 v45, s54, v29
 v_mul_f32 v46, s54, v30
 v_mul_f32 v47, s54, v31
 v_cvt_pk_bf16_f32 v64, v32, v33
 v_cvt_pk_bf16_f32 v65, v34, v35
 v_cvt_pk_bf16_f32 v66, v36, v37
 v_cvt_pk_bf16_f32 v67, v38, v39
 v_cvt_pk_bf16_f32 v68, v40, v41
 v_cvt_pk_bf16_f32 v69, v42, v43
 v_cvt_pk_bf16_f32 v70, v44, v45
 v_cvt_pk_bf16_f32 v71, v46, v47
 s_mov_b32 s55, 526336
 buffer_store_dwordx4 v[64:67], v186, s[24:27], s55 offen sc1
 buffer_store_dwordx4 v[68:71], v186, s[24:27], s55 offen offset:1024 sc1
 v_accvgpr_read_b32 v16, a200
 v_accvgpr_read_b32 v17, a201
 v_accvgpr_read_b32 v18, a202
 v_accvgpr_read_b32 v19, a203
 v_accvgpr_read_b32 v20, a232
 v_accvgpr_read_b32 v21, a233
 v_accvgpr_read_b32 v22, a234
 v_accvgpr_read_b32 v23, a235
 v_accvgpr_read_b32 v24, a204
 v_accvgpr_read_b32 v25, a205
 v_accvgpr_read_b32 v26, a206
 v_accvgpr_read_b32 v27, a207
 v_accvgpr_read_b32 v28, a236
 v_accvgpr_read_b32 v29, a237
 v_accvgpr_read_b32 v30, a238
 v_accvgpr_read_b32 v31, a239
 v_mul_f32 v32, s54, v16
 v_mul_f32 v33, s54, v17
 v_mul_f32 v34, s54, v18
 v_mul_f32 v35, s54, v19
 v_mul_f32 v36, s54, v20
 v_mul_f32 v37, s54, v21
 v_mul_f32 v38, s54, v22
 v_mul_f32 v39, s54, v23
 v_mul_f32 v40, s54, v24
 v_mul_f32 v41, s54, v25
 v_mul_f32 v42, s54, v26
 v_mul_f32 v43, s54, v27
 v_mul_f32 v44, s54, v28
 v_mul_f32 v45, s54, v29
 v_mul_f32 v46, s54, v30
 v_mul_f32 v47, s54, v31
 v_cvt_pk_bf16_f32 v72, v32, v33
 v_cvt_pk_bf16_f32 v73, v34, v35
 v_cvt_pk_bf16_f32 v74, v36, v37
 v_cvt_pk_bf16_f32 v75, v38, v39
 v_cvt_pk_bf16_f32 v76, v40, v41
 v_cvt_pk_bf16_f32 v77, v42, v43
 v_cvt_pk_bf16_f32 v78, v44, v45
 v_cvt_pk_bf16_f32 v79, v46, v47
 s_mov_b32 s55, 657408
 buffer_store_dwordx4 v[72:75], v186, s[24:27], s55 offen sc1
 buffer_store_dwordx4 v[76:79], v186, s[24:27], s55 offen offset:1024 sc1
 v_accvgpr_read_b32 v16, a16
 v_accvgpr_read_b32 v17, a17
 v_accvgpr_read_b32 v18, a18
 v_accvgpr_read_b32 v19, a19
 v_accvgpr_read_b32 v20, a48
 v_accvgpr_read_b32 v21, a49
 v_accvgpr_read_b32 v22, a50
 v_accvgpr_read_b32 v23, a51
 v_accvgpr_read_b32 v24, a20
 v_accvgpr_read_b32 v25, a21
 v_accvgpr_read_b32 v26, a22
 v_accvgpr_read_b32 v27, a23
 v_accvgpr_read_b32 v28, a52
 v_accvgpr_read_b32 v29, a53
 v_accvgpr_read_b32 v30, a54
 v_accvgpr_read_b32 v31, a55
 v_mul_f32 v32, s54, v16
 v_mul_f32 v33, s54, v17
 v_mul_f32 v34, s54, v18
 v_mul_f32 v35, s54, v19
 v_mul_f32 v36, s54, v20
 v_mul_f32 v37, s54, v21
 v_mul_f32 v38, s54, v22
 v_mul_f32 v39, s54, v23
 v_mul_f32 v40, s54, v24
 v_mul_f32 v41, s54, v25
 v_mul_f32 v42, s54, v26
 v_mul_f32 v43, s54, v27
 v_mul_f32 v44, s54, v28
 v_mul_f32 v45, s54, v29
 v_mul_f32 v46, s54, v30
 v_mul_f32 v47, s54, v31
 v_cvt_pk_bf16_f32 v64, v32, v33
 v_cvt_pk_bf16_f32 v65, v34, v35
 v_cvt_pk_bf16_f32 v66, v36, v37
 v_cvt_pk_bf16_f32 v67, v38, v39
 v_cvt_pk_bf16_f32 v68, v40, v41
 v_cvt_pk_bf16_f32 v69, v42, v43
 v_cvt_pk_bf16_f32 v70, v44, v45
 v_cvt_pk_bf16_f32 v71, v46, v47
 s_mov_b32 s55, 4096
 buffer_store_dwordx4 v[64:67], v186, s[24:27], s55 offen sc1
 buffer_store_dwordx4 v[68:71], v186, s[24:27], s55 offen offset:1024 sc1
 v_accvgpr_read_b32 v16, a80
 v_accvgpr_read_b32 v17, a81
 v_accvgpr_read_b32 v18, a82
 v_accvgpr_read_b32 v19, a83
 v_accvgpr_read_b32 v20, a112
 v_accvgpr_read_b32 v21, a113
 v_accvgpr_read_b32 v22, a114
 v_accvgpr_read_b32 v23, a115
 v_accvgpr_read_b32 v24, a84
 v_accvgpr_read_b32 v25, a85
 v_accvgpr_read_b32 v26, a86
 v_accvgpr_read_b32 v27, a87
 v_accvgpr_read_b32 v28, a116
 v_accvgpr_read_b32 v29, a117
 v_accvgpr_read_b32 v30, a118
 v_accvgpr_read_b32 v31, a119
 v_mul_f32 v32, s54, v16
 v_mul_f32 v33, s54, v17
 v_mul_f32 v34, s54, v18
 v_mul_f32 v35, s54, v19
 v_mul_f32 v36, s54, v20
 v_mul_f32 v37, s54, v21
 v_mul_f32 v38, s54, v22
 v_mul_f32 v39, s54, v23
 v_mul_f32 v40, s54, v24
 v_mul_f32 v41, s54, v25
 v_mul_f32 v42, s54, v26
 v_mul_f32 v43, s54, v27
 v_mul_f32 v44, s54, v28
 v_mul_f32 v45, s54, v29
 v_mul_f32 v46, s54, v30
 v_mul_f32 v47, s54, v31
 v_cvt_pk_bf16_f32 v72, v32, v33
 v_cvt_pk_bf16_f32 v73, v34, v35
 v_cvt_pk_bf16_f32 v74, v36, v37
 v_cvt_pk_bf16_f32 v75, v38, v39
 v_cvt_pk_bf16_f32 v76, v40, v41
 v_cvt_pk_bf16_f32 v77, v42, v43
 v_cvt_pk_bf16_f32 v78, v44, v45
 v_cvt_pk_bf16_f32 v79, v46, v47
 s_mov_b32 s55, 135168
 buffer_store_dwordx4 v[72:75], v186, s[24:27], s55 offen sc1
 buffer_store_dwordx4 v[76:79], v186, s[24:27], s55 offen offset:1024 sc1
 v_accvgpr_read_b32 v16, a144
 v_accvgpr_read_b32 v17, a145
 v_accvgpr_read_b32 v18, a146
 v_accvgpr_read_b32 v19, a147
 v_accvgpr_read_b32 v20, a176
 v_accvgpr_read_b32 v21, a177
 v_accvgpr_read_b32 v22, a178
 v_accvgpr_read_b32 v23, a179
 v_accvgpr_read_b32 v24, a148
 v_accvgpr_read_b32 v25, a149
 v_accvgpr_read_b32 v26, a150
 v_accvgpr_read_b32 v27, a151
 v_accvgpr_read_b32 v28, a180
 v_accvgpr_read_b32 v29, a181
 v_accvgpr_read_b32 v30, a182
 v_accvgpr_read_b32 v31, a183
 v_mul_f32 v32, s54, v16
 v_mul_f32 v33, s54, v17
 v_mul_f32 v34, s54, v18
 v_mul_f32 v35, s54, v19
 v_mul_f32 v36, s54, v20
 v_mul_f32 v37, s54, v21
 v_mul_f32 v38, s54, v22
 v_mul_f32 v39, s54, v23
 v_mul_f32 v40, s54, v24
 v_mul_f32 v41, s54, v25
 v_mul_f32 v42, s54, v26
 v_mul_f32 v43, s54, v27
 v_mul_f32 v44, s54, v28
 v_mul_f32 v45, s54, v29
 v_mul_f32 v46, s54, v30
 v_mul_f32 v47, s54, v31
 v_cvt_pk_bf16_f32 v64, v32, v33
 v_cvt_pk_bf16_f32 v65, v34, v35
 v_cvt_pk_bf16_f32 v66, v36, v37
 v_cvt_pk_bf16_f32 v67, v38, v39
 v_cvt_pk_bf16_f32 v68, v40, v41
 v_cvt_pk_bf16_f32 v69, v42, v43
 v_cvt_pk_bf16_f32 v70, v44, v45
 v_cvt_pk_bf16_f32 v71, v46, v47
 s_mov_b32 s55, 528384
 buffer_store_dwordx4 v[64:67], v186, s[24:27], s55 offen sc1
 buffer_store_dwordx4 v[68:71], v186, s[24:27], s55 offen offset:1024 sc1
 v_accvgpr_read_b32 v16, a208
 v_accvgpr_read_b32 v17, a209
 v_accvgpr_read_b32 v18, a210
 v_accvgpr_read_b32 v19, a211
 v_accvgpr_read_b32 v20, a240
 v_accvgpr_read_b32 v21, a241
 v_accvgpr_read_b32 v22, a242
 v_accvgpr_read_b32 v23, a243
 v_accvgpr_read_b32 v24, a212
 v_accvgpr_read_b32 v25, a213
 v_accvgpr_read_b32 v26, a214
 v_accvgpr_read_b32 v27, a215
 v_accvgpr_read_b32 v28, a244
 v_accvgpr_read_b32 v29, a245
 v_accvgpr_read_b32 v30, a246
 v_accvgpr_read_b32 v31, a247
 v_mul_f32 v32, s54, v16
 v_mul_f32 v33, s54, v17
 v_mul_f32 v34, s54, v18
 v_mul_f32 v35, s54, v19
 v_mul_f32 v36, s54, v20
 v_mul_f32 v37, s54, v21
 v_mul_f32 v38, s54, v22
 v_mul_f32 v39, s54, v23
 v_mul_f32 v40, s54, v24
 v_mul_f32 v41, s54, v25
 v_mul_f32 v42, s54, v26
 v_mul_f32 v43, s54, v27
 v_mul_f32 v44, s54, v28
 v_mul_f32 v45, s54, v29
 v_mul_f32 v46, s54, v30
 v_mul_f32 v47, s54, v31
 v_cvt_pk_bf16_f32 v72, v32, v33
 v_cvt_pk_bf16_f32 v73, v34, v35
 v_cvt_pk_bf16_f32 v74, v36, v37
 v_cvt_pk_bf16_f32 v75, v38, v39
 v_cvt_pk_bf16_f32 v76, v40, v41
 v_cvt_pk_bf16_f32 v77, v42, v43
 v_cvt_pk_bf16_f32 v78, v44, v45
 v_cvt_pk_bf16_f32 v79, v46, v47
 s_mov_b32 s55, 659456
 buffer_store_dwordx4 v[72:75], v186, s[24:27], s55 offen sc1
 buffer_store_dwordx4 v[76:79], v186, s[24:27], s55 offen offset:1024 sc1
 v_mul_f32 v32, s54, v192
 v_mul_f32 v33, s54, v193
 v_mul_f32 v34, s54, v194
 v_mul_f32 v35, s54, v195
 v_mul_f32 v36, s54, v200
 v_mul_f32 v37, s54, v201
 v_mul_f32 v38, s54, v202
 v_mul_f32 v39, s54, v203
 v_mul_f32 v40, s54, v196
 v_mul_f32 v41, s54, v197
 v_mul_f32 v42, s54, v198
 v_mul_f32 v43, s54, v199
 v_mul_f32 v44, s54, v204
 v_mul_f32 v45, s54, v205
 v_mul_f32 v46, s54, v206
 v_mul_f32 v47, s54, v207
 v_cvt_pk_bf16_f32 v64, v32, v33
 v_cvt_pk_bf16_f32 v65, v34, v35
 v_cvt_pk_bf16_f32 v66, v36, v37
 v_cvt_pk_bf16_f32 v67, v38, v39
 v_cvt_pk_bf16_f32 v68, v40, v41
 v_cvt_pk_bf16_f32 v69, v42, v43
 v_cvt_pk_bf16_f32 v70, v44, v45
 v_cvt_pk_bf16_f32 v71, v46, v47
 s_mov_b32 s55, 6144
 buffer_store_dwordx4 v[64:67], v186, s[24:27], s55 offen sc1
 buffer_store_dwordx4 v[68:71], v186, s[24:27], s55 offen offset:1024 sc1
 v_mul_f32 v32, s54, v208
 v_mul_f32 v33, s54, v209
 v_mul_f32 v34, s54, v210
 v_mul_f32 v35, s54, v211
 v_mul_f32 v36, s54, v216
 v_mul_f32 v37, s54, v217
 v_mul_f32 v38, s54, v218
 v_mul_f32 v39, s54, v219
 v_mul_f32 v40, s54, v212
 v_mul_f32 v41, s54, v213
 v_mul_f32 v42, s54, v214
 v_mul_f32 v43, s54, v215
 v_mul_f32 v44, s54, v220
 v_mul_f32 v45, s54, v221
 v_mul_f32 v46, s54, v222
 v_mul_f32 v47, s54, v223
 v_cvt_pk_bf16_f32 v72, v32, v33
 v_cvt_pk_bf16_f32 v73, v34, v35
 v_cvt_pk_bf16_f32 v74, v36, v37
 v_cvt_pk_bf16_f32 v75, v38, v39
 v_cvt_pk_bf16_f32 v76, v40, v41
 v_cvt_pk_bf16_f32 v77, v42, v43
 v_cvt_pk_bf16_f32 v78, v44, v45
 v_cvt_pk_bf16_f32 v79, v46, v47
 s_mov_b32 s55, 137216
 buffer_store_dwordx4 v[72:75], v186, s[24:27], s55 offen sc1
 buffer_store_dwordx4 v[76:79], v186, s[24:27], s55 offen offset:1024 sc1
 v_mul_f32 v32, s54, v224
 v_mul_f32 v33, s54, v225
 v_mul_f32 v34, s54, v226
 v_mul_f32 v35, s54, v227
 v_mul_f32 v36, s54, v232
 v_mul_f32 v37, s54, v233
 v_mul_f32 v38, s54, v234
 v_mul_f32 v39, s54, v235
 v_mul_f32 v40, s54, v228
 v_mul_f32 v41, s54, v229
 v_mul_f32 v42, s54, v230
 v_mul_f32 v43, s54, v231
 v_mul_f32 v44, s54, v236
 v_mul_f32 v45, s54, v237
 v_mul_f32 v46, s54, v238
 v_mul_f32 v47, s54, v239
 v_cvt_pk_bf16_f32 v64, v32, v33
 v_cvt_pk_bf16_f32 v65, v34, v35
 v_cvt_pk_bf16_f32 v66, v36, v37
 v_cvt_pk_bf16_f32 v67, v38, v39
 v_cvt_pk_bf16_f32 v68, v40, v41
 v_cvt_pk_bf16_f32 v69, v42, v43
 v_cvt_pk_bf16_f32 v70, v44, v45
 v_cvt_pk_bf16_f32 v71, v46, v47
 s_mov_b32 s55, 530432
 buffer_store_dwordx4 v[64:67], v186, s[24:27], s55 offen sc1
 buffer_store_dwordx4 v[68:71], v186, s[24:27], s55 offen offset:1024 sc1
 v_mul_f32 v32, s54, v240
 v_mul_f32 v33, s54, v241
 v_mul_f32 v34, s54, v242
 v_mul_f32 v35, s54, v243
 v_mul_f32 v36, s54, v248
 v_mul_f32 v37, s54, v249
 v_mul_f32 v38, s54, v250
 v_mul_f32 v39, s54, v251
 v_mul_f32 v40, s54, v244
 v_mul_f32 v41, s54, v245
 v_mul_f32 v42, s54, v246
 v_mul_f32 v43, s54, v247
 v_mul_f32 v44, s54, v252
 v_mul_f32 v45, s54, v253
 v_mul_f32 v46, s54, v254
 v_mul_f32 v47, s54, v255
 v_cvt_pk_bf16_f32 v72, v32, v33
 v_cvt_pk_bf16_f32 v73, v34, v35
 v_cvt_pk_bf16_f32 v74, v36, v37
 v_cvt_pk_bf16_f32 v75, v38, v39
 v_cvt_pk_bf16_f32 v76, v40, v41
 v_cvt_pk_bf16_f32 v77, v42, v43
 v_cvt_pk_bf16_f32 v78, v44, v45
 v_cvt_pk_bf16_f32 v79, v46, v47
 s_mov_b32 s55, 661504
 buffer_store_dwordx4 v[72:75], v186, s[24:27], s55 offen sc1
 buffer_store_dwordx4 v[76:79], v186, s[24:27], s55 offen offset:1024 sc1
 s_branch L_gemm1_kernel_fin
L_gemm1_kernel_gu:
 s_lshl_b32 s52, s21, 1
 s_add_u32 s52, s52, s50
 s_mul_i32 s52, s52, 1179648
 s_sub_u32 s53, s22, 4
 s_lshl_b32 s53, s53, 12
 s_add_u32 s52, s52, s53
 s_lshl_b32 s53, s49, 11
 s_add_u32 s52, s52, s53
 s_add_u32 s52, s52, 9437184
 s_add_u32 s24, s4, s52
 s_addc_u32 s25, s5, 0
 s_and_b32 s25, s25, 0xffff
 s_mov_b32 s26, 1179648
 s_mov_b32 s27, 0x20000
 v_lshlrev_b32 v186, 4, v0
 s_mov_b32 s54, 0xbfb8aa3b
 s_mov_b32 s56, 0xbfb8aa3b
 s_mov_b32 s57, 0xbfb8aa3b
 s_mov_b32 s58, 1.0
 s_mov_b32 s59, 1.0
 v_accvgpr_read_b32 v16, a0
 v_accvgpr_read_b32 v17, a1
 v_accvgpr_read_b32 v18, a2
 v_accvgpr_read_b32 v19, a3
 v_accvgpr_read_b32 v20, a32
 v_accvgpr_read_b32 v21, a33
 v_accvgpr_read_b32 v22, a34
 v_accvgpr_read_b32 v23, a35
 v_accvgpr_read_b32 v24, a4
 v_accvgpr_read_b32 v25, a5
 v_accvgpr_read_b32 v26, a6
 v_accvgpr_read_b32 v27, a7
 v_accvgpr_read_b32 v28, a36
 v_accvgpr_read_b32 v29, a37
 v_accvgpr_read_b32 v30, a38
 v_accvgpr_read_b32 v31, a39
 v_accvgpr_read_b32 v32, a128
 v_accvgpr_read_b32 v33, a129
 v_accvgpr_read_b32 v34, a130
 v_accvgpr_read_b32 v35, a131
 v_accvgpr_read_b32 v36, a160
 v_accvgpr_read_b32 v37, a161
 v_accvgpr_read_b32 v38, a162
 v_accvgpr_read_b32 v39, a163
 v_accvgpr_read_b32 v40, a132
 v_accvgpr_read_b32 v41, a133
 v_accvgpr_read_b32 v42, a134
 v_accvgpr_read_b32 v43, a135
 v_accvgpr_read_b32 v44, a164
 v_accvgpr_read_b32 v45, a165
 v_accvgpr_read_b32 v46, a166
 v_accvgpr_read_b32 v47, a167
 v_pk_mul_f32 v[48:49], v[16:17], s[56:57]
 v_pk_mul_f32 v[50:51], v[18:19], s[56:57]
 v_pk_mul_f32 v[52:53], v[20:21], s[56:57]
 v_pk_mul_f32 v[54:55], v[22:23], s[56:57]
 v_pk_mul_f32 v[56:57], v[24:25], s[56:57]
 v_pk_mul_f32 v[58:59], v[26:27], s[56:57]
 v_pk_mul_f32 v[60:61], v[28:29], s[56:57]
 v_pk_mul_f32 v[62:63], v[30:31], s[56:57]
 v_exp_f32 v48, v48
 v_exp_f32 v49, v49
 v_exp_f32 v50, v50
 v_exp_f32 v51, v51
 v_exp_f32 v52, v52
 v_exp_f32 v53, v53
 v_exp_f32 v54, v54
 v_exp_f32 v55, v55
 v_exp_f32 v56, v56
 v_exp_f32 v57, v57
 v_exp_f32 v58, v58
 v_exp_f32 v59, v59
 v_exp_f32 v60, v60
 v_exp_f32 v61, v61
 v_exp_f32 v62, v62
 v_exp_f32 v63, v63
 v_pk_mul_f32 v[16:17], v[16:17], v[32:33]
 v_pk_mul_f32 v[18:19], v[18:19], v[34:35]
 v_pk_mul_f32 v[20:21], v[20:21], v[36:37]
 v_pk_mul_f32 v[22:23], v[22:23], v[38:39]
 v_pk_mul_f32 v[24:25], v[24:25], v[40:41]
 v_pk_mul_f32 v[26:27], v[26:27], v[42:43]
 v_pk_mul_f32 v[28:29], v[28:29], v[44:45]
 v_pk_mul_f32 v[30:31], v[30:31], v[46:47]
 v_pk_add_f32 v[48:49], v[48:49], s[58:59]
 v_pk_add_f32 v[50:51], v[50:51], s[58:59]
 v_pk_add_f32 v[52:53], v[52:53], s[58:59]
 v_pk_add_f32 v[54:55], v[54:55], s[58:59]
 v_pk_add_f32 v[56:57], v[56:57], s[58:59]
 v_pk_add_f32 v[58:59], v[58:59], s[58:59]
 v_pk_add_f32 v[60:61], v[60:61], s[58:59]
 v_pk_add_f32 v[62:63], v[62:63], s[58:59]
 v_rcp_f32 v48, v48
 v_rcp_f32 v49, v49
 v_rcp_f32 v50, v50
 v_rcp_f32 v51, v51
 v_rcp_f32 v52, v52
 v_rcp_f32 v53, v53
 v_rcp_f32 v54, v54
 v_rcp_f32 v55, v55
 v_rcp_f32 v56, v56
 v_rcp_f32 v57, v57
 v_rcp_f32 v58, v58
 v_rcp_f32 v59, v59
 v_rcp_f32 v60, v60
 v_rcp_f32 v61, v61
 v_rcp_f32 v62, v62
 v_rcp_f32 v63, v63
 s_nop 0
 v_pk_mul_f32 v[16:17], v[16:17], v[48:49]
 v_pk_mul_f32 v[18:19], v[18:19], v[50:51]
 v_pk_mul_f32 v[20:21], v[20:21], v[52:53]
 v_pk_mul_f32 v[22:23], v[22:23], v[54:55]
 v_pk_mul_f32 v[24:25], v[24:25], v[56:57]
 v_pk_mul_f32 v[26:27], v[26:27], v[58:59]
 v_pk_mul_f32 v[28:29], v[28:29], v[60:61]
 v_pk_mul_f32 v[30:31], v[30:31], v[62:63]
 v_cvt_pk_bf16_f32 v64, v16, v17
 v_cvt_pk_bf16_f32 v65, v18, v19
 v_cvt_pk_bf16_f32 v66, v20, v21
 v_cvt_pk_bf16_f32 v67, v22, v23
 v_cvt_pk_bf16_f32 v68, v24, v25
 v_cvt_pk_bf16_f32 v69, v26, v27
 v_cvt_pk_bf16_f32 v70, v28, v29
 v_cvt_pk_bf16_f32 v71, v30, v31
 s_mov_b32 s55, 0
 buffer_store_dwordx4 v[64:67], v186, s[24:27], s55 offen sc1
 s_mov_b32 s55, 147456
 buffer_store_dwordx4 v[68:71], v186, s[24:27], s55 offen sc1
 v_accvgpr_read_b32 v16, a64
 v_accvgpr_read_b32 v17, a65
 v_accvgpr_read_b32 v18, a66
 v_accvgpr_read_b32 v19, a67
 v_accvgpr_read_b32 v20, a96
 v_accvgpr_read_b32 v21, a97
 v_accvgpr_read_b32 v22, a98
 v_accvgpr_read_b32 v23, a99
 v_accvgpr_read_b32 v24, a68
 v_accvgpr_read_b32 v25, a69
 v_accvgpr_read_b32 v26, a70
 v_accvgpr_read_b32 v27, a71
 v_accvgpr_read_b32 v28, a100
 v_accvgpr_read_b32 v29, a101
 v_accvgpr_read_b32 v30, a102
 v_accvgpr_read_b32 v31, a103
 v_accvgpr_read_b32 v32, a192
 v_accvgpr_read_b32 v33, a193
 v_accvgpr_read_b32 v34, a194
 v_accvgpr_read_b32 v35, a195
 v_accvgpr_read_b32 v36, a224
 v_accvgpr_read_b32 v37, a225
 v_accvgpr_read_b32 v38, a226
 v_accvgpr_read_b32 v39, a227
 v_accvgpr_read_b32 v40, a196
 v_accvgpr_read_b32 v41, a197
 v_accvgpr_read_b32 v42, a198
 v_accvgpr_read_b32 v43, a199
 v_accvgpr_read_b32 v44, a228
 v_accvgpr_read_b32 v45, a229
 v_accvgpr_read_b32 v46, a230
 v_accvgpr_read_b32 v47, a231
 v_pk_mul_f32 v[48:49], v[16:17], s[56:57]
 v_pk_mul_f32 v[50:51], v[18:19], s[56:57]
 v_pk_mul_f32 v[52:53], v[20:21], s[56:57]
 v_pk_mul_f32 v[54:55], v[22:23], s[56:57]
 v_pk_mul_f32 v[56:57], v[24:25], s[56:57]
 v_pk_mul_f32 v[58:59], v[26:27], s[56:57]
 v_pk_mul_f32 v[60:61], v[28:29], s[56:57]
 v_pk_mul_f32 v[62:63], v[30:31], s[56:57]
 v_exp_f32 v48, v48
 v_exp_f32 v49, v49
 v_exp_f32 v50, v50
 v_exp_f32 v51, v51
 v_exp_f32 v52, v52
 v_exp_f32 v53, v53
 v_exp_f32 v54, v54
 v_exp_f32 v55, v55
 v_exp_f32 v56, v56
 v_exp_f32 v57, v57
 v_exp_f32 v58, v58
 v_exp_f32 v59, v59
 v_exp_f32 v60, v60
 v_exp_f32 v61, v61
 v_exp_f32 v62, v62
 v_exp_f32 v63, v63
 v_pk_mul_f32 v[16:17], v[16:17], v[32:33]
 v_pk_mul_f32 v[18:19], v[18:19], v[34:35]
 v_pk_mul_f32 v[20:21], v[20:21], v[36:37]
 v_pk_mul_f32 v[22:23], v[22:23], v[38:39]
 v_pk_mul_f32 v[24:25], v[24:25], v[40:41]
 v_pk_mul_f32 v[26:27], v[26:27], v[42:43]
 v_pk_mul_f32 v[28:29], v[28:29], v[44:45]
 v_pk_mul_f32 v[30:31], v[30:31], v[46:47]
 v_pk_add_f32 v[48:49], v[48:49], s[58:59]
 v_pk_add_f32 v[50:51], v[50:51], s[58:59]
 v_pk_add_f32 v[52:53], v[52:53], s[58:59]
 v_pk_add_f32 v[54:55], v[54:55], s[58:59]
 v_pk_add_f32 v[56:57], v[56:57], s[58:59]
 v_pk_add_f32 v[58:59], v[58:59], s[58:59]
 v_pk_add_f32 v[60:61], v[60:61], s[58:59]
 v_pk_add_f32 v[62:63], v[62:63], s[58:59]
 v_rcp_f32 v48, v48
 v_rcp_f32 v49, v49
 v_rcp_f32 v50, v50
 v_rcp_f32 v51, v51
 v_rcp_f32 v52, v52
 v_rcp_f32 v53, v53
 v_rcp_f32 v54, v54
 v_rcp_f32 v55, v55
 v_rcp_f32 v56, v56
 v_rcp_f32 v57, v57
 v_rcp_f32 v58, v58
 v_rcp_f32 v59, v59
 v_rcp_f32 v60, v60
 v_rcp_f32 v61, v61
 v_rcp_f32 v62, v62
 v_rcp_f32 v63, v63
 s_nop 0
 v_pk_mul_f32 v[16:17], v[16:17], v[48:49]
 v_pk_mul_f32 v[18:19], v[18:19], v[50:51]
 v_pk_mul_f32 v[20:21], v[20:21], v[52:53]
 v_pk_mul_f32 v[22:23], v[22:23], v[54:55]
 v_pk_mul_f32 v[24:25], v[24:25], v[56:57]
 v_pk_mul_f32 v[26:27], v[26:27], v[58:59]
 v_pk_mul_f32 v[28:29], v[28:29], v[60:61]
 v_pk_mul_f32 v[30:31], v[30:31], v[62:63]
 v_cvt_pk_bf16_f32 v72, v16, v17
 v_cvt_pk_bf16_f32 v73, v18, v19
 v_cvt_pk_bf16_f32 v74, v20, v21
 v_cvt_pk_bf16_f32 v75, v22, v23
 v_cvt_pk_bf16_f32 v76, v24, v25
 v_cvt_pk_bf16_f32 v77, v26, v27
 v_cvt_pk_bf16_f32 v78, v28, v29
 v_cvt_pk_bf16_f32 v79, v30, v31
 s_mov_b32 s55, 1024
 buffer_store_dwordx4 v[72:75], v186, s[24:27], s55 offen sc1
 s_mov_b32 s55, 148480
 buffer_store_dwordx4 v[76:79], v186, s[24:27], s55 offen sc1
 v_accvgpr_read_b32 v16, a8
 v_accvgpr_read_b32 v17, a9
 v_accvgpr_read_b32 v18, a10
 v_accvgpr_read_b32 v19, a11
 v_accvgpr_read_b32 v20, a40
 v_accvgpr_read_b32 v21, a41
 v_accvgpr_read_b32 v22, a42
 v_accvgpr_read_b32 v23, a43
 v_accvgpr_read_b32 v24, a12
 v_accvgpr_read_b32 v25, a13
 v_accvgpr_read_b32 v26, a14
 v_accvgpr_read_b32 v27, a15
 v_accvgpr_read_b32 v28, a44
 v_accvgpr_read_b32 v29, a45
 v_accvgpr_read_b32 v30, a46
 v_accvgpr_read_b32 v31, a47
 v_accvgpr_read_b32 v32, a136
 v_accvgpr_read_b32 v33, a137
 v_accvgpr_read_b32 v34, a138
 v_accvgpr_read_b32 v35, a139
 v_accvgpr_read_b32 v36, a168
 v_accvgpr_read_b32 v37, a169
 v_accvgpr_read_b32 v38, a170
 v_accvgpr_read_b32 v39, a171
 v_accvgpr_read_b32 v40, a140
 v_accvgpr_read_b32 v41, a141
 v_accvgpr_read_b32 v42, a142
 v_accvgpr_read_b32 v43, a143
 v_accvgpr_read_b32 v44, a172
 v_accvgpr_read_b32 v45, a173
 v_accvgpr_read_b32 v46, a174
 v_accvgpr_read_b32 v47, a175
 v_pk_mul_f32 v[48:49], v[16:17], s[56:57]
 v_pk_mul_f32 v[50:51], v[18:19], s[56:57]
 v_pk_mul_f32 v[52:53], v[20:21], s[56:57]
 v_pk_mul_f32 v[54:55], v[22:23], s[56:57]
 v_pk_mul_f32 v[56:57], v[24:25], s[56:57]
 v_pk_mul_f32 v[58:59], v[26:27], s[56:57]
 v_pk_mul_f32 v[60:61], v[28:29], s[56:57]
 v_pk_mul_f32 v[62:63], v[30:31], s[56:57]
 v_exp_f32 v48, v48
 v_exp_f32 v49, v49
 v_exp_f32 v50, v50
 v_exp_f32 v51, v51
 v_exp_f32 v52, v52
 v_exp_f32 v53, v53
 v_exp_f32 v54, v54
 v_exp_f32 v55, v55
 v_exp_f32 v56, v56
 v_exp_f32 v57, v57
 v_exp_f32 v58, v58
 v_exp_f32 v59, v59
 v_exp_f32 v60, v60
 v_exp_f32 v61, v61
 v_exp_f32 v62, v62
 v_exp_f32 v63, v63
 v_pk_mul_f32 v[16:17], v[16:17], v[32:33]
 v_pk_mul_f32 v[18:19], v[18:19], v[34:35]
 v_pk_mul_f32 v[20:21], v[20:21], v[36:37]
 v_pk_mul_f32 v[22:23], v[22:23], v[38:39]
 v_pk_mul_f32 v[24:25], v[24:25], v[40:41]
 v_pk_mul_f32 v[26:27], v[26:27], v[42:43]
 v_pk_mul_f32 v[28:29], v[28:29], v[44:45]
 v_pk_mul_f32 v[30:31], v[30:31], v[46:47]
 v_pk_add_f32 v[48:49], v[48:49], s[58:59]
 v_pk_add_f32 v[50:51], v[50:51], s[58:59]
 v_pk_add_f32 v[52:53], v[52:53], s[58:59]
 v_pk_add_f32 v[54:55], v[54:55], s[58:59]
 v_pk_add_f32 v[56:57], v[56:57], s[58:59]
 v_pk_add_f32 v[58:59], v[58:59], s[58:59]
 v_pk_add_f32 v[60:61], v[60:61], s[58:59]
 v_pk_add_f32 v[62:63], v[62:63], s[58:59]
 v_rcp_f32 v48, v48
 v_rcp_f32 v49, v49
 v_rcp_f32 v50, v50
 v_rcp_f32 v51, v51
 v_rcp_f32 v52, v52
 v_rcp_f32 v53, v53
 v_rcp_f32 v54, v54
 v_rcp_f32 v55, v55
 v_rcp_f32 v56, v56
 v_rcp_f32 v57, v57
 v_rcp_f32 v58, v58
 v_rcp_f32 v59, v59
 v_rcp_f32 v60, v60
 v_rcp_f32 v61, v61
 v_rcp_f32 v62, v62
 v_rcp_f32 v63, v63
 s_nop 0
 v_pk_mul_f32 v[16:17], v[16:17], v[48:49]
 v_pk_mul_f32 v[18:19], v[18:19], v[50:51]
 v_pk_mul_f32 v[20:21], v[20:21], v[52:53]
 v_pk_mul_f32 v[22:23], v[22:23], v[54:55]
 v_pk_mul_f32 v[24:25], v[24:25], v[56:57]
 v_pk_mul_f32 v[26:27], v[26:27], v[58:59]
 v_pk_mul_f32 v[28:29], v[28:29], v[60:61]
 v_pk_mul_f32 v[30:31], v[30:31], v[62:63]
 v_cvt_pk_bf16_f32 v64, v16, v17
 v_cvt_pk_bf16_f32 v65, v18, v19
 v_cvt_pk_bf16_f32 v66, v20, v21
 v_cvt_pk_bf16_f32 v67, v22, v23
 v_cvt_pk_bf16_f32 v68, v24, v25
 v_cvt_pk_bf16_f32 v69, v26, v27
 v_cvt_pk_bf16_f32 v70, v28, v29
 v_cvt_pk_bf16_f32 v71, v30, v31
 s_mov_b32 s55, 294912
 buffer_store_dwordx4 v[64:67], v186, s[24:27], s55 offen sc1
 s_mov_b32 s55, 442368
 buffer_store_dwordx4 v[68:71], v186, s[24:27], s55 offen sc1
 v_accvgpr_read_b32 v16, a72
 v_accvgpr_read_b32 v17, a73
 v_accvgpr_read_b32 v18, a74
 v_accvgpr_read_b32 v19, a75
 v_accvgpr_read_b32 v20, a104
 v_accvgpr_read_b32 v21, a105
 v_accvgpr_read_b32 v22, a106
 v_accvgpr_read_b32 v23, a107
 v_accvgpr_read_b32 v24, a76
 v_accvgpr_read_b32 v25, a77
 v_accvgpr_read_b32 v26, a78
 v_accvgpr_read_b32 v27, a79
 v_accvgpr_read_b32 v28, a108
 v_accvgpr_read_b32 v29, a109
 v_accvgpr_read_b32 v30, a110
 v_accvgpr_read_b32 v31, a111
 v_accvgpr_read_b32 v32, a200
 v_accvgpr_read_b32 v33, a201
 v_accvgpr_read_b32 v34, a202
 v_accvgpr_read_b32 v35, a203
 v_accvgpr_read_b32 v36, a232
 v_accvgpr_read_b32 v37, a233
 v_accvgpr_read_b32 v38, a234
 v_accvgpr_read_b32 v39, a235
 v_accvgpr_read_b32 v40, a204
 v_accvgpr_read_b32 v41, a205
 v_accvgpr_read_b32 v42, a206
 v_accvgpr_read_b32 v43, a207
 v_accvgpr_read_b32 v44, a236
 v_accvgpr_read_b32 v45, a237
 v_accvgpr_read_b32 v46, a238
 v_accvgpr_read_b32 v47, a239
 v_pk_mul_f32 v[48:49], v[16:17], s[56:57]
 v_pk_mul_f32 v[50:51], v[18:19], s[56:57]
 v_pk_mul_f32 v[52:53], v[20:21], s[56:57]
 v_pk_mul_f32 v[54:55], v[22:23], s[56:57]
 v_pk_mul_f32 v[56:57], v[24:25], s[56:57]
 v_pk_mul_f32 v[58:59], v[26:27], s[56:57]
 v_pk_mul_f32 v[60:61], v[28:29], s[56:57]
 v_pk_mul_f32 v[62:63], v[30:31], s[56:57]
 v_exp_f32 v48, v48
 v_exp_f32 v49, v49
 v_exp_f32 v50, v50
 v_exp_f32 v51, v51
 v_exp_f32 v52, v52
 v_exp_f32 v53, v53
 v_exp_f32 v54, v54
 v_exp_f32 v55, v55
 v_exp_f32 v56, v56
 v_exp_f32 v57, v57
 v_exp_f32 v58, v58
 v_exp_f32 v59, v59
 v_exp_f32 v60, v60
 v_exp_f32 v61, v61
 v_exp_f32 v62, v62
 v_exp_f32 v63, v63
 v_pk_mul_f32 v[16:17], v[16:17], v[32:33]
 v_pk_mul_f32 v[18:19], v[18:19], v[34:35]
 v_pk_mul_f32 v[20:21], v[20:21], v[36:37]
 v_pk_mul_f32 v[22:23], v[22:23], v[38:39]
 v_pk_mul_f32 v[24:25], v[24:25], v[40:41]
 v_pk_mul_f32 v[26:27], v[26:27], v[42:43]
 v_pk_mul_f32 v[28:29], v[28:29], v[44:45]
 v_pk_mul_f32 v[30:31], v[30:31], v[46:47]
 v_pk_add_f32 v[48:49], v[48:49], s[58:59]
 v_pk_add_f32 v[50:51], v[50:51], s[58:59]
 v_pk_add_f32 v[52:53], v[52:53], s[58:59]
 v_pk_add_f32 v[54:55], v[54:55], s[58:59]
 v_pk_add_f32 v[56:57], v[56:57], s[58:59]
 v_pk_add_f32 v[58:59], v[58:59], s[58:59]
 v_pk_add_f32 v[60:61], v[60:61], s[58:59]
 v_pk_add_f32 v[62:63], v[62:63], s[58:59]
 v_rcp_f32 v48, v48
 v_rcp_f32 v49, v49
 v_rcp_f32 v50, v50
 v_rcp_f32 v51, v51
 v_rcp_f32 v52, v52
 v_rcp_f32 v53, v53
 v_rcp_f32 v54, v54
 v_rcp_f32 v55, v55
 v_rcp_f32 v56, v56
 v_rcp_f32 v57, v57
 v_rcp_f32 v58, v58
 v_rcp_f32 v59, v59
 v_rcp_f32 v60, v60
 v_rcp_f32 v61, v61
 v_rcp_f32 v62, v62
 v_rcp_f32 v63, v63
 s_nop 0
 v_pk_mul_f32 v[16:17], v[16:17], v[48:49]
 v_pk_mul_f32 v[18:19], v[18:19], v[50:51]
 v_pk_mul_f32 v[20:21], v[20:21], v[52:53]
 v_pk_mul_f32 v[22:23], v[22:23], v[54:55]
 v_pk_mul_f32 v[24:25], v[24:25], v[56:57]
 v_pk_mul_f32 v[26:27], v[26:27], v[58:59]
 v_pk_mul_f32 v[28:29], v[28:29], v[60:61]
 v_pk_mul_f32 v[30:31], v[30:31], v[62:63]
 v_cvt_pk_bf16_f32 v72, v16, v17
 v_cvt_pk_bf16_f32 v73, v18, v19
 v_cvt_pk_bf16_f32 v74, v20, v21
 v_cvt_pk_bf16_f32 v75, v22, v23
 v_cvt_pk_bf16_f32 v76, v24, v25
 v_cvt_pk_bf16_f32 v77, v26, v27
 v_cvt_pk_bf16_f32 v78, v28, v29
 v_cvt_pk_bf16_f32 v79, v30, v31
 s_mov_b32 s55, 295936
 buffer_store_dwordx4 v[72:75], v186, s[24:27], s55 offen sc1
 s_mov_b32 s55, 443392
 buffer_store_dwordx4 v[76:79], v186, s[24:27], s55 offen sc1
 v_accvgpr_read_b32 v16, a16
 v_accvgpr_read_b32 v17, a17
 v_accvgpr_read_b32 v18, a18
 v_accvgpr_read_b32 v19, a19
 v_accvgpr_read_b32 v20, a48
 v_accvgpr_read_b32 v21, a49
 v_accvgpr_read_b32 v22, a50
 v_accvgpr_read_b32 v23, a51
 v_accvgpr_read_b32 v24, a20
 v_accvgpr_read_b32 v25, a21
 v_accvgpr_read_b32 v26, a22
 v_accvgpr_read_b32 v27, a23
 v_accvgpr_read_b32 v28, a52
 v_accvgpr_read_b32 v29, a53
 v_accvgpr_read_b32 v30, a54
 v_accvgpr_read_b32 v31, a55
 v_accvgpr_read_b32 v32, a144
 v_accvgpr_read_b32 v33, a145
 v_accvgpr_read_b32 v34, a146
 v_accvgpr_read_b32 v35, a147
 v_accvgpr_read_b32 v36, a176
 v_accvgpr_read_b32 v37, a177
 v_accvgpr_read_b32 v38, a178
 v_accvgpr_read_b32 v39, a179
 v_accvgpr_read_b32 v40, a148
 v_accvgpr_read_b32 v41, a149
 v_accvgpr_read_b32 v42, a150
 v_accvgpr_read_b32 v43, a151
 v_accvgpr_read_b32 v44, a180
 v_accvgpr_read_b32 v45, a181
 v_accvgpr_read_b32 v46, a182
 v_accvgpr_read_b32 v47, a183
 v_pk_mul_f32 v[48:49], v[16:17], s[56:57]
 v_pk_mul_f32 v[50:51], v[18:19], s[56:57]
 v_pk_mul_f32 v[52:53], v[20:21], s[56:57]
 v_pk_mul_f32 v[54:55], v[22:23], s[56:57]
 v_pk_mul_f32 v[56:57], v[24:25], s[56:57]
 v_pk_mul_f32 v[58:59], v[26:27], s[56:57]
 v_pk_mul_f32 v[60:61], v[28:29], s[56:57]
 v_pk_mul_f32 v[62:63], v[30:31], s[56:57]
 v_exp_f32 v48, v48
 v_exp_f32 v49, v49
 v_exp_f32 v50, v50
 v_exp_f32 v51, v51
 v_exp_f32 v52, v52
 v_exp_f32 v53, v53
 v_exp_f32 v54, v54
 v_exp_f32 v55, v55
 v_exp_f32 v56, v56
 v_exp_f32 v57, v57
 v_exp_f32 v58, v58
 v_exp_f32 v59, v59
 v_exp_f32 v60, v60
 v_exp_f32 v61, v61
 v_exp_f32 v62, v62
 v_exp_f32 v63, v63
 v_pk_mul_f32 v[16:17], v[16:17], v[32:33]
 v_pk_mul_f32 v[18:19], v[18:19], v[34:35]
 v_pk_mul_f32 v[20:21], v[20:21], v[36:37]
 v_pk_mul_f32 v[22:23], v[22:23], v[38:39]
 v_pk_mul_f32 v[24:25], v[24:25], v[40:41]
 v_pk_mul_f32 v[26:27], v[26:27], v[42:43]
 v_pk_mul_f32 v[28:29], v[28:29], v[44:45]
 v_pk_mul_f32 v[30:31], v[30:31], v[46:47]
 v_pk_add_f32 v[48:49], v[48:49], s[58:59]
 v_pk_add_f32 v[50:51], v[50:51], s[58:59]
 v_pk_add_f32 v[52:53], v[52:53], s[58:59]
 v_pk_add_f32 v[54:55], v[54:55], s[58:59]
 v_pk_add_f32 v[56:57], v[56:57], s[58:59]
 v_pk_add_f32 v[58:59], v[58:59], s[58:59]
 v_pk_add_f32 v[60:61], v[60:61], s[58:59]
 v_pk_add_f32 v[62:63], v[62:63], s[58:59]
 v_rcp_f32 v48, v48
 v_rcp_f32 v49, v49
 v_rcp_f32 v50, v50
 v_rcp_f32 v51, v51
 v_rcp_f32 v52, v52
 v_rcp_f32 v53, v53
 v_rcp_f32 v54, v54
 v_rcp_f32 v55, v55
 v_rcp_f32 v56, v56
 v_rcp_f32 v57, v57
 v_rcp_f32 v58, v58
 v_rcp_f32 v59, v59
 v_rcp_f32 v60, v60
 v_rcp_f32 v61, v61
 v_rcp_f32 v62, v62
 v_rcp_f32 v63, v63
 s_nop 0
 v_pk_mul_f32 v[16:17], v[16:17], v[48:49]
 v_pk_mul_f32 v[18:19], v[18:19], v[50:51]
 v_pk_mul_f32 v[20:21], v[20:21], v[52:53]
 v_pk_mul_f32 v[22:23], v[22:23], v[54:55]
 v_pk_mul_f32 v[24:25], v[24:25], v[56:57]
 v_pk_mul_f32 v[26:27], v[26:27], v[58:59]
 v_pk_mul_f32 v[28:29], v[28:29], v[60:61]
 v_pk_mul_f32 v[30:31], v[30:31], v[62:63]
 v_cvt_pk_bf16_f32 v64, v16, v17
 v_cvt_pk_bf16_f32 v65, v18, v19
 v_cvt_pk_bf16_f32 v66, v20, v21
 v_cvt_pk_bf16_f32 v67, v22, v23
 v_cvt_pk_bf16_f32 v68, v24, v25
 v_cvt_pk_bf16_f32 v69, v26, v27
 v_cvt_pk_bf16_f32 v70, v28, v29
 v_cvt_pk_bf16_f32 v71, v30, v31
 s_mov_b32 s55, 589824
 buffer_store_dwordx4 v[64:67], v186, s[24:27], s55 offen sc1
 s_mov_b32 s55, 737280
 buffer_store_dwordx4 v[68:71], v186, s[24:27], s55 offen sc1
 v_accvgpr_read_b32 v16, a80
 v_accvgpr_read_b32 v17, a81
 v_accvgpr_read_b32 v18, a82
 v_accvgpr_read_b32 v19, a83
 v_accvgpr_read_b32 v20, a112
 v_accvgpr_read_b32 v21, a113
 v_accvgpr_read_b32 v22, a114
 v_accvgpr_read_b32 v23, a115
 v_accvgpr_read_b32 v24, a84
 v_accvgpr_read_b32 v25, a85
 v_accvgpr_read_b32 v26, a86
 v_accvgpr_read_b32 v27, a87
 v_accvgpr_read_b32 v28, a116
 v_accvgpr_read_b32 v29, a117
 v_accvgpr_read_b32 v30, a118
 v_accvgpr_read_b32 v31, a119
 v_accvgpr_read_b32 v32, a208
 v_accvgpr_read_b32 v33, a209
 v_accvgpr_read_b32 v34, a210
 v_accvgpr_read_b32 v35, a211
 v_accvgpr_read_b32 v36, a240
 v_accvgpr_read_b32 v37, a241
 v_accvgpr_read_b32 v38, a242
 v_accvgpr_read_b32 v39, a243
 v_accvgpr_read_b32 v40, a212
 v_accvgpr_read_b32 v41, a213
 v_accvgpr_read_b32 v42, a214
 v_accvgpr_read_b32 v43, a215
 v_accvgpr_read_b32 v44, a244
 v_accvgpr_read_b32 v45, a245
 v_accvgpr_read_b32 v46, a246
 v_accvgpr_read_b32 v47, a247
 v_pk_mul_f32 v[48:49], v[16:17], s[56:57]
 v_pk_mul_f32 v[50:51], v[18:19], s[56:57]
 v_pk_mul_f32 v[52:53], v[20:21], s[56:57]
 v_pk_mul_f32 v[54:55], v[22:23], s[56:57]
 v_pk_mul_f32 v[56:57], v[24:25], s[56:57]
 v_pk_mul_f32 v[58:59], v[26:27], s[56:57]
 v_pk_mul_f32 v[60:61], v[28:29], s[56:57]
 v_pk_mul_f32 v[62:63], v[30:31], s[56:57]
 v_exp_f32 v48, v48
 v_exp_f32 v49, v49
 v_exp_f32 v50, v50
 v_exp_f32 v51, v51
 v_exp_f32 v52, v52
 v_exp_f32 v53, v53
 v_exp_f32 v54, v54
 v_exp_f32 v55, v55
 v_exp_f32 v56, v56
 v_exp_f32 v57, v57
 v_exp_f32 v58, v58
 v_exp_f32 v59, v59
 v_exp_f32 v60, v60
 v_exp_f32 v61, v61
 v_exp_f32 v62, v62
 v_exp_f32 v63, v63
 v_pk_mul_f32 v[16:17], v[16:17], v[32:33]
 v_pk_mul_f32 v[18:19], v[18:19], v[34:35]
 v_pk_mul_f32 v[20:21], v[20:21], v[36:37]
 v_pk_mul_f32 v[22:23], v[22:23], v[38:39]
 v_pk_mul_f32 v[24:25], v[24:25], v[40:41]
 v_pk_mul_f32 v[26:27], v[26:27], v[42:43]
 v_pk_mul_f32 v[28:29], v[28:29], v[44:45]
 v_pk_mul_f32 v[30:31], v[30:31], v[46:47]
 v_pk_add_f32 v[48:49], v[48:49], s[58:59]
 v_pk_add_f32 v[50:51], v[50:51], s[58:59]
 v_pk_add_f32 v[52:53], v[52:53], s[58:59]
 v_pk_add_f32 v[54:55], v[54:55], s[58:59]
 v_pk_add_f32 v[56:57], v[56:57], s[58:59]
 v_pk_add_f32 v[58:59], v[58:59], s[58:59]
 v_pk_add_f32 v[60:61], v[60:61], s[58:59]
 v_pk_add_f32 v[62:63], v[62:63], s[58:59]
 v_rcp_f32 v48, v48
 v_rcp_f32 v49, v49
 v_rcp_f32 v50, v50
 v_rcp_f32 v51, v51
 v_rcp_f32 v52, v52
 v_rcp_f32 v53, v53
 v_rcp_f32 v54, v54
 v_rcp_f32 v55, v55
 v_rcp_f32 v56, v56
 v_rcp_f32 v57, v57
 v_rcp_f32 v58, v58
 v_rcp_f32 v59, v59
 v_rcp_f32 v60, v60
 v_rcp_f32 v61, v61
 v_rcp_f32 v62, v62
 v_rcp_f32 v63, v63
 s_nop 0
 v_pk_mul_f32 v[16:17], v[16:17], v[48:49]
 v_pk_mul_f32 v[18:19], v[18:19], v[50:51]
 v_pk_mul_f32 v[20:21], v[20:21], v[52:53]
 v_pk_mul_f32 v[22:23], v[22:23], v[54:55]
 v_pk_mul_f32 v[24:25], v[24:25], v[56:57]
 v_pk_mul_f32 v[26:27], v[26:27], v[58:59]
 v_pk_mul_f32 v[28:29], v[28:29], v[60:61]
 v_pk_mul_f32 v[30:31], v[30:31], v[62:63]
 v_cvt_pk_bf16_f32 v72, v16, v17
 v_cvt_pk_bf16_f32 v73, v18, v19
 v_cvt_pk_bf16_f32 v74, v20, v21
 v_cvt_pk_bf16_f32 v75, v22, v23
 v_cvt_pk_bf16_f32 v76, v24, v25
 v_cvt_pk_bf16_f32 v77, v26, v27
 v_cvt_pk_bf16_f32 v78, v28, v29
 v_cvt_pk_bf16_f32 v79, v30, v31
 s_mov_b32 s55, 590848
 buffer_store_dwordx4 v[72:75], v186, s[24:27], s55 offen sc1
 s_mov_b32 s55, 738304
 buffer_store_dwordx4 v[76:79], v186, s[24:27], s55 offen sc1
 v_pk_mul_f32 v[48:49], v[192:193], s[56:57]
 v_pk_mul_f32 v[50:51], v[194:195], s[56:57]
 v_pk_mul_f32 v[52:53], v[200:201], s[56:57]
 v_pk_mul_f32 v[54:55], v[202:203], s[56:57]
 v_pk_mul_f32 v[56:57], v[196:197], s[56:57]
 v_pk_mul_f32 v[58:59], v[198:199], s[56:57]
 v_pk_mul_f32 v[60:61], v[204:205], s[56:57]
 v_pk_mul_f32 v[62:63], v[206:207], s[56:57]
 v_exp_f32 v48, v48
 v_exp_f32 v49, v49
 v_exp_f32 v50, v50
 v_exp_f32 v51, v51
 v_exp_f32 v52, v52
 v_exp_f32 v53, v53
 v_exp_f32 v54, v54
 v_exp_f32 v55, v55
 v_exp_f32 v56, v56
 v_exp_f32 v57, v57
 v_exp_f32 v58, v58
 v_exp_f32 v59, v59
 v_exp_f32 v60, v60
 v_exp_f32 v61, v61
 v_exp_f32 v62, v62
 v_exp_f32 v63, v63
 v_pk_mul_f32 v[192:193], v[192:193], v[224:225]
 v_pk_mul_f32 v[194:195], v[194:195], v[226:227]
 v_pk_mul_f32 v[200:201], v[200:201], v[232:233]
 v_pk_mul_f32 v[202:203], v[202:203], v[234:235]
 v_pk_mul_f32 v[196:197], v[196:197], v[228:229]
 v_pk_mul_f32 v[198:199], v[198:199], v[230:231]
 v_pk_mul_f32 v[204:205], v[204:205], v[236:237]
 v_pk_mul_f32 v[206:207], v[206:207], v[238:239]
 v_pk_add_f32 v[48:49], v[48:49], s[58:59]
 v_pk_add_f32 v[50:51], v[50:51], s[58:59]
 v_pk_add_f32 v[52:53], v[52:53], s[58:59]
 v_pk_add_f32 v[54:55], v[54:55], s[58:59]
 v_pk_add_f32 v[56:57], v[56:57], s[58:59]
 v_pk_add_f32 v[58:59], v[58:59], s[58:59]
 v_pk_add_f32 v[60:61], v[60:61], s[58:59]
 v_pk_add_f32 v[62:63], v[62:63], s[58:59]
 v_rcp_f32 v48, v48
 v_rcp_f32 v49, v49
 v_rcp_f32 v50, v50
 v_rcp_f32 v51, v51
 v_rcp_f32 v52, v52
 v_rcp_f32 v53, v53
 v_rcp_f32 v54, v54
 v_rcp_f32 v55, v55
 v_rcp_f32 v56, v56
 v_rcp_f32 v57, v57
 v_rcp_f32 v58, v58
 v_rcp_f32 v59, v59
 v_rcp_f32 v60, v60
 v_rcp_f32 v61, v61
 v_rcp_f32 v62, v62
 v_rcp_f32 v63, v63
 s_nop 0
 v_pk_mul_f32 v[192:193], v[192:193], v[48:49]
 v_pk_mul_f32 v[194:195], v[194:195], v[50:51]
 v_pk_mul_f32 v[200:201], v[200:201], v[52:53]
 v_pk_mul_f32 v[202:203], v[202:203], v[54:55]
 v_pk_mul_f32 v[196:197], v[196:197], v[56:57]
 v_pk_mul_f32 v[198:199], v[198:199], v[58:59]
 v_pk_mul_f32 v[204:205], v[204:205], v[60:61]
 v_pk_mul_f32 v[206:207], v[206:207], v[62:63]
 v_cvt_pk_bf16_f32 v64, v192, v193
 v_cvt_pk_bf16_f32 v65, v194, v195
 v_cvt_pk_bf16_f32 v66, v200, v201
 v_cvt_pk_bf16_f32 v67, v202, v203
 v_cvt_pk_bf16_f32 v68, v196, v197
 v_cvt_pk_bf16_f32 v69, v198, v199
 v_cvt_pk_bf16_f32 v70, v204, v205
 v_cvt_pk_bf16_f32 v71, v206, v207
 s_mov_b32 s55, 884736
 buffer_store_dwordx4 v[64:67], v186, s[24:27], s55 offen sc1
 s_mov_b32 s55, 1032192
 buffer_store_dwordx4 v[68:71], v186, s[24:27], s55 offen sc1
 v_pk_mul_f32 v[48:49], v[208:209], s[56:57]
 v_pk_mul_f32 v[50:51], v[210:211], s[56:57]
 v_pk_mul_f32 v[52:53], v[216:217], s[56:57]
 v_pk_mul_f32 v[54:55], v[218:219], s[56:57]
 v_pk_mul_f32 v[56:57], v[212:213], s[56:57]
 v_pk_mul_f32 v[58:59], v[214:215], s[56:57]
 v_pk_mul_f32 v[60:61], v[220:221], s[56:57]
 v_pk_mul_f32 v[62:63], v[222:223], s[56:57]
 v_exp_f32 v48, v48
 v_exp_f32 v49, v49
 v_exp_f32 v50, v50
 v_exp_f32 v51, v51
 v_exp_f32 v52, v52
 v_exp_f32 v53, v53
 v_exp_f32 v54, v54
 v_exp_f32 v55, v55
 v_exp_f32 v56, v56
 v_exp_f32 v57, v57
 v_exp_f32 v58, v58
 v_exp_f32 v59, v59
 v_exp_f32 v60, v60
 v_exp_f32 v61, v61
 v_exp_f32 v62, v62
 v_exp_f32 v63, v63
 v_pk_mul_f32 v[208:209], v[208:209], v[240:241]
 v_pk_mul_f32 v[210:211], v[210:211], v[242:243]
 v_pk_mul_f32 v[216:217], v[216:217], v[248:249]
 v_pk_mul_f32 v[218:219], v[218:219], v[250:251]
 v_pk_mul_f32 v[212:213], v[212:213], v[244:245]
 v_pk_mul_f32 v[214:215], v[214:215], v[246:247]
 v_pk_mul_f32 v[220:221], v[220:221], v[252:253]
 v_pk_mul_f32 v[222:223], v[222:223], v[254:255]
 v_pk_add_f32 v[48:49], v[48:49], s[58:59]
 v_pk_add_f32 v[50:51], v[50:51], s[58:59]
 v_pk_add_f32 v[52:53], v[52:53], s[58:59]
 v_pk_add_f32 v[54:55], v[54:55], s[58:59]
 v_pk_add_f32 v[56:57], v[56:57], s[58:59]
 v_pk_add_f32 v[58:59], v[58:59], s[58:59]
 v_pk_add_f32 v[60:61], v[60:61], s[58:59]
 v_pk_add_f32 v[62:63], v[62:63], s[58:59]
 v_rcp_f32 v48, v48
 v_rcp_f32 v49, v49
 v_rcp_f32 v50, v50
 v_rcp_f32 v51, v51
 v_rcp_f32 v52, v52
 v_rcp_f32 v53, v53
 v_rcp_f32 v54, v54
 v_rcp_f32 v55, v55
 v_rcp_f32 v56, v56
 v_rcp_f32 v57, v57
 v_rcp_f32 v58, v58
 v_rcp_f32 v59, v59
 v_rcp_f32 v60, v60
 v_rcp_f32 v61, v61
 v_rcp_f32 v62, v62
 v_rcp_f32 v63, v63
 s_nop 0
 v_pk_mul_f32 v[208:209], v[208:209], v[48:49]
 v_pk_mul_f32 v[210:211], v[210:211], v[50:51]
 v_pk_mul_f32 v[216:217], v[216:217], v[52:53]
 v_pk_mul_f32 v[218:219], v[218:219], v[54:55]
 v_pk_mul_f32 v[212:213], v[212:213], v[56:57]
 v_pk_mul_f32 v[214:215], v[214:215], v[58:59]
 v_pk_mul_f32 v[220:221], v[220:221], v[60:61]
 v_pk_mul_f32 v[222:223], v[222:223], v[62:63]
 v_cvt_pk_bf16_f32 v72, v208, v209
 v_cvt_pk_bf16_f32 v73, v210, v211
 v_cvt_pk_bf16_f32 v74, v216, v217
 v_cvt_pk_bf16_f32 v75, v218, v219
 v_cvt_pk_bf16_f32 v76, v212, v213
 v_cvt_pk_bf16_f32 v77, v214, v215
 v_cvt_pk_bf16_f32 v78, v220, v221
 v_cvt_pk_bf16_f32 v79, v222, v223
 s_mov_b32 s55, 885760
 buffer_store_dwordx4 v[72:75], v186, s[24:27], s55 offen sc1
 s_mov_b32 s55, 1033216
 buffer_store_dwordx4 v[76:79], v186, s[24:27], s55 offen sc1
L_gemm1_kernel_fin:
L_gemm1_kernel_end:
 s_endpgm
.globl fused_kernel
.p2align 8
.type fused_kernel,@function
fused_kernel:

 s_cmp_ge_u32 s2, 256
 s_cbranch_scc1 L_fused_kernel_end
 s_load_dwordx2 s[4:5], s[0:1], 88
 s_load_dwordx2 s[6:7], s[0:1], 0
 s_load_dwordx2 s[8:9], s[0:1], 32
 s_load_dwordx4 s[12:15], s[0:1], 64
 s_load_dwordx2 s[16:17], s[0:1], 80
 v_lshrrev_b32 v1, 6, v0
 v_and_b32 v2, 255, v0
 v_and_b32 v0, 63, v0
 v_readfirstlane_b32 s20, v1
 s_and_b32 s52, s2, 7
 s_lshr_b32 s53, s2, 3
 s_lshl_b32 s21, s52, 2
 s_lshr_b32 s54, s53, 3
 s_add_u32 s21, s21, s54
 s_and_b32 s22, s53, 7
 s_cmp_ge_u32 s20, 4
 s_cbranch_scc1 L_fused_kernel_gemm
 s_setprio 1
 v_lshlrev_b32 v188, 4, v0
 s_waitcnt lgkmcnt(0)
 s_add_u32 s18, s4, 8912896
 s_addc_u32 s19, s5, 0
 s_add_u32 s24, s4, 8388608
 s_addc_u32 s25, s5, 0
 s_and_b32 s25, s25, 0xffff
 s_mov_b32 s26, 262144
 s_mov_b32 s27, 0x20000
 s_lshl_b32 s52, s22, 2
 s_and_b32 s53, s20, 2
 s_add_u32 s56, s52, s53
 s_lshl_b32 s53, s21, 1
 s_and_b32 s54, s20, 1
 s_add_u32 s57, s53, s54
 s_lshl_b32 s52, s56, 17
 s_lshl_b32 s53, s57, 11
 s_add_u32 s52, s52, s53
 s_add_u32 s52, s52, 4194304
 s_add_u32 s28, s4, s52
 s_addc_u32 s29, s5, 0
 s_and_b32 s29, s29, 0xffff
 s_mov_b32 s30, 133120
 s_mov_b32 s31, 0x20000
 s_mul_i32 s52, s57, 294912
 s_lshl_b32 s53, s56, 10
 s_add_u32 s52, s52, s53
 s_add_u32 s52, s52, 9551872
 s_add_u32 s32, s4, s52
 s_addc_u32 s33, s5, 0
 s_and_b32 s33, s33, 0xffff
 s_mov_b32 s34, 294912
 s_mov_b32 s35, 0x20000
 s_lshl_b32 s36, s20, 11
 s_lshl_b32 s37, s20, 11
 s_mov_b32 s52, 0
 buffer_load_dwordx4 v[128:131], v188, s[28:31], s52 offen
 s_mov_b32 s52, 1024
 buffer_load_dwordx4 v[132:135], v188, s[28:31], s52 offen
 s_mov_b32 s52, 131072
 buffer_load_dwordx4 v[136:139], v188, s[28:31], s52 offen
 s_mov_b32 s52, 132096
 buffer_load_dwordx4 v[140:143], v188, s[28:31], s52 offen
 s_add_u32 m0, s37, 0
 s_nop 0
 buffer_load_dwordx4 v188, s[24:27], s36 offen offset:0 lds
 buffer_load_dwordx4 v188, s[24:27], s36 offen offset:1024 lds
 s_add_u32 s36, s36, 8192
 s_add_u32 m0, s37, 8192
 s_nop 0
 buffer_load_dwordx4 v188, s[24:27], s36 offen offset:0 lds
 buffer_load_dwordx4 v188, s[24:27], s36 offen offset:1024 lds
 s_add_u32 s36, s36, 8192
 v_mov_b32 v176, 0x3f803f80
 v_mov_b32 v177, 0x3f803f80
 v_mov_b32 v178, 0x3f803f80
 v_mov_b32 v179, 0x3f803f80
 v_mov_b32 v64, 0
 v_mov_b32 v65, 0
 v_mov_b32 v66, 0
 v_mov_b32 v67, 0
 v_mov_b32 v68, 0
 v_mov_b32 v69, 0
 v_mov_b32 v70, 0
 v_mov_b32 v71, 0
 v_mov_b32 v96, 0
 v_mov_b32 v97, 0
 v_mov_b32 v98, 0
 v_mov_b32 v99, 0
 v_mov_b32 v72, 0
 v_mov_b32 v73, 0
 v_mov_b32 v74, 0
 v_mov_b32 v75, 0
 v_mov_b32 v76, 0
 v_mov_b32 v77, 0
 v_mov_b32 v78, 0
 v_mov_b32 v79, 0
 v_mov_b32 v100, 0
 v_mov_b32 v101, 0
 v_mov_b32 v102, 0
 v_mov_b32 v103, 0
 v_mov_b32 v80, 0
 v_mov_b32 v81, 0
 v_mov_b32 v82, 0
 v_mov_b32 v83, 0
 v_mov_b32 v84, 0
 v_mov_b32 v85, 0
 v_mov_b32 v86, 0
 v_mov_b32 v87, 0
 v_mov_b32 v104, 0
 v_mov_b32 v105, 0
 v_mov_b32 v106, 0
 v_mov_b32 v107, 0
 v_mov_b32 v88, 0
 v_mov_b32 v89, 0
 v_mov_b32 v90, 0
 v_mov_b32 v91, 0
 v_mov_b32 v92, 0
 v_mov_b32 v93, 0
 v_mov_b32 v94, 0
 v_mov_b32 v95, 0
 v_mov_b32 v108, 0
 v_mov_b32 v109, 0
 v_mov_b32 v110, 0
 v_mov_b32 v111, 0
 s_waitcnt vmcnt(2)
 s_barrier
 ds_read_b128 v[144:147], v188 offset:0
 ds_read_b128 v[148:151], v188 offset:1024
 ds_read_b128 v[160:163], v188 offset:2048
 ds_read_b128 v[164:167], v188 offset:3072
 s_waitcnt lgkmcnt(0)
 v_mfma_f32_16x16x32_bf16 v[16:19], v[144:147], v[128:131], 0
 v_mfma_f32_16x16x32_bf16 v[20:23], v[148:151], v[128:131], 0
 v_mfma_f32_16x16x32_bf16 v[24:27], v[144:147], v[132:135], 0
 v_mfma_f32_16x16x32_bf16 v[28:31], v[148:151], v[132:135], 0
 v_mfma_f32_16x16x32_bf16 v[32:35], v[144:147], v[136:139], 0
 v_mfma_f32_16x16x32_bf16 v[36:39], v[148:151], v[136:139], 0
 v_mfma_f32_16x16x32_bf16 v[40:43], v[144:147], v[140:143], 0
 v_mfma_f32_16x16x32_bf16 v[44:47], v[148:151], v[140:143], 0
 s_nop 7
 s_nop 1
 v_max3_f32 v180, v16, v17, v18
 v_max3_f32 v180, v180, v19, v20
 v_max3_f32 v180, v180, v21, v22
 v_max_f32 v180, v180, v23
 v_max3_f32 v181, v24, v25, v26
 v_max3_f32 v181, v181, v27, v28
 v_max3_f32 v181, v181, v29, v30
 v_max_f32 v181, v181, v31
 v_max3_f32 v182, v32, v33, v34
 v_max3_f32 v182, v182, v35, v36
 v_max3_f32 v182, v182, v37, v38
 v_max_f32 v182, v182, v39
 v_max3_f32 v183, v40, v41, v42
 v_max3_f32 v183, v183, v43, v44
 v_max3_f32 v183, v183, v45, v46
 v_max_f32 v183, v183, v47
 v_mov_b32 v184, v180
 v_mov_b32 v185, v181
 v_mov_b32 v186, v182
 v_mov_b32 v187, v183
 s_nop 1
 v_permlane16_swap_b32 v184, v180
 v_permlane16_swap_b32 v185, v181
 v_permlane16_swap_b32 v186, v182
 v_permlane16_swap_b32 v187, v183
 s_nop 1
 v_max_f32 v180, v180, v184
 v_max_f32 v181, v181, v185
 v_max_f32 v182, v182, v186
 v_max_f32 v183, v183, v187
 v_mov_b32 v184, v180
 v_mov_b32 v185, v181
 v_mov_b32 v186, v182
 v_mov_b32 v187, v183
 s_nop 1
 v_permlane32_swap_b32 v184, v180
 v_permlane32_swap_b32 v185, v181
 v_permlane32_swap_b32 v186, v182
 v_permlane32_swap_b32 v187, v183
 s_nop 1
 v_max_f32 v180, v180, v184
 v_max_f32 v181, v181, v185
 v_max_f32 v182, v182, v186
 v_max_f32 v183, v183, v187
 v_sub_f32 v112, 0, v180
 v_sub_f32 v113, 0, v180
 v_sub_f32 v114, 0, v180
 v_sub_f32 v115, 0, v180
 v_sub_f32 v116, 0, v181
 v_sub_f32 v117, 0, v181
 v_sub_f32 v118, 0, v181
 v_sub_f32 v119, 0, v181
 v_sub_f32 v120, 0, v182
 v_sub_f32 v121, 0, v182
 v_sub_f32 v122, 0, v182
 v_sub_f32 v123, 0, v182
 v_sub_f32 v124, 0, v183
 v_sub_f32 v125, 0, v183
 v_sub_f32 v126, 0, v183
 v_sub_f32 v127, 0, v183
 s_nop 1
 v_mfma_f32_16x16x32_bf16 v[16:19], v[144:147], v[128:131], v[112:115]
 v_mfma_f32_16x16x32_bf16 v[20:23], v[148:151], v[128:131], v[112:115]
 v_mfma_f32_16x16x32_bf16 v[24:27], v[144:147], v[132:135], v[116:119]
 v_mfma_f32_16x16x32_bf16 v[28:31], v[148:151], v[132:135], v[116:119]
 s_nop 7
 s_mov_b32 s23, 0
 v_mov_b32 v56, 0
 v_mov_b32 v57, 0
 v_mov_b32 v58, 0
 v_mov_b32 v59, 0
 v_mov_b32 v60, 0
 v_mov_b32 v61, 0
 v_mov_b32 v62, 0
 v_mov_b32 v63, 0
 v_mov_b32 v168, 0
 v_mov_b32 v169, 0
 v_mov_b32 v170, 0
 v_mov_b32 v171, 0
 v_mov_b32 v172, 0
 v_mov_b32 v173, 0
 v_mov_b32 v174, 0
 v_mov_b32 v175, 0
.p2align 6
L_fused_kernel_aloop:
 v_mfma_f32_16x16x32_bf16 v[32:35], v[144:147], v[136:139], v[120:123]
 ds_read_b128 v[152:155], v188 offset:4096
 v_exp_f32 v16, v16
 v_exp_f32 v17, v17
 v_mfma_f32_16x16x32_bf16 v[36:39], v[148:151], v[136:139], v[120:123]
 ds_read_b128 v[156:159], v188 offset:5120
 v_exp_f32 v18, v18
 v_exp_f32 v19, v19
 v_mfma_f32_16x16x32_bf16 v[40:43], v[144:147], v[140:143], v[124:127]
 v_exp_f32 v20, v20
 v_cvt_pk_bf16_f32 v48, v16, v17
 v_exp_f32 v21, v21
 v_mfma_f32_16x16x32_bf16 v[44:47], v[148:151], v[140:143], v[124:127]
 v_cvt_pk_bf16_f32 v49, v18, v19
 v_exp_f32 v22, v22
 v_exp_f32 v23, v23
 v_mfma_f32_16x16x32_bf16 v[80:83], v[168:171], v[56:59], v[80:83]
 v_exp_f32 v24, v24
 v_cvt_pk_bf16_f32 v50, v20, v21
 v_cvt_pk_bf16_f32 v51, v22, v23
 v_mfma_f32_16x16x32_bf16 v[84:87], v[172:175], v[56:59], v[84:87]
 v_exp_f32 v25, v25
 v_exp_f32 v26, v26
 v_mfma_f32_16x16x32_bf16 v[104:107], v[176:179], v[56:59], v[104:107]
 v_exp_f32 v27, v27
 v_cvt_pk_bf16_f32 v52, v24, v25
 v_mfma_f32_16x16x32_bf16 v[88:91], v[168:171], v[60:63], v[88:91]
 v_exp_f32 v28, v28
 v_exp_f32 v29, v29
 v_cvt_pk_bf16_f32 v53, v26, v27
 v_mfma_f32_16x16x32_bf16 v[92:95], v[172:175], v[60:63], v[92:95]
 s_waitcnt lgkmcnt(0)
 v_exp_f32 v30, v30
 v_exp_f32 v31, v31
 v_mfma_f32_16x16x32_bf16 v[108:111], v[176:179], v[60:63], v[108:111]
 v_cvt_pk_bf16_f32 v54, v28, v29
 v_cvt_pk_bf16_f32 v55, v30, v31
 v_mfma_f32_16x16x32_bf16 v[16:19], v[152:155], v[128:131], v[112:115]
 ds_read_b128 v[168:171], v188 offset:6144
 v_exp_f32 v32, v32
 v_exp_f32 v33, v33
 v_mfma_f32_16x16x32_bf16 v[20:23], v[156:159], v[128:131], v[112:115]
 ds_read_b128 v[172:175], v188 offset:7168
 v_exp_f32 v34, v34
 v_exp_f32 v35, v35
 v_mfma_f32_16x16x32_bf16 v[24:27], v[152:155], v[132:135], v[116:119]
 v_exp_f32 v36, v36
 v_cvt_pk_bf16_f32 v56, v32, v33
 v_exp_f32 v37, v37
 v_mfma_f32_16x16x32_bf16 v[28:31], v[156:159], v[132:135], v[116:119]
 v_cvt_pk_bf16_f32 v57, v34, v35
 v_exp_f32 v38, v38
 v_exp_f32 v39, v39
 v_mfma_f32_16x16x32_bf16 v[64:67], v[160:163], v[48:51], v[64:67]
 v_exp_f32 v40, v40
 v_cvt_pk_bf16_f32 v58, v36, v37
 v_cvt_pk_bf16_f32 v59, v38, v39
 v_mfma_f32_16x16x32_bf16 v[68:71], v[164:167], v[48:51], v[68:71]
 v_exp_f32 v41, v41
 v_exp_f32 v42, v42
 v_mfma_f32_16x16x32_bf16 v[96:99], v[176:179], v[48:51], v[96:99]
 v_exp_f32 v43, v43
 v_cvt_pk_bf16_f32 v60, v40, v41
 v_mfma_f32_16x16x32_bf16 v[72:75], v[160:163], v[52:55], v[72:75]
 v_exp_f32 v44, v44
 v_exp_f32 v45, v45
 v_cvt_pk_bf16_f32 v61, v42, v43
 v_mfma_f32_16x16x32_bf16 v[76:79], v[164:167], v[52:55], v[76:79]
 s_waitcnt lgkmcnt(0)
 v_exp_f32 v46, v46
 v_exp_f32 v47, v47
 v_mfma_f32_16x16x32_bf16 v[100:103], v[176:179], v[52:55], v[100:103]
 v_cvt_pk_bf16_f32 v62, v44, v45
 v_cvt_pk_bf16_f32 v63, v46, v47
 v_mfma_f32_16x16x32_bf16 v[32:35], v[152:155], v[136:139], v[120:123]
 s_waitcnt vmcnt(0)
 s_barrier
 v_exp_f32 v16, v16
 v_exp_f32 v17, v17
 v_mfma_f32_16x16x32_bf16 v[36:39], v[156:159], v[136:139], v[120:123]
 ds_read_b128 v[144:147], v188 offset:8192
 v_exp_f32 v18, v18
 v_exp_f32 v19, v19
 v_mfma_f32_16x16x32_bf16 v[40:43], v[152:155], v[140:143], v[124:127]
 ds_read_b128 v[148:151], v188 offset:9216
 v_exp_f32 v20, v20
 v_cvt_pk_bf16_f32 v48, v16, v17
 v_exp_f32 v21, v21
 v_mfma_f32_16x16x32_bf16 v[44:47], v[156:159], v[140:143], v[124:127]
 v_cvt_pk_bf16_f32 v49, v18, v19
 v_exp_f32 v22, v22
 v_exp_f32 v23, v23
 v_mfma_f32_16x16x32_bf16 v[80:83], v[160:163], v[56:59], v[80:83]
 s_add_u32 m0, s37, 0
 v_exp_f32 v24, v24
 v_cvt_pk_bf16_f32 v50, v20, v21
 v_cvt_pk_bf16_f32 v51, v22, v23
 v_mfma_f32_16x16x32_bf16 v[84:87], v[164:167], v[56:59], v[84:87]
 v_exp_f32 v25, v25
 v_exp_f32 v26, v26
 v_mfma_f32_16x16x32_bf16 v[104:107], v[176:179], v[56:59], v[104:107]
 buffer_load_dwordx4 v188, s[24:27], s36 offen offset:0 lds
 v_exp_f32 v27, v27
 v_cvt_pk_bf16_f32 v52, v24, v25
 v_mfma_f32_16x16x32_bf16 v[88:91], v[160:163], v[60:63], v[88:91]
 v_exp_f32 v28, v28
 v_exp_f32 v29, v29
 v_cvt_pk_bf16_f32 v53, v26, v27
 v_mfma_f32_16x16x32_bf16 v[92:95], v[164:167], v[60:63], v[92:95]
 s_waitcnt lgkmcnt(0)
 v_exp_f32 v30, v30
 v_exp_f32 v31, v31
 v_mfma_f32_16x16x32_bf16 v[108:111], v[176:179], v[60:63], v[108:111]
 v_cvt_pk_bf16_f32 v54, v28, v29
 v_cvt_pk_bf16_f32 v55, v30, v31
 v_mfma_f32_16x16x32_bf16 v[16:19], v[144:147], v[128:131], v[112:115]
 ds_read_b128 v[160:163], v188 offset:10240
 v_exp_f32 v32, v32
 v_exp_f32 v33, v33
 v_mfma_f32_16x16x32_bf16 v[20:23], v[148:151], v[128:131], v[112:115]
 ds_read_b128 v[164:167], v188 offset:11264
 v_exp_f32 v34, v34
 v_exp_f32 v35, v35
 v_mfma_f32_16x16x32_bf16 v[24:27], v[144:147], v[132:135], v[116:119]
 v_exp_f32 v36, v36
 v_cvt_pk_bf16_f32 v56, v32, v33
 v_exp_f32 v37, v37
 v_mfma_f32_16x16x32_bf16 v[28:31], v[148:151], v[132:135], v[116:119]
 buffer_load_dwordx4 v188, s[24:27], s36 offen offset:1024 lds
 s_add_u32 s36, s36, 8192
 v_cvt_pk_bf16_f32 v57, v34, v35
 v_exp_f32 v38, v38
 v_exp_f32 v39, v39
 v_mfma_f32_16x16x32_bf16 v[64:67], v[168:171], v[48:51], v[64:67]
 v_exp_f32 v40, v40
 v_cvt_pk_bf16_f32 v58, v36, v37
 v_cvt_pk_bf16_f32 v59, v38, v39
 v_mfma_f32_16x16x32_bf16 v[68:71], v[172:175], v[48:51], v[68:71]
 v_exp_f32 v41, v41
 v_exp_f32 v42, v42
 v_mfma_f32_16x16x32_bf16 v[96:99], v[176:179], v[48:51], v[96:99]
 v_exp_f32 v43, v43
 v_cvt_pk_bf16_f32 v60, v40, v41
 v_mfma_f32_16x16x32_bf16 v[72:75], v[168:171], v[52:55], v[72:75]
 v_exp_f32 v44, v44
 v_exp_f32 v45, v45
 v_cvt_pk_bf16_f32 v61, v42, v43
 v_mfma_f32_16x16x32_bf16 v[76:79], v[172:175], v[52:55], v[76:79]
 s_waitcnt lgkmcnt(0)
 v_exp_f32 v46, v46
 v_exp_f32 v47, v47
 v_mfma_f32_16x16x32_bf16 v[100:103], v[176:179], v[52:55], v[100:103]
 v_cvt_pk_bf16_f32 v62, v44, v45
 v_cvt_pk_bf16_f32 v63, v46, v47
 v_mfma_f32_16x16x32_bf16 v[32:35], v[144:147], v[136:139], v[120:123]
 ds_read_b128 v[152:155], v188 offset:12288
 v_exp_f32 v16, v16
 v_exp_f32 v17, v17
 v_mfma_f32_16x16x32_bf16 v[36:39], v[148:151], v[136:139], v[120:123]
 ds_read_b128 v[156:159], v188 offset:13312
 v_exp_f32 v18, v18
 v_exp_f32 v19, v19
 v_mfma_f32_16x16x32_bf16 v[40:43], v[144:147], v[140:143], v[124:127]
 v_exp_f32 v20, v20
 v_cvt_pk_bf16_f32 v48, v16, v17
 v_exp_f32 v21, v21
 v_mfma_f32_16x16x32_bf16 v[44:47], v[148:151], v[140:143], v[124:127]
 v_cvt_pk_bf16_f32 v49, v18, v19
 v_exp_f32 v22, v22
 v_exp_f32 v23, v23
 v_mfma_f32_16x16x32_bf16 v[80:83], v[168:171], v[56:59], v[80:83]
 v_exp_f32 v24, v24
 v_cvt_pk_bf16_f32 v50, v20, v21
 v_cvt_pk_bf16_f32 v51, v22, v23
 v_mfma_f32_16x16x32_bf16 v[84:87], v[172:175], v[56:59], v[84:87]
 v_exp_f32 v25, v25
 v_exp_f32 v26, v26
 v_mfma_f32_16x16x32_bf16 v[104:107], v[176:179], v[56:59], v[104:107]
 v_exp_f32 v27, v27
 v_cvt_pk_bf16_f32 v52, v24, v25
 v_mfma_f32_16x16x32_bf16 v[88:91], v[168:171], v[60:63], v[88:91]
 v_exp_f32 v28, v28
 v_exp_f32 v29, v29
 v_cvt_pk_bf16_f32 v53, v26, v27
 v_mfma_f32_16x16x32_bf16 v[92:95], v[172:175], v[60:63], v[92:95]
 s_waitcnt lgkmcnt(0)
 v_exp_f32 v30, v30
 v_exp_f32 v31, v31
 v_mfma_f32_16x16x32_bf16 v[108:111], v[176:179], v[60:63], v[108:111]
 v_cvt_pk_bf16_f32 v54, v28, v29
 v_cvt_pk_bf16_f32 v55, v30, v31
 v_mfma_f32_16x16x32_bf16 v[16:19], v[152:155], v[128:131], v[112:115]
 ds_read_b128 v[168:171], v188 offset:14336
 v_exp_f32 v32, v32
 v_exp_f32 v33, v33
 v_mfma_f32_16x16x32_bf16 v[20:23], v[156:159], v[128:131], v[112:115]
 ds_read_b128 v[172:175], v188 offset:15360
 v_exp_f32 v34, v34
 v_exp_f32 v35, v35
 v_mfma_f32_16x16x32_bf16 v[24:27], v[152:155], v[132:135], v[116:119]
 v_exp_f32 v36, v36
 v_cvt_pk_bf16_f32 v56, v32, v33
 v_exp_f32 v37, v37
 v_mfma_f32_16x16x32_bf16 v[28:31], v[156:159], v[132:135], v[116:119]
 v_cvt_pk_bf16_f32 v57, v34, v35
 v_exp_f32 v38, v38
 v_exp_f32 v39, v39
 v_mfma_f32_16x16x32_bf16 v[64:67], v[160:163], v[48:51], v[64:67]
 v_exp_f32 v40, v40
 v_cvt_pk_bf16_f32 v58, v36, v37
 v_cvt_pk_bf16_f32 v59, v38, v39
 v_mfma_f32_16x16x32_bf16 v[68:71], v[164:167], v[48:51], v[68:71]
 v_exp_f32 v41, v41
 v_exp_f32 v42, v42
 v_mfma_f32_16x16x32_bf16 v[96:99], v[176:179], v[48:51], v[96:99]
 v_exp_f32 v43, v43
 v_cvt_pk_bf16_f32 v60, v40, v41
 v_mfma_f32_16x16x32_bf16 v[72:75], v[160:163], v[52:55], v[72:75]
 v_exp_f32 v44, v44
 v_exp_f32 v45, v45
 v_cvt_pk_bf16_f32 v61, v42, v43
 v_mfma_f32_16x16x32_bf16 v[76:79], v[164:167], v[52:55], v[76:79]
 s_waitcnt lgkmcnt(0)
 v_exp_f32 v46, v46
 v_exp_f32 v47, v47
 v_mfma_f32_16x16x32_bf16 v[100:103], v[176:179], v[52:55], v[100:103]
 v_cvt_pk_bf16_f32 v62, v44, v45
 v_cvt_pk_bf16_f32 v63, v46, v47
 v_mfma_f32_16x16x32_bf16 v[32:35], v[152:155], v[136:139], v[120:123]
 s_waitcnt vmcnt(0)
 s_barrier
 v_exp_f32 v16, v16
 v_exp_f32 v17, v17
 v_mfma_f32_16x16x32_bf16 v[36:39], v[156:159], v[136:139], v[120:123]
 ds_read_b128 v[144:147], v188 offset:0
 v_exp_f32 v18, v18
 v_exp_f32 v19, v19
 v_mfma_f32_16x16x32_bf16 v[40:43], v[152:155], v[140:143], v[124:127]
 ds_read_b128 v[148:151], v188 offset:1024
 v_exp_f32 v20, v20
 v_cvt_pk_bf16_f32 v48, v16, v17
 v_exp_f32 v21, v21
 v_mfma_f32_16x16x32_bf16 v[44:47], v[156:159], v[140:143], v[124:127]
 v_cvt_pk_bf16_f32 v49, v18, v19
 v_exp_f32 v22, v22
 v_exp_f32 v23, v23
 v_mfma_f32_16x16x32_bf16 v[80:83], v[160:163], v[56:59], v[80:83]
 s_add_u32 m0, s37, 8192
 v_exp_f32 v24, v24
 v_cvt_pk_bf16_f32 v50, v20, v21
 v_cvt_pk_bf16_f32 v51, v22, v23
 v_mfma_f32_16x16x32_bf16 v[84:87], v[164:167], v[56:59], v[84:87]
 v_exp_f32 v25, v25
 v_exp_f32 v26, v26
 v_mfma_f32_16x16x32_bf16 v[104:107], v[176:179], v[56:59], v[104:107]
 buffer_load_dwordx4 v188, s[24:27], s36 offen offset:0 lds
 v_exp_f32 v27, v27
 v_cvt_pk_bf16_f32 v52, v24, v25
 v_mfma_f32_16x16x32_bf16 v[88:91], v[160:163], v[60:63], v[88:91]
 v_exp_f32 v28, v28
 v_exp_f32 v29, v29
 v_cvt_pk_bf16_f32 v53, v26, v27
 v_mfma_f32_16x16x32_bf16 v[92:95], v[164:167], v[60:63], v[92:95]
 s_waitcnt lgkmcnt(0)
 v_exp_f32 v30, v30
 v_exp_f32 v31, v31
 v_mfma_f32_16x16x32_bf16 v[108:111], v[176:179], v[60:63], v[108:111]
 v_cvt_pk_bf16_f32 v54, v28, v29
 v_cvt_pk_bf16_f32 v55, v30, v31
 v_mfma_f32_16x16x32_bf16 v[16:19], v[144:147], v[128:131], v[112:115]
 ds_read_b128 v[160:163], v188 offset:2048
 v_exp_f32 v32, v32
 v_exp_f32 v33, v33
 v_mfma_f32_16x16x32_bf16 v[20:23], v[148:151], v[128:131], v[112:115]
 ds_read_b128 v[164:167], v188 offset:3072
 v_exp_f32 v34, v34
 v_exp_f32 v35, v35
 v_mfma_f32_16x16x32_bf16 v[24:27], v[144:147], v[132:135], v[116:119]
 v_exp_f32 v36, v36
 v_cvt_pk_bf16_f32 v56, v32, v33
 v_exp_f32 v37, v37
 v_mfma_f32_16x16x32_bf16 v[28:31], v[148:151], v[132:135], v[116:119]
 buffer_load_dwordx4 v188, s[24:27], s36 offen offset:1024 lds
 s_add_u32 s36, s36, 8192
 v_cvt_pk_bf16_f32 v57, v34, v35
 v_exp_f32 v38, v38
 v_exp_f32 v39, v39
 v_mfma_f32_16x16x32_bf16 v[64:67], v[168:171], v[48:51], v[64:67]
 v_exp_f32 v40, v40
 v_cvt_pk_bf16_f32 v58, v36, v37
 v_cvt_pk_bf16_f32 v59, v38, v39
 v_mfma_f32_16x16x32_bf16 v[68:71], v[172:175], v[48:51], v[68:71]
 v_exp_f32 v41, v41
 v_exp_f32 v42, v42
 v_mfma_f32_16x16x32_bf16 v[96:99], v[176:179], v[48:51], v[96:99]
 v_exp_f32 v43, v43
 v_cvt_pk_bf16_f32 v60, v40, v41
 v_mfma_f32_16x16x32_bf16 v[72:75], v[168:171], v[52:55], v[72:75]
 v_exp_f32 v44, v44
 v_exp_f32 v45, v45
 v_cvt_pk_bf16_f32 v61, v42, v43
 v_mfma_f32_16x16x32_bf16 v[76:79], v[172:175], v[52:55], v[76:79]
 s_waitcnt lgkmcnt(0)
 v_exp_f32 v46, v46
 v_exp_f32 v47, v47
 v_mfma_f32_16x16x32_bf16 v[100:103], v[176:179], v[52:55], v[100:103]
 v_cvt_pk_bf16_f32 v62, v44, v45
 v_cvt_pk_bf16_f32 v63, v46, v47
 s_add_u32 s23, s23, 1
 s_cmp_lt_u32 s23, 16
 s_cbranch_scc1 L_fused_kernel_aloop
 s_nop 1
 v_mfma_f32_16x16x32_bf16 v[80:83], v[168:171], v[56:59], v[80:83]
 v_mfma_f32_16x16x32_bf16 v[84:87], v[172:175], v[56:59], v[84:87]
 v_mfma_f32_16x16x32_bf16 v[88:91], v[168:171], v[60:63], v[88:91]
 v_mfma_f32_16x16x32_bf16 v[92:95], v[172:175], v[60:63], v[92:95]
 v_mfma_f32_16x16x32_bf16 v[104:107], v[176:179], v[56:59], v[104:107]
 v_mfma_f32_16x16x32_bf16 v[108:111], v[176:179], v[60:63], v[108:111]
 s_nop 7
 s_nop 1
 v_rcp_f32 v180, v96
 v_rcp_f32 v181, v100
 v_rcp_f32 v182, v104
 v_rcp_f32 v183, v108
 s_nop 0
 v_mul_f32 v64, v64, v180
 v_mul_f32 v65, v65, v180
 v_mul_f32 v66, v66, v180
 v_mul_f32 v67, v67, v180
 v_mul_f32 v68, v68, v180
 v_mul_f32 v69, v69, v180
 v_mul_f32 v70, v70, v180
 v_mul_f32 v71, v71, v180
 v_cvt_pk_bf16_f32 v48, v64, v65
 v_cvt_pk_bf16_f32 v49, v66, v67
 v_cvt_pk_bf16_f32 v50, v68, v69
 v_cvt_pk_bf16_f32 v51, v70, v71
 s_mov_b32 s54, 0
 buffer_store_dwordx4 v[48:51], v188, s[32:35], s54 offen sc1
 v_mul_f32 v72, v72, v181
 v_mul_f32 v73, v73, v181
 v_mul_f32 v74, v74, v181
 v_mul_f32 v75, v75, v181
 v_mul_f32 v76, v76, v181
 v_mul_f32 v77, v77, v181
 v_mul_f32 v78, v78, v181
 v_mul_f32 v79, v79, v181
 v_cvt_pk_bf16_f32 v52, v72, v73
 v_cvt_pk_bf16_f32 v53, v74, v75
 v_cvt_pk_bf16_f32 v54, v76, v77
 v_cvt_pk_bf16_f32 v55, v78, v79
 s_mov_b32 s54, 147456
 buffer_store_dwordx4 v[52:55], v188, s[32:35], s54 offen sc1
 v_mul_f32 v80, v80, v182
 v_mul_f32 v81, v81, v182
 v_mul_f32 v82, v82, v182
 v_mul_f32 v83, v83, v182
 v_mul_f32 v84, v84, v182
 v_mul_f32 v85, v85, v182
 v_mul_f32 v86, v86, v182
 v_mul_f32 v87, v87, v182
 v_cvt_pk_bf16_f32 v56, v80, v81
 v_cvt_pk_bf16_f32 v57, v82, v83
 v_cvt_pk_bf16_f32 v58, v84, v85
 v_cvt_pk_bf16_f32 v59, v86, v87
 s_mov_b32 s54, 1024
 buffer_store_dwordx4 v[56:59], v188, s[32:35], s54 offen sc1
 v_mul_f32 v88, v88, v183
 v_mul_f32 v89, v89, v183
 v_mul_f32 v90, v90, v183
 v_mul_f32 v91, v91, v183
 v_mul_f32 v92, v92, v183
 v_mul_f32 v93, v93, v183
 v_mul_f32 v94, v94, v183
 v_mul_f32 v95, v95, v183
 v_cvt_pk_bf16_f32 v60, v88, v89
 v_cvt_pk_bf16_f32 v61, v90, v91
 v_cvt_pk_bf16_f32 v62, v92, v93
 v_cvt_pk_bf16_f32 v63, v94, v95
 s_mov_b32 s54, 148480
 buffer_store_dwordx4 v[60:63], v188, s[32:35], s54 offen sc1
 v_mov_b32 v184, 0x71800000
 v_mov_b32 v186, 0x7f800000
 s_mov_b64 s[62:63], 0
 v_cmp_nlt_f32 vcc, v96, v184
 v_add_f32 v185, v64, v65
 s_or_b64 s[62:63], s[62:63], vcc
 v_add_f32 v185, v185, v66
 v_add_f32 v185, v185, v67
 v_add_f32 v185, v185, v68
 v_add_f32 v185, v185, v69
 v_add_f32 v185, v185, v70
 v_add_f32 v185, v185, v71
 v_cmp_nlt_f32 vcc, |v185|, v186
 s_nop 1
 s_or_b64 s[62:63], s[62:63], vcc
 v_cmp_nlt_f32 vcc, v100, v184
 v_add_f32 v185, v72, v73
 s_or_b64 s[62:63], s[62:63], vcc
 v_add_f32 v185, v185, v74
 v_add_f32 v185, v185, v75
 v_add_f32 v185, v185, v76
 v_add_f32 v185, v185, v77
 v_add_f32 v185, v185, v78
 v_add_f32 v185, v185, v79
 v_cmp_nlt_f32 vcc, |v185|, v186
 s_nop 1
 s_or_b64 s[62:63], s[62:63], vcc
 v_cmp_nlt_f32 vcc, v104, v184
 v_add_f32 v185, v80, v81
 s_or_b64 s[62:63], s[62:63], vcc
 v_add_f32 v185, v185, v82
 v_add_f32 v185, v185, v83
 v_add_f32 v185, v185, v84
 v_add_f32 v185, v185, v85
 v_add_f32 v185, v185, v86
 v_add_f32 v185, v185, v87
 v_cmp_nlt_f32 vcc, |v185|, v186
 s_nop 1
 s_or_b64 s[62:63], s[62:63], vcc
 v_cmp_nlt_f32 vcc, v108, v184
 v_add_f32 v185, v88, v89
 s_or_b64 s[62:63], s[62:63], vcc
 v_add_f32 v185, v185, v90
 v_add_f32 v185, v185, v91
 v_add_f32 v185, v185, v92
 v_add_f32 v185, v185, v93
 v_add_f32 v185, v185, v94
 v_add_f32 v185, v185, v95
 v_cmp_nlt_f32 vcc, |v185|, v186
 s_nop 1
 s_or_b64 s[62:63], s[62:63], vcc
 s_cmp_lg_u64 s[62:63], 0
 s_cbranch_scc1 L_fused_kernel_slow
L_fused_kernel_apub:
 s_waitcnt vmcnt(0)
 s_barrier
 s_cmp_lg_u32 s20, 0
 s_cbranch_scc1 L_fused_kernel_adone
 s_lshl_b32 s52, s21, 8
 v_mov_b32 v180, s52
 v_mov_b32 v181, 1
 s_mov_b64 exec, 1
 global_atomic_add v180, v181, s[18:19] sc1
 s_mov_b64 exec, -1
L_fused_kernel_adone:
 s_endpgm
L_fused_kernel_slow:
 s_waitcnt vmcnt(0)
 v_mov_b32 v180, 0xff800000
 v_mov_b32 v181, 0xff800000
 v_mov_b32 v182, 0xff800000
 v_mov_b32 v183, 0xff800000
 s_mov_b32 s36, 0
L_fused_kernel_slow1:
 buffer_load_dwordx4 v[144:147], v188, s[24:27], s36 offen offset:0
 buffer_load_dwordx4 v[148:151], v188, s[24:27], s36 offen offset:1024
 s_waitcnt vmcnt(0)
 v_mfma_f32_16x16x32_bf16 v[16:19], v[144:147], v[128:131], 0
 v_mfma_f32_16x16x32_bf16 v[20:23], v[148:151], v[128:131], 0
 v_mfma_f32_16x16x32_bf16 v[24:27], v[144:147], v[132:135], 0
 v_mfma_f32_16x16x32_bf16 v[28:31], v[148:151], v[132:135], 0
 v_mfma_f32_16x16x32_bf16 v[32:35], v[144:147], v[136:139], 0
 v_mfma_f32_16x16x32_bf16 v[36:39], v[148:151], v[136:139], 0
 v_mfma_f32_16x16x32_bf16 v[40:43], v[144:147], v[140:143], 0
 v_mfma_f32_16x16x32_bf16 v[44:47], v[148:151], v[140:143], 0
 s_nop 7
 s_nop 1
 v_max3_f32 v180, v180, v16, v17
 v_max3_f32 v180, v180, v18, v19
 v_max3_f32 v180, v180, v20, v21
 v_max3_f32 v180, v180, v22, v23
 v_max3_f32 v181, v181, v24, v25
 v_max3_f32 v181, v181, v26, v27
 v_max3_f32 v181, v181, v28, v29
 v_max3_f32 v181, v181, v30, v31
 v_max3_f32 v182, v182, v32, v33
 v_max3_f32 v182, v182, v34, v35
 v_max3_f32 v182, v182, v36, v37
 v_max3_f32 v182, v182, v38, v39
 v_max3_f32 v183, v183, v40, v41
 v_max3_f32 v183, v183, v42, v43
 v_max3_f32 v183, v183, v44, v45
 v_max3_f32 v183, v183, v46, v47
 s_add_u32 s36, s36, 4096
 s_cmp_lt_u32 s36, 262144
 s_cbranch_scc1 L_fused_kernel_slow1
 v_mov_b32 v184, v180
 v_mov_b32 v185, v181
 v_mov_b32 v186, v182
 v_mov_b32 v187, v183
 s_nop 1
 v_permlane16_swap_b32 v184, v180
 v_permlane16_swap_b32 v185, v181
 v_permlane16_swap_b32 v186, v182
 v_permlane16_swap_b32 v187, v183
 s_nop 1
 v_max_f32 v180, v180, v184
 v_max_f32 v181, v181, v185
 v_max_f32 v182, v182, v186
 v_max_f32 v183, v183, v187
 v_mov_b32 v184, v180
 v_mov_b32 v185, v181
 v_mov_b32 v186, v182
 v_mov_b32 v187, v183
 s_nop 1
 v_permlane32_swap_b32 v184, v180
 v_permlane32_swap_b32 v185, v181
 v_permlane32_swap_b32 v186, v182
 v_permlane32_swap_b32 v187, v183
 s_nop 1
 v_max_f32 v180, v180, v184
 v_max_f32 v181, v181, v185
 v_max_f32 v182, v182, v186
 v_max_f32 v183, v183, v187
 v_sub_f32 v112, 0, v180
 v_sub_f32 v113, 0, v180
 v_sub_f32 v114, 0, v180
 v_sub_f32 v115, 0, v180
 v_sub_f32 v116, 0, v181
 v_sub_f32 v117, 0, v181
 v_sub_f32 v118, 0, v181
 v_sub_f32 v119, 0, v181
 v_sub_f32 v120, 0, v182
 v_sub_f32 v121, 0, v182
 v_sub_f32 v122, 0, v182
 v_sub_f32 v123, 0, v182
 v_sub_f32 v124, 0, v183
 v_sub_f32 v125, 0, v183
 v_sub_f32 v126, 0, v183
 v_sub_f32 v127, 0, v183
 v_mov_b32 v64, 0
 v_mov_b32 v65, 0
 v_mov_b32 v66, 0
 v_mov_b32 v67, 0
 v_mov_b32 v68, 0
 v_mov_b32 v69, 0
 v_mov_b32 v70, 0
 v_mov_b32 v71, 0
 v_mov_b32 v96, 0
 v_mov_b32 v97, 0
 v_mov_b32 v98, 0
 v_mov_b32 v99, 0
 v_mov_b32 v72, 0
 v_mov_b32 v73, 0
 v_mov_b32 v74, 0
 v_mov_b32 v75, 0
 v_mov_b32 v76, 0
 v_mov_b32 v77, 0
 v_mov_b32 v78, 0
 v_mov_b32 v79, 0
 v_mov_b32 v100, 0
 v_mov_b32 v101, 0
 v_mov_b32 v102, 0
 v_mov_b32 v103, 0
 v_mov_b32 v80, 0
 v_mov_b32 v81, 0
 v_mov_b32 v82, 0
 v_mov_b32 v83, 0
 v_mov_b32 v84, 0
 v_mov_b32 v85, 0
 v_mov_b32 v86, 0
 v_mov_b32 v87, 0
 v_mov_b32 v104, 0
 v_mov_b32 v105, 0
 v_mov_b32 v106, 0
 v_mov_b32 v107, 0
 v_mov_b32 v88, 0
 v_mov_b32 v89, 0
 v_mov_b32 v90, 0
 v_mov_b32 v91, 0
 v_mov_b32 v92, 0
 v_mov_b32 v93, 0
 v_mov_b32 v94, 0
 v_mov_b32 v95, 0
 v_mov_b32 v108, 0
 v_mov_b32 v109, 0
 v_mov_b32 v110, 0
 v_mov_b32 v111, 0
 s_mov_b32 s36, 0
L_fused_kernel_slow2:
 buffer_load_dwordx4 v[144:147], v188, s[24:27], s36 offen offset:0
 buffer_load_dwordx4 v[160:163], v188, s[24:27], s36 offen offset:2048
 buffer_load_dwordx4 v[148:151], v188, s[24:27], s36 offen offset:1024
 buffer_load_dwordx4 v[164:167], v188, s[24:27], s36 offen offset:3072
 s_waitcnt vmcnt(0)
 v_mfma_f32_16x16x32_bf16 v[16:19], v[144:147], v[128:131], v[112:115]
 v_mfma_f32_16x16x32_bf16 v[20:23], v[148:151], v[128:131], v[112:115]
 v_mfma_f32_16x16x32_bf16 v[24:27], v[144:147], v[132:135], v[116:119]
 v_mfma_f32_16x16x32_bf16 v[28:31], v[148:151], v[132:135], v[116:119]
 v_mfma_f32_16x16x32_bf16 v[32:35], v[144:147], v[136:139], v[120:123]
 v_mfma_f32_16x16x32_bf16 v[36:39], v[148:151], v[136:139], v[120:123]
 v_mfma_f32_16x16x32_bf16 v[40:43], v[144:147], v[140:143], v[124:127]
 v_mfma_f32_16x16x32_bf16 v[44:47], v[148:151], v[140:143], v[124:127]
 s_nop 7
 s_nop 1
 v_exp_f32 v16, v16
 v_exp_f32 v17, v17
 v_exp_f32 v18, v18
 v_exp_f32 v19, v19
 v_exp_f32 v20, v20
 v_exp_f32 v21, v21
 v_exp_f32 v22, v22
 v_exp_f32 v23, v23
 s_nop 0
 v_cvt_pk_bf16_f32 v48, v16, v17
 v_cvt_pk_bf16_f32 v49, v18, v19
 v_cvt_pk_bf16_f32 v50, v20, v21
 v_cvt_pk_bf16_f32 v51, v22, v23
 v_exp_f32 v24, v24
 v_exp_f32 v25, v25
 v_exp_f32 v26, v26
 v_exp_f32 v27, v27
 v_exp_f32 v28, v28
 v_exp_f32 v29, v29
 v_exp_f32 v30, v30
 v_exp_f32 v31, v31
 s_nop 0
 v_cvt_pk_bf16_f32 v52, v24, v25
 v_cvt_pk_bf16_f32 v53, v26, v27
 v_cvt_pk_bf16_f32 v54, v28, v29
 v_cvt_pk_bf16_f32 v55, v30, v31
 v_exp_f32 v32, v32
 v_exp_f32 v33, v33
 v_exp_f32 v34, v34
 v_exp_f32 v35, v35
 v_exp_f32 v36, v36
 v_exp_f32 v37, v37
 v_exp_f32 v38, v38
 v_exp_f32 v39, v39
 s_nop 0
 v_cvt_pk_bf16_f32 v56, v32, v33
 v_cvt_pk_bf16_f32 v57, v34, v35
 v_cvt_pk_bf16_f32 v58, v36, v37
 v_cvt_pk_bf16_f32 v59, v38, v39
 v_exp_f32 v40, v40
 v_exp_f32 v41, v41
 v_exp_f32 v42, v42
 v_exp_f32 v43, v43
 v_exp_f32 v44, v44
 v_exp_f32 v45, v45
 v_exp_f32 v46, v46
 v_exp_f32 v47, v47
 s_nop 0
 v_cvt_pk_bf16_f32 v60, v40, v41
 v_cvt_pk_bf16_f32 v61, v42, v43
 v_cvt_pk_bf16_f32 v62, v44, v45
 v_cvt_pk_bf16_f32 v63, v46, v47
 s_nop 1
 v_mfma_f32_16x16x32_bf16 v[64:67], v[160:163], v[48:51], v[64:67]
 v_mfma_f32_16x16x32_bf16 v[68:71], v[164:167], v[48:51], v[68:71]
 v_mfma_f32_16x16x32_bf16 v[72:75], v[160:163], v[52:55], v[72:75]
 v_mfma_f32_16x16x32_bf16 v[76:79], v[164:167], v[52:55], v[76:79]
 v_mfma_f32_16x16x32_bf16 v[96:99], v[176:179], v[48:51], v[96:99]
 v_mfma_f32_16x16x32_bf16 v[100:103], v[176:179], v[52:55], v[100:103]
 v_mfma_f32_16x16x32_bf16 v[80:83], v[160:163], v[56:59], v[80:83]
 v_mfma_f32_16x16x32_bf16 v[84:87], v[164:167], v[56:59], v[84:87]
 v_mfma_f32_16x16x32_bf16 v[88:91], v[160:163], v[60:63], v[88:91]
 v_mfma_f32_16x16x32_bf16 v[92:95], v[164:167], v[60:63], v[92:95]
 v_mfma_f32_16x16x32_bf16 v[104:107], v[176:179], v[56:59], v[104:107]
 v_mfma_f32_16x16x32_bf16 v[108:111], v[176:179], v[60:63], v[108:111]
 s_add_u32 s36, s36, 4096
 s_cmp_lt_u32 s36, 262144
 s_cbranch_scc1 L_fused_kernel_slow2
 s_nop 7
 s_nop 1
 v_rcp_f32 v180, v96
 v_rcp_f32 v181, v100
 v_rcp_f32 v182, v104
 v_rcp_f32 v183, v108
 s_nop 0
 v_mul_f32 v64, v64, v180
 v_mul_f32 v65, v65, v180
 v_mul_f32 v66, v66, v180
 v_mul_f32 v67, v67, v180
 v_mul_f32 v68, v68, v180
 v_mul_f32 v69, v69, v180
 v_mul_f32 v70, v70, v180
 v_mul_f32 v71, v71, v180
 v_cvt_pk_bf16_f32 v48, v64, v65
 v_cvt_pk_bf16_f32 v49, v66, v67
 v_cvt_pk_bf16_f32 v50, v68, v69
 v_cvt_pk_bf16_f32 v51, v70, v71
 s_mov_b32 s54, 0
 buffer_store_dwordx4 v[48:51], v188, s[32:35], s54 offen sc1
 v_mul_f32 v72, v72, v181
 v_mul_f32 v73, v73, v181
 v_mul_f32 v74, v74, v181
 v_mul_f32 v75, v75, v181
 v_mul_f32 v76, v76, v181
 v_mul_f32 v77, v77, v181
 v_mul_f32 v78, v78, v181
 v_mul_f32 v79, v79, v181
 v_cvt_pk_bf16_f32 v52, v72, v73
 v_cvt_pk_bf16_f32 v53, v74, v75
 v_cvt_pk_bf16_f32 v54, v76, v77
 v_cvt_pk_bf16_f32 v55, v78, v79
 s_mov_b32 s54, 147456
 buffer_store_dwordx4 v[52:55], v188, s[32:35], s54 offen sc1
 v_mul_f32 v80, v80, v182
 v_mul_f32 v81, v81, v182
 v_mul_f32 v82, v82, v182
 v_mul_f32 v83, v83, v182
 v_mul_f32 v84, v84, v182
 v_mul_f32 v85, v85, v182
 v_mul_f32 v86, v86, v182
 v_mul_f32 v87, v87, v182
 v_cvt_pk_bf16_f32 v56, v80, v81
 v_cvt_pk_bf16_f32 v57, v82, v83
 v_cvt_pk_bf16_f32 v58, v84, v85
 v_cvt_pk_bf16_f32 v59, v86, v87
 s_mov_b32 s54, 1024
 buffer_store_dwordx4 v[56:59], v188, s[32:35], s54 offen sc1
 v_mul_f32 v88, v88, v183
 v_mul_f32 v89, v89, v183
 v_mul_f32 v90, v90, v183
 v_mul_f32 v91, v91, v183
 v_mul_f32 v92, v92, v183
 v_mul_f32 v93, v93, v183
 v_mul_f32 v94, v94, v183
 v_mul_f32 v95, v95, v183
 v_cvt_pk_bf16_f32 v60, v88, v89
 v_cvt_pk_bf16_f32 v61, v90, v91
 v_cvt_pk_bf16_f32 v62, v92, v93
 v_cvt_pk_bf16_f32 v63, v94, v95
 s_mov_b32 s54, 148480
 buffer_store_dwordx4 v[60:63], v188, s[32:35], s54 offen sc1
 s_branch L_fused_kernel_apub
L_fused_kernel_gemm:
 s_and_b32 s51, s20, 3
 v_lshlrev_b32 v11, 4, v0
 v_lshrrev_b32 v12, 4, v0
 v_lshlrev_b32 v13, 1, v12
 v_bfe_u32 v14, v0, 1, 3
 v_xor_b32 v13, v13, v14
 v_lshlrev_b32 v12, 11, v12
 v_lshl_add_u32 v12, v13, 5, v12
 v_and_b32 v13, 1, v0
 v_lshl_add_u32 v12, v13, 4, v12
 v_add_u32 v7, 0, v12
 v_add_u32 v8, 7136, v12
 v_add_u32 v9, 14272, v12
 v_add_u32 v10, 21408, v12
 s_lshl_b32 s44, s51, 16
 s_add_u32 s45, s44, 32768
 s_mul_i32 s46, s51, 33792
 s_add_u32 s46, s46, 16384
 v_bfe_u32 v12, v0, 2, 2
 v_lshrrev_b32 v13, 4, v0
 v_mul_u32_u24 v13, 1056, v13
 v_lshl_add_u32 v13, v12, 8, v13
 v_and_b32 v14, 3, v0
 v_lshl_add_u32 v13, v14, 3, v13
 v_add_u32 v13, s46, v13
 v_xor_b32 v14, 0, v12
 v_lshl_add_u32 v3, v14, 6, v13
 v_xor_b32 v14, 1, v12
 v_lshl_add_u32 v4, v14, 6, v13
 v_xor_b32 v14, 2, v12
 v_lshl_add_u32 v5, v14, 6, v13
 v_xor_b32 v14, 3, v12
 v_lshl_add_u32 v6, v14, 6, v13
 s_waitcnt lgkmcnt(0)
 s_add_u32 s18, s4, 8912896
 s_addc_u32 s19, s5, 0
 s_mul_i32 s52, s21, 589824
 s_lshl_b32 s53, s51, 10
 s_add_u32 s52, s52, s53
 s_add_u32 s52, s52, 9437184
 s_add_u32 s24, s4, s52
 s_addc_u32 s25, s5, 0
 s_and_b32 s25, s25, 0xffff
 s_mov_b32 s26, 443392
 s_mov_b32 s27, 0x20000
 s_add_u32 s58, s51, 0
 s_and_b32 s58, s58, 3
 s_mul_i32 s47, s58, 147456
 s_add_u32 s58, s51, 1
 s_and_b32 s58, s58, 3
 s_mul_i32 s48, s58, 147456
 s_add_u32 s58, s51, 2
 s_and_b32 s58, s58, 3
 s_mul_i32 s49, s58, 147456
 s_add_u32 s58, s51, 3
 s_and_b32 s58, s58, 3
 s_mul_i32 s50, s58, 147456
 s_lshl_b32 s52, s22, 8
 s_add_u32 s28, s12, s52
 s_addc_u32 s29, s13, 0
 s_and_b32 s29, s29, 0xffff
 s_sub_u32 s30, 7340032, s52
 s_mov_b32 s31, 0x20000
 s_add_u32 s32, s8, s52
 s_addc_u32 s33, s9, 0
 s_and_b32 s33, s33, 0xffff
 s_sub_u32 s34, 2097152, s52
 s_mov_b32 s35, 0x20000
 s_lshl_b32 s53, s21, 17
 s_add_u32 s53, s53, s52
 s_add_u32 s36, s14, s53
 s_addc_u32 s37, s15, 0
 s_and_b32 s37, s37, 0xffff
 s_sub_u32 s38, 4194304, s53
 s_mov_b32 s39, 0x20000
 s_add_u32 s40, s6, s53
 s_addc_u32 s41, s7, 0
 s_and_b32 s41, s41, 0xffff
 s_sub_u32 s42, 4194304, s53
 s_mov_b32 s43, 0x20000
 s_barrier
 s_add_u32 m0, s46, 0
 s_nop 0
 buffer_load_dwordx4 v7, s[28:31], s44 offen offset:0 lds
 buffer_load_dwordx4 v8, s[28:31], s44 offen offset:1056 lds
 buffer_load_dwordx4 v9, s[28:31], s44 offen offset:2112 lds
 buffer_load_dwordx4 v10, s[28:31], s44 offen offset:3168 lds
 s_add_u32 m0, s46, 4224
 s_nop 0
 buffer_load_dwordx4 v7, s[28:31], s45 offen offset:0 lds
 buffer_load_dwordx4 v8, s[28:31], s45 offen offset:1056 lds
 buffer_load_dwordx4 v9, s[28:31], s45 offen offset:2112 lds
 buffer_load_dwordx4 v10, s[28:31], s45 offen offset:3168 lds
 s_add_u32 s44, s44, 262144
 s_add_u32 s45, s45, 262144
 s_add_u32 m0, s46, 8448
 s_nop 0
 buffer_load_dwordx4 v7, s[28:31], s44 offen offset:0 lds
 buffer_load_dwordx4 v8, s[28:31], s44 offen offset:1056 lds
 buffer_load_dwordx4 v9, s[28:31], s44 offen offset:2112 lds
 buffer_load_dwordx4 v10, s[28:31], s44 offen offset:3168 lds
 s_add_u32 m0, s46, 12672
 s_nop 0
 buffer_load_dwordx4 v7, s[28:31], s45 offen offset:0 lds
 buffer_load_dwordx4 v8, s[28:31], s45 offen offset:1056 lds
 buffer_load_dwordx4 v9, s[28:31], s45 offen offset:2112 lds
 buffer_load_dwordx4 v10, s[28:31], s45 offen offset:3168 lds
 s_add_u32 s44, s44, 262144
 s_add_u32 s45, s45, 262144
 buffer_load_dwordx4 v[80:83], v11, s[24:27], s47 offen
 buffer_load_dwordx4 v[84:87], v11, s[24:27], s48 offen
 buffer_load_dwordx4 v[88:91], v11, s[24:27], s49 offen
 buffer_load_dwordx4 v[92:95], v11, s[24:27], s50 offen
 s_add_u32 s24, s24, 4096
 s_addc_u32 s25, s25, 0
 s_barrier
 s_add_u32 m0, s46, 16896
 s_nop 0
 buffer_load_dwordx4 v7, s[28:31], s44 offen offset:0 lds
 buffer_load_dwordx4 v8, s[28:31], s44 offen offset:1056 lds
 buffer_load_dwordx4 v9, s[28:31], s44 offen offset:2112 lds
 buffer_load_dwordx4 v10, s[28:31], s44 offen offset:3168 lds
 s_add_u32 m0, s46, 21120
 s_nop 0
 buffer_load_dwordx4 v7, s[28:31], s45 offen offset:0 lds
 buffer_load_dwordx4 v8, s[28:31], s45 offen offset:1056 lds
 buffer_load_dwordx4 v9, s[28:31], s45 offen offset:2112 lds
 buffer_load_dwordx4 v10, s[28:31], s45 offen offset:3168 lds
 s_add_u32 s44, s44, 262144
 s_add_u32 s45, s45, 262144
 buffer_load_dwordx4 v[96:99], v11, s[24:27], s47 offen
 buffer_load_dwordx4 v[100:103], v11, s[24:27], s48 offen
 buffer_load_dwordx4 v[104:107], v11, s[24:27], s49 offen
 buffer_load_dwordx4 v[108:111], v11, s[24:27], s50 offen
 s_add_u32 s24, s24, 4096
 s_addc_u32 s25, s25, 0
 s_barrier
 s_add_u32 m0, s46, 25344
 s_nop 0
 buffer_load_dwordx4 v7, s[28:31], s44 offen offset:0 lds
 buffer_load_dwordx4 v8, s[28:31], s44 offen offset:1056 lds
 buffer_load_dwordx4 v9, s[28:31], s44 offen offset:2112 lds
 buffer_load_dwordx4 v10, s[28:31], s44 offen offset:3168 lds
 s_add_u32 m0, s46, 29568
 s_nop 0
 buffer_load_dwordx4 v7, s[28:31], s45 offen offset:0 lds
 buffer_load_dwordx4 v8, s[28:31], s45 offen offset:1056 lds
 buffer_load_dwordx4 v9, s[28:31], s45 offen offset:2112 lds
 buffer_load_dwordx4 v10, s[28:31], s45 offen offset:3168 lds
 s_add_u32 s44, s44, 262144
 s_add_u32 s45, s45, 262144
 v_mov_b32 v128, 0
 v_mov_b32 v129, 0
 v_mov_b32 v130, 0
 v_mov_b32 v131, 0
 v_mov_b32 v132, 0
 v_mov_b32 v133, 0
 v_mov_b32 v134, 0
 v_mov_b32 v135, 0
 v_mov_b32 v136, 0
 v_mov_b32 v137, 0
 v_mov_b32 v138, 0
 v_mov_b32 v139, 0
 v_mov_b32 v140, 0
 v_mov_b32 v141, 0
 v_mov_b32 v142, 0
 v_mov_b32 v143, 0
 v_mov_b32 v144, 0
 v_mov_b32 v145, 0
 v_mov_b32 v146, 0
 v_mov_b32 v147, 0
 v_mov_b32 v148, 0
 v_mov_b32 v149, 0
 v_mov_b32 v150, 0
 v_mov_b32 v151, 0
 v_mov_b32 v152, 0
 v_mov_b32 v153, 0
 v_mov_b32 v154, 0
 v_mov_b32 v155, 0
 v_mov_b32 v156, 0
 v_mov_b32 v157, 0
 v_mov_b32 v158, 0
 v_mov_b32 v159, 0
 v_mov_b32 v160, 0
 v_mov_b32 v161, 0
 v_mov_b32 v162, 0
 v_mov_b32 v163, 0
 v_mov_b32 v164, 0
 v_mov_b32 v165, 0
 v_mov_b32 v166, 0
 v_mov_b32 v167, 0
 v_mov_b32 v168, 0
 v_mov_b32 v169, 0
 v_mov_b32 v170, 0
 v_mov_b32 v171, 0
 v_mov_b32 v172, 0
 v_mov_b32 v173, 0
 v_mov_b32 v174, 0
 v_mov_b32 v175, 0
 v_mov_b32 v176, 0
 v_mov_b32 v177, 0
 v_mov_b32 v178, 0
 v_mov_b32 v179, 0
 v_mov_b32 v180, 0
 v_mov_b32 v181, 0
 v_mov_b32 v182, 0
 v_mov_b32 v183, 0
 v_mov_b32 v184, 0
 v_mov_b32 v185, 0
 v_mov_b32 v186, 0
 v_mov_b32 v187, 0
 v_mov_b32 v188, 0
 v_mov_b32 v189, 0
 v_mov_b32 v190, 0
 v_mov_b32 v191, 0
 v_mov_b32 v192, 0
 v_mov_b32 v193, 0
 v_mov_b32 v194, 0
 v_mov_b32 v195, 0
 v_mov_b32 v196, 0
 v_mov_b32 v197, 0
 v_mov_b32 v198, 0
 v_mov_b32 v199, 0
 v_mov_b32 v200, 0
 v_mov_b32 v201, 0
 v_mov_b32 v202, 0
 v_mov_b32 v203, 0
 v_mov_b32 v204, 0
 v_mov_b32 v205, 0
 v_mov_b32 v206, 0
 v_mov_b32 v207, 0
 v_mov_b32 v208, 0
 v_mov_b32 v209, 0
 v_mov_b32 v210, 0
 v_mov_b32 v211, 0
 v_mov_b32 v212, 0
 v_mov_b32 v213, 0
 v_mov_b32 v214, 0
 v_mov_b32 v215, 0
 v_mov_b32 v216, 0
 v_mov_b32 v217, 0
 v_mov_b32 v218, 0
 v_mov_b32 v219, 0
 v_mov_b32 v220, 0
 v_mov_b32 v221, 0
 v_mov_b32 v222, 0
 v_mov_b32 v223, 0
 v_mov_b32 v224, 0
 v_mov_b32 v225, 0
 v_mov_b32 v226, 0
 v_mov_b32 v227, 0
 v_mov_b32 v228, 0
 v_mov_b32 v229, 0
 v_mov_b32 v230, 0
 v_mov_b32 v231, 0
 v_mov_b32 v232, 0
 v_mov_b32 v233, 0
 v_mov_b32 v234, 0
 v_mov_b32 v235, 0
 v_mov_b32 v236, 0
 v_mov_b32 v237, 0
 v_mov_b32 v238, 0
 v_mov_b32 v239, 0
 v_mov_b32 v240, 0
 v_mov_b32 v241, 0
 v_mov_b32 v242, 0
 v_mov_b32 v243, 0
 v_mov_b32 v244, 0
 v_mov_b32 v245, 0
 v_mov_b32 v246, 0
 v_mov_b32 v247, 0
 v_mov_b32 v248, 0
 v_mov_b32 v249, 0
 v_mov_b32 v250, 0
 v_mov_b32 v251, 0
 v_mov_b32 v252, 0
 v_mov_b32 v253, 0
 v_mov_b32 v254, 0
 v_mov_b32 v255, 0
 s_waitcnt vmcnt(32)
 ds_read_b64_tr_b16 v[16:17], v3 offset:0
 ds_read_b64_tr_b16 v[18:19], v3 offset:4224
 ds_read_b64_tr_b16 v[20:21], v3 offset:32
 ds_read_b64_tr_b16 v[22:23], v3 offset:4256
 ds_read_b64_tr_b16 v[24:25], v4 offset:0
 ds_read_b64_tr_b16 v[26:27], v4 offset:4224
 ds_read_b64_tr_b16 v[28:29], v4 offset:32
 ds_read_b64_tr_b16 v[30:31], v4 offset:4256
 ds_read_b64_tr_b16 v[32:33], v5 offset:0
 ds_read_b64_tr_b16 v[34:35], v5 offset:4224
 ds_read_b64_tr_b16 v[36:37], v5 offset:32
 ds_read_b64_tr_b16 v[38:39], v5 offset:4256
 ds_read_b64_tr_b16 v[40:41], v6 offset:0
 ds_read_b64_tr_b16 v[42:43], v6 offset:4224
 ds_read_b64_tr_b16 v[44:45], v6 offset:32
 ds_read_b64_tr_b16 v[46:47], v6 offset:4256
 s_add_u32 s62, s24, 106496
 s_addc_u32 s63, s25, 0
 s_waitcnt vmcnt(20) lgkmcnt(0)
 s_barrier
 v_mfma_f32_16x16x32_bf16 v[128:131], v[16:19], v[80:83], v[128:131]
 buffer_load_dwordx4 v[112:115], v11, s[24:27], s47 offen
 ds_read_b64_tr_b16 v[48:49], v3 offset:8448
 v_mfma_f32_16x16x32_bf16 v[132:135], v[16:19], v[84:87], v[132:135]
 buffer_load_dwordx4 v[116:119], v11, s[24:27], s48 offen
 ds_read_b64_tr_b16 v[50:51], v3 offset:12672
 v_mfma_f32_16x16x32_bf16 v[136:139], v[16:19], v[88:91], v[136:139]
 buffer_load_dwordx4 v[120:123], v11, s[24:27], s49 offen
 ds_read_b64_tr_b16 v[52:53], v3 offset:8480
 v_mfma_f32_16x16x32_bf16 v[140:143], v[16:19], v[92:95], v[140:143]
 buffer_load_dwordx4 v[124:127], v11, s[24:27], s50 offen
 s_add_u32 s24, s24, 4096
 s_addc_u32 s25, s25, 0
 v_mfma_f32_16x16x32_bf16 v[144:147], v[20:23], v[80:83], v[144:147]
 ds_read_b64_tr_b16 v[54:55], v3 offset:12704
 v_mfma_f32_16x16x32_bf16 v[148:151], v[20:23], v[84:87], v[148:151]
 ds_read_b64_tr_b16 v[56:57], v4 offset:8448
 s_add_u32 m0, s46, 0
 v_mfma_f32_16x16x32_bf16 v[152:155], v[20:23], v[88:91], v[152:155]
 ds_read_b64_tr_b16 v[58:59], v4 offset:12672
 v_mfma_f32_16x16x32_bf16 v[156:159], v[20:23], v[92:95], v[156:159]
 buffer_load_dwordx4 v7, s[28:31], s44 offen offset:0 lds
 v_mfma_f32_16x16x32_bf16 v[160:163], v[24:27], v[80:83], v[160:163]
 ds_read_b64_tr_b16 v[60:61], v4 offset:8480
 v_mfma_f32_16x16x32_bf16 v[164:167], v[24:27], v[84:87], v[164:167]
 ds_read_b64_tr_b16 v[62:63], v4 offset:12704
 v_mfma_f32_16x16x32_bf16 v[168:171], v[24:27], v[88:91], v[168:171]
 buffer_load_dwordx4 v8, s[28:31], s44 offen offset:1056 lds
 v_mfma_f32_16x16x32_bf16 v[172:175], v[24:27], v[92:95], v[172:175]
 ds_read_b64_tr_b16 v[64:65], v5 offset:8448
 v_mfma_f32_16x16x32_bf16 v[176:179], v[28:31], v[80:83], v[176:179]
 ds_read_b64_tr_b16 v[66:67], v5 offset:12672
 buffer_load_dwordx4 v9, s[28:31], s44 offen offset:2112 lds
 v_mfma_f32_16x16x32_bf16 v[180:183], v[28:31], v[84:87], v[180:183]
 ds_read_b64_tr_b16 v[68:69], v5 offset:8480
 v_mfma_f32_16x16x32_bf16 v[184:187], v[28:31], v[88:91], v[184:187]
 v_mfma_f32_16x16x32_bf16 v[188:191], v[28:31], v[92:95], v[188:191]
 ds_read_b64_tr_b16 v[70:71], v5 offset:12704
 buffer_load_dwordx4 v10, s[28:31], s44 offen offset:3168 lds
 v_mfma_f32_16x16x32_bf16 v[192:195], v[32:35], v[80:83], v[192:195]
 ds_read_b64_tr_b16 v[72:73], v6 offset:8448
 v_mfma_f32_16x16x32_bf16 v[196:199], v[32:35], v[84:87], v[196:199]
 ds_read_b64_tr_b16 v[74:75], v6 offset:12672
 v_mfma_f32_16x16x32_bf16 v[200:203], v[32:35], v[88:91], v[200:203]
 s_add_u32 m0, s46, 4224
 v_mfma_f32_16x16x32_bf16 v[204:207], v[32:35], v[92:95], v[204:207]
 ds_read_b64_tr_b16 v[76:77], v6 offset:8480
 v_mfma_f32_16x16x32_bf16 v[208:211], v[36:39], v[80:83], v[208:211]
 ds_read_b64_tr_b16 v[78:79], v6 offset:12704
 buffer_load_dwordx4 v7, s[28:31], s45 offen offset:0 lds
 v_mfma_f32_16x16x32_bf16 v[212:215], v[36:39], v[84:87], v[212:215]
 v_mfma_f32_16x16x32_bf16 v[216:219], v[36:39], v[88:91], v[216:219]
 v_mfma_f32_16x16x32_bf16 v[220:223], v[36:39], v[92:95], v[220:223]
 buffer_load_dwordx4 v8, s[28:31], s45 offen offset:1056 lds
 v_mfma_f32_16x16x32_bf16 v[224:227], v[40:43], v[80:83], v[224:227]
 v_mfma_f32_16x16x32_bf16 v[228:231], v[40:43], v[84:87], v[228:231]
 buffer_load_dwordx4 v9, s[28:31], s45 offen offset:2112 lds
 v_mfma_f32_16x16x32_bf16 v[232:235], v[40:43], v[88:91], v[232:235]
 v_mfma_f32_16x16x32_bf16 v[236:239], v[40:43], v[92:95], v[236:239]
 v_mfma_f32_16x16x32_bf16 v[240:243], v[44:47], v[80:83], v[240:243]
 buffer_load_dwordx4 v10, s[28:31], s45 offen offset:3168 lds
 s_add_u32 s44, s44, 262144
 s_add_u32 s45, s45, 262144
 s_barrier
 v_mfma_f32_16x16x32_bf16 v[244:247], v[44:47], v[84:87], v[244:247]
 v_mfma_f32_16x16x32_bf16 v[248:251], v[44:47], v[88:91], v[248:251]
 v_mfma_f32_16x16x32_bf16 v[252:255], v[44:47], v[92:95], v[252:255]
 s_waitcnt vmcnt(20) lgkmcnt(0)
 v_mfma_f32_16x16x32_bf16 v[128:131], v[48:51], v[96:99], v[128:131]
 buffer_load_dwordx4 v[80:83], v11, s[24:27], s47 offen
 ds_read_b64_tr_b16 v[16:17], v3 offset:16896
 v_mfma_f32_16x16x32_bf16 v[132:135], v[48:51], v[100:103], v[132:135]
 buffer_load_dwordx4 v[84:87], v11, s[24:27], s48 offen
 ds_read_b64_tr_b16 v[18:19], v3 offset:21120
 v_mfma_f32_16x16x32_bf16 v[136:139], v[48:51], v[104:107], v[136:139]
 buffer_load_dwordx4 v[88:91], v11, s[24:27], s49 offen
 ds_read_b64_tr_b16 v[20:21], v3 offset:16928
 v_mfma_f32_16x16x32_bf16 v[140:143], v[48:51], v[108:111], v[140:143]
 buffer_load_dwordx4 v[92:95], v11, s[24:27], s50 offen
 s_add_u32 s24, s24, 4096
 s_addc_u32 s25, s25, 0
 v_mfma_f32_16x16x32_bf16 v[144:147], v[52:55], v[96:99], v[144:147]
 ds_read_b64_tr_b16 v[22:23], v3 offset:21152
 v_mfma_f32_16x16x32_bf16 v[148:151], v[52:55], v[100:103], v[148:151]
 ds_read_b64_tr_b16 v[24:25], v4 offset:16896
 s_add_u32 m0, s46, 8448
 v_mfma_f32_16x16x32_bf16 v[152:155], v[52:55], v[104:107], v[152:155]
 ds_read_b64_tr_b16 v[26:27], v4 offset:21120
 v_mfma_f32_16x16x32_bf16 v[156:159], v[52:55], v[108:111], v[156:159]
 buffer_load_dwordx4 v7, s[28:31], s44 offen offset:0 lds
 v_mfma_f32_16x16x32_bf16 v[160:163], v[56:59], v[96:99], v[160:163]
 ds_read_b64_tr_b16 v[28:29], v4 offset:16928
 v_mfma_f32_16x16x32_bf16 v[164:167], v[56:59], v[100:103], v[164:167]
 ds_read_b64_tr_b16 v[30:31], v4 offset:21152
 v_mfma_f32_16x16x32_bf16 v[168:171], v[56:59], v[104:107], v[168:171]
 buffer_load_dwordx4 v8, s[28:31], s44 offen offset:1056 lds
 v_mfma_f32_16x16x32_bf16 v[172:175], v[56:59], v[108:111], v[172:175]
 ds_read_b64_tr_b16 v[32:33], v5 offset:16896
 v_mfma_f32_16x16x32_bf16 v[176:179], v[60:63], v[96:99], v[176:179]
 ds_read_b64_tr_b16 v[34:35], v5 offset:21120
 buffer_load_dwordx4 v9, s[28:31], s44 offen offset:2112 lds
 v_mfma_f32_16x16x32_bf16 v[180:183], v[60:63], v[100:103], v[180:183]
 ds_read_b64_tr_b16 v[36:37], v5 offset:16928
 v_mfma_f32_16x16x32_bf16 v[184:187], v[60:63], v[104:107], v[184:187]
 v_mfma_f32_16x16x32_bf16 v[188:191], v[60:63], v[108:111], v[188:191]
 ds_read_b64_tr_b16 v[38:39], v5 offset:21152
 buffer_load_dwordx4 v10, s[28:31], s44 offen offset:3168 lds
 v_mfma_f32_16x16x32_bf16 v[192:195], v[64:67], v[96:99], v[192:195]
 ds_read_b64_tr_b16 v[40:41], v6 offset:16896
 v_mfma_f32_16x16x32_bf16 v[196:199], v[64:67], v[100:103], v[196:199]
 ds_read_b64_tr_b16 v[42:43], v6 offset:21120
 v_mfma_f32_16x16x32_bf16 v[200:203], v[64:67], v[104:107], v[200:203]
 s_add_u32 m0, s46, 12672
 v_mfma_f32_16x16x32_bf16 v[204:207], v[64:67], v[108:111], v[204:207]
 ds_read_b64_tr_b16 v[44:45], v6 offset:16928
 v_mfma_f32_16x16x32_bf16 v[208:211], v[68:71], v[96:99], v[208:211]
 ds_read_b64_tr_b16 v[46:47], v6 offset:21152
 buffer_load_dwordx4 v7, s[28:31], s45 offen offset:0 lds
 v_mfma_f32_16x16x32_bf16 v[212:215], v[68:71], v[100:103], v[212:215]
 v_mfma_f32_16x16x32_bf16 v[216:219], v[68:71], v[104:107], v[216:219]
 v_mfma_f32_16x16x32_bf16 v[220:223], v[68:71], v[108:111], v[220:223]
 buffer_load_dwordx4 v8, s[28:31], s45 offen offset:1056 lds
 v_mfma_f32_16x16x32_bf16 v[224:227], v[72:75], v[96:99], v[224:227]
 v_mfma_f32_16x16x32_bf16 v[228:231], v[72:75], v[100:103], v[228:231]
 buffer_load_dwordx4 v9, s[28:31], s45 offen offset:2112 lds
 s_barrier
 v_mfma_f32_16x16x32_bf16 v[232:235], v[72:75], v[104:107], v[232:235]
 v_mfma_f32_16x16x32_bf16 v[236:239], v[72:75], v[108:111], v[236:239]
 v_mfma_f32_16x16x32_bf16 v[240:243], v[76:79], v[96:99], v[240:243]
 buffer_load_dwordx4 v10, s[28:31], s45 offen offset:3168 lds
 s_add_u32 s44, s44, 262144
 s_add_u32 s45, s45, 262144
 v_mfma_f32_16x16x32_bf16 v[244:247], v[76:79], v[100:103], v[244:247]
 v_mfma_f32_16x16x32_bf16 v[248:251], v[76:79], v[104:107], v[248:251]
 v_mfma_f32_16x16x32_bf16 v[252:255], v[76:79], v[108:111], v[252:255]
 s_waitcnt vmcnt(20) lgkmcnt(0)
 v_mfma_f32_16x16x32_bf16 v[128:131], v[16:19], v[112:115], v[128:131]
 buffer_load_dwordx4 v[96:99], v11, s[24:27], s47 offen
 ds_read_b64_tr_b16 v[48:49], v3 offset:25344
 v_mfma_f32_16x16x32_bf16 v[132:135], v[16:19], v[116:119], v[132:135]
 buffer_load_dwordx4 v[100:103], v11, s[24:27], s48 offen
 ds_read_b64_tr_b16 v[50:51], v3 offset:29568
 v_mfma_f32_16x16x32_bf16 v[136:139], v[16:19], v[120:123], v[136:139]
 buffer_load_dwordx4 v[104:107], v11, s[24:27], s49 offen
 ds_read_b64_tr_b16 v[52:53], v3 offset:25376
 v_mfma_f32_16x16x32_bf16 v[140:143], v[16:19], v[124:127], v[140:143]
 buffer_load_dwordx4 v[108:111], v11, s[24:27], s50 offen
 s_add_u32 s24, s24, 4096
 s_addc_u32 s25, s25, 0
 v_mfma_f32_16x16x32_bf16 v[144:147], v[20:23], v[112:115], v[144:147]
 ds_read_b64_tr_b16 v[54:55], v3 offset:29600
 v_mfma_f32_16x16x32_bf16 v[148:151], v[20:23], v[116:119], v[148:151]
 ds_read_b64_tr_b16 v[56:57], v4 offset:25344
 s_add_u32 m0, s46, 16896
 v_mfma_f32_16x16x32_bf16 v[152:155], v[20:23], v[120:123], v[152:155]
 ds_read_b64_tr_b16 v[58:59], v4 offset:29568
 v_mfma_f32_16x16x32_bf16 v[156:159], v[20:23], v[124:127], v[156:159]
 buffer_load_dwordx4 v7, s[28:31], s44 offen offset:0 lds
 v_mfma_f32_16x16x32_bf16 v[160:163], v[24:27], v[112:115], v[160:163]
 ds_read_b64_tr_b16 v[60:61], v4 offset:25376
 v_mfma_f32_16x16x32_bf16 v[164:167], v[24:27], v[116:119], v[164:167]
 ds_read_b64_tr_b16 v[62:63], v4 offset:29600
 v_mfma_f32_16x16x32_bf16 v[168:171], v[24:27], v[120:123], v[168:171]
 buffer_load_dwordx4 v8, s[28:31], s44 offen offset:1056 lds
 v_mfma_f32_16x16x32_bf16 v[172:175], v[24:27], v[124:127], v[172:175]
 ds_read_b64_tr_b16 v[64:65], v5 offset:25344
 v_mfma_f32_16x16x32_bf16 v[176:179], v[28:31], v[112:115], v[176:179]
 ds_read_b64_tr_b16 v[66:67], v5 offset:29568
 buffer_load_dwordx4 v9, s[28:31], s44 offen offset:2112 lds
 v_mfma_f32_16x16x32_bf16 v[180:183], v[28:31], v[116:119], v[180:183]
 ds_read_b64_tr_b16 v[68:69], v5 offset:25376
 v_mfma_f32_16x16x32_bf16 v[184:187], v[28:31], v[120:123], v[184:187]
 v_mfma_f32_16x16x32_bf16 v[188:191], v[28:31], v[124:127], v[188:191]
 ds_read_b64_tr_b16 v[70:71], v5 offset:29600
 buffer_load_dwordx4 v10, s[28:31], s44 offen offset:3168 lds
 v_mfma_f32_16x16x32_bf16 v[192:195], v[32:35], v[112:115], v[192:195]
 ds_read_b64_tr_b16 v[72:73], v6 offset:25344
 v_mfma_f32_16x16x32_bf16 v[196:199], v[32:35], v[116:119], v[196:199]
 ds_read_b64_tr_b16 v[74:75], v6 offset:29568
 v_mfma_f32_16x16x32_bf16 v[200:203], v[32:35], v[120:123], v[200:203]
 s_add_u32 m0, s46, 21120
 v_mfma_f32_16x16x32_bf16 v[204:207], v[32:35], v[124:127], v[204:207]
 ds_read_b64_tr_b16 v[76:77], v6 offset:25376
 v_mfma_f32_16x16x32_bf16 v[208:211], v[36:39], v[112:115], v[208:211]
 ds_read_b64_tr_b16 v[78:79], v6 offset:29600
 buffer_load_dwordx4 v7, s[28:31], s45 offen offset:0 lds
 v_mfma_f32_16x16x32_bf16 v[212:215], v[36:39], v[116:119], v[212:215]
 s_barrier
 v_mfma_f32_16x16x32_bf16 v[216:219], v[36:39], v[120:123], v[216:219]
 v_mfma_f32_16x16x32_bf16 v[220:223], v[36:39], v[124:127], v[220:223]
 buffer_load_dwordx4 v8, s[28:31], s45 offen offset:1056 lds
 v_mfma_f32_16x16x32_bf16 v[224:227], v[40:43], v[112:115], v[224:227]
 v_mfma_f32_16x16x32_bf16 v[228:231], v[40:43], v[116:119], v[228:231]
 buffer_load_dwordx4 v9, s[28:31], s45 offen offset:2112 lds
 v_mfma_f32_16x16x32_bf16 v[232:235], v[40:43], v[120:123], v[232:235]
 v_mfma_f32_16x16x32_bf16 v[236:239], v[40:43], v[124:127], v[236:239]
 v_mfma_f32_16x16x32_bf16 v[240:243], v[44:47], v[112:115], v[240:243]
 buffer_load_dwordx4 v10, s[28:31], s45 offen offset:3168 lds
 s_add_u32 s44, s44, 262144
 s_add_u32 s45, s45, 262144
 v_mfma_f32_16x16x32_bf16 v[244:247], v[44:47], v[116:119], v[244:247]
 v_mfma_f32_16x16x32_bf16 v[248:251], v[44:47], v[120:123], v[248:251]
 v_mfma_f32_16x16x32_bf16 v[252:255], v[44:47], v[124:127], v[252:255]
 s_waitcnt vmcnt(20) lgkmcnt(0)
 v_mfma_f32_16x16x32_bf16 v[128:131], v[48:51], v[80:83], v[128:131]
 buffer_load_dwordx4 v[112:115], v11, s[24:27], s47 offen
 ds_read_b64_tr_b16 v[16:17], v3 offset:0
 v_mfma_f32_16x16x32_bf16 v[132:135], v[48:51], v[84:87], v[132:135]
 buffer_load_dwordx4 v[116:119], v11, s[24:27], s48 offen
 ds_read_b64_tr_b16 v[18:19], v3 offset:4224
 v_mfma_f32_16x16x32_bf16 v[136:139], v[48:51], v[88:91], v[136:139]
 buffer_load_dwordx4 v[120:123], v11, s[24:27], s49 offen
 ds_read_b64_tr_b16 v[20:21], v3 offset:32
 v_mfma_f32_16x16x32_bf16 v[140:143], v[48:51], v[92:95], v[140:143]
 buffer_load_dwordx4 v[124:127], v11, s[24:27], s50 offen
 s_add_u32 s24, s24, 4096
 s_addc_u32 s25, s25, 0
 v_mfma_f32_16x16x32_bf16 v[144:147], v[52:55], v[80:83], v[144:147]
 ds_read_b64_tr_b16 v[22:23], v3 offset:4256
 v_mfma_f32_16x16x32_bf16 v[148:151], v[52:55], v[84:87], v[148:151]
 ds_read_b64_tr_b16 v[24:25], v4 offset:0
 s_add_u32 m0, s46, 25344
 v_mfma_f32_16x16x32_bf16 v[152:155], v[52:55], v[88:91], v[152:155]
 ds_read_b64_tr_b16 v[26:27], v4 offset:4224
 v_mfma_f32_16x16x32_bf16 v[156:159], v[52:55], v[92:95], v[156:159]
 buffer_load_dwordx4 v7, s[28:31], s44 offen offset:0 lds
 v_mfma_f32_16x16x32_bf16 v[160:163], v[56:59], v[80:83], v[160:163]
 ds_read_b64_tr_b16 v[28:29], v4 offset:32
 v_mfma_f32_16x16x32_bf16 v[164:167], v[56:59], v[84:87], v[164:167]
 ds_read_b64_tr_b16 v[30:31], v4 offset:4256
 v_mfma_f32_16x16x32_bf16 v[168:171], v[56:59], v[88:91], v[168:171]
 buffer_load_dwordx4 v8, s[28:31], s44 offen offset:1056 lds
 v_mfma_f32_16x16x32_bf16 v[172:175], v[56:59], v[92:95], v[172:175]
 ds_read_b64_tr_b16 v[32:33], v5 offset:0
 v_mfma_f32_16x16x32_bf16 v[176:179], v[60:63], v[80:83], v[176:179]
 ds_read_b64_tr_b16 v[34:35], v5 offset:4224
 buffer_load_dwordx4 v9, s[28:31], s44 offen offset:2112 lds
 v_mfma_f32_16x16x32_bf16 v[180:183], v[60:63], v[84:87], v[180:183]
 ds_read_b64_tr_b16 v[36:37], v5 offset:32
 v_mfma_f32_16x16x32_bf16 v[184:187], v[60:63], v[88:91], v[184:187]
 v_mfma_f32_16x16x32_bf16 v[188:191], v[60:63], v[92:95], v[188:191]
 ds_read_b64_tr_b16 v[38:39], v5 offset:4256
 buffer_load_dwordx4 v10, s[28:31], s44 offen offset:3168 lds
 v_mfma_f32_16x16x32_bf16 v[192:195], v[64:67], v[80:83], v[192:195]
 ds_read_b64_tr_b16 v[40:41], v6 offset:0
 v_mfma_f32_16x16x32_bf16 v[196:199], v[64:67], v[84:87], v[196:199]
 ds_read_b64_tr_b16 v[42:43], v6 offset:4224
 v_mfma_f32_16x16x32_bf16 v[200:203], v[64:67], v[88:91], v[200:203]
 s_add_u32 m0, s46, 29568
 s_barrier
 v_mfma_f32_16x16x32_bf16 v[204:207], v[64:67], v[92:95], v[204:207]
 ds_read_b64_tr_b16 v[44:45], v6 offset:32
 v_mfma_f32_16x16x32_bf16 v[208:211], v[68:71], v[80:83], v[208:211]
 ds_read_b64_tr_b16 v[46:47], v6 offset:4256
 buffer_load_dwordx4 v7, s[28:31], s45 offen offset:0 lds
 v_mfma_f32_16x16x32_bf16 v[212:215], v[68:71], v[84:87], v[212:215]
 v_mfma_f32_16x16x32_bf16 v[216:219], v[68:71], v[88:91], v[216:219]
 v_mfma_f32_16x16x32_bf16 v[220:223], v[68:71], v[92:95], v[220:223]
 buffer_load_dwordx4 v8, s[28:31], s45 offen offset:1056 lds
 v_mfma_f32_16x16x32_bf16 v[224:227], v[72:75], v[80:83], v[224:227]
 v_mfma_f32_16x16x32_bf16 v[228:231], v[72:75], v[84:87], v[228:231]
 buffer_load_dwordx4 v9, s[28:31], s45 offen offset:2112 lds
 v_mfma_f32_16x16x32_bf16 v[232:235], v[72:75], v[88:91], v[232:235]
 v_mfma_f32_16x16x32_bf16 v[236:239], v[72:75], v[92:95], v[236:239]
 v_mfma_f32_16x16x32_bf16 v[240:243], v[76:79], v[80:83], v[240:243]
 buffer_load_dwordx4 v10, s[28:31], s45 offen offset:3168 lds
 s_add_u32 s44, s44, 262144
 s_add_u32 s45, s45, 262144
 v_mfma_f32_16x16x32_bf16 v[244:247], v[76:79], v[84:87], v[244:247]
 v_mfma_f32_16x16x32_bf16 v[248:251], v[76:79], v[88:91], v[248:251]
 v_mfma_f32_16x16x32_bf16 v[252:255], v[76:79], v[92:95], v[252:255]
 s_waitcnt vmcnt(20) lgkmcnt(0)
 v_mfma_f32_16x16x32_bf16 v[128:131], v[16:19], v[96:99], v[128:131]
 buffer_load_dwordx4 v[80:83], v11, s[24:27], s47 offen
 ds_read_b64_tr_b16 v[48:49], v3 offset:8448
 v_mfma_f32_16x16x32_bf16 v[132:135], v[16:19], v[100:103], v[132:135]
 buffer_load_dwordx4 v[84:87], v11, s[24:27], s48 offen
 ds_read_b64_tr_b16 v[50:51], v3 offset:12672
 v_mfma_f32_16x16x32_bf16 v[136:139], v[16:19], v[104:107], v[136:139]
 buffer_load_dwordx4 v[88:91], v11, s[24:27], s49 offen
 ds_read_b64_tr_b16 v[52:53], v3 offset:8480
 v_mfma_f32_16x16x32_bf16 v[140:143], v[16:19], v[108:111], v[140:143]
 buffer_load_dwordx4 v[92:95], v11, s[24:27], s50 offen
 s_add_u32 s24, s24, 4096
 s_addc_u32 s25, s25, 0
 v_mfma_f32_16x16x32_bf16 v[144:147], v[20:23], v[96:99], v[144:147]
 ds_read_b64_tr_b16 v[54:55], v3 offset:12704
 v_mfma_f32_16x16x32_bf16 v[148:151], v[20:23], v[100:103], v[148:151]
 ds_read_b64_tr_b16 v[56:57], v4 offset:8448
 s_add_u32 m0, s46, 0
 v_mfma_f32_16x16x32_bf16 v[152:155], v[20:23], v[104:107], v[152:155]
 ds_read_b64_tr_b16 v[58:59], v4 offset:12672
 v_mfma_f32_16x16x32_bf16 v[156:159], v[20:23], v[108:111], v[156:159]
 buffer_load_dwordx4 v7, s[28:31], s44 offen offset:0 lds
 v_mfma_f32_16x16x32_bf16 v[160:163], v[24:27], v[96:99], v[160:163]
 ds_read_b64_tr_b16 v[60:61], v4 offset:8480
 v_mfma_f32_16x16x32_bf16 v[164:167], v[24:27], v[100:103], v[164:167]
 ds_read_b64_tr_b16 v[62:63], v4 offset:12704
 v_mfma_f32_16x16x32_bf16 v[168:171], v[24:27], v[104:107], v[168:171]
 buffer_load_dwordx4 v8, s[28:31], s44 offen offset:1056 lds
 v_mfma_f32_16x16x32_bf16 v[172:175], v[24:27], v[108:111], v[172:175]
 ds_read_b64_tr_b16 v[64:65], v5 offset:8448
 v_mfma_f32_16x16x32_bf16 v[176:179], v[28:31], v[96:99], v[176:179]
 ds_read_b64_tr_b16 v[66:67], v5 offset:12672
 buffer_load_dwordx4 v9, s[28:31], s44 offen offset:2112 lds
 v_mfma_f32_16x16x32_bf16 v[180:183], v[28:31], v[100:103], v[180:183]
 ds_read_b64_tr_b16 v[68:69], v5 offset:8480
 v_mfma_f32_16x16x32_bf16 v[184:187], v[28:31], v[104:107], v[184:187]
 v_mfma_f32_16x16x32_bf16 v[188:191], v[28:31], v[108:111], v[188:191]
 ds_read_b64_tr_b16 v[70:71], v5 offset:12704
 buffer_load_dwordx4 v10, s[28:31], s44 offen offset:3168 lds
 s_barrier
 v_mfma_f32_16x16x32_bf16 v[192:195], v[32:35], v[96:99], v[192:195]
 ds_read_b64_tr_b16 v[72:73], v6 offset:8448
 v_mfma_f32_16x16x32_bf16 v[196:199], v[32:35], v[100:103], v[196:199]
 ds_read_b64_tr_b16 v[74:75], v6 offset:12672
 v_mfma_f32_16x16x32_bf16 v[200:203], v[32:35], v[104:107], v[200:203]
 s_add_u32 m0, s46, 4224
 v_mfma_f32_16x16x32_bf16 v[204:207], v[32:35], v[108:111], v[204:207]
 ds_read_b64_tr_b16 v[76:77], v6 offset:8480
 v_mfma_f32_16x16x32_bf16 v[208:211], v[36:39], v[96:99], v[208:211]
 ds_read_b64_tr_b16 v[78:79], v6 offset:12704
 buffer_load_dwordx4 v7, s[28:31], s45 offen offset:0 lds
 v_mfma_f32_16x16x32_bf16 v[212:215], v[36:39], v[100:103], v[212:215]
 v_mfma_f32_16x16x32_bf16 v[216:219], v[36:39], v[104:107], v[216:219]
 v_mfma_f32_16x16x32_bf16 v[220:223], v[36:39], v[108:111], v[220:223]
 buffer_load_dwordx4 v8, s[28:31], s45 offen offset:1056 lds
 v_mfma_f32_16x16x32_bf16 v[224:227], v[40:43], v[96:99], v[224:227]
 v_mfma_f32_16x16x32_bf16 v[228:231], v[40:43], v[100:103], v[228:231]
 buffer_load_dwordx4 v9, s[28:31], s45 offen offset:2112 lds
 v_mfma_f32_16x16x32_bf16 v[232:235], v[40:43], v[104:107], v[232:235]
 v_mfma_f32_16x16x32_bf16 v[236:239], v[40:43], v[108:111], v[236:239]
 v_mfma_f32_16x16x32_bf16 v[240:243], v[44:47], v[96:99], v[240:243]
 buffer_load_dwordx4 v10, s[28:31], s45 offen offset:3168 lds
 s_add_u32 s44, s44, 262144
 s_add_u32 s45, s45, 262144
 v_mfma_f32_16x16x32_bf16 v[244:247], v[44:47], v[100:103], v[244:247]
 v_mfma_f32_16x16x32_bf16 v[248:251], v[44:47], v[104:107], v[248:251]
 v_mfma_f32_16x16x32_bf16 v[252:255], v[44:47], v[108:111], v[252:255]
 s_waitcnt vmcnt(20) lgkmcnt(0)
 v_mfma_f32_16x16x32_bf16 v[128:131], v[48:51], v[112:115], v[128:131]
 buffer_load_dwordx4 v[96:99], v11, s[24:27], s47 offen
 ds_read_b64_tr_b16 v[16:17], v3 offset:16896
 v_mfma_f32_16x16x32_bf16 v[132:135], v[48:51], v[116:119], v[132:135]
 buffer_load_dwordx4 v[100:103], v11, s[24:27], s48 offen
 ds_read_b64_tr_b16 v[18:19], v3 offset:21120
 v_mfma_f32_16x16x32_bf16 v[136:139], v[48:51], v[120:123], v[136:139]
 buffer_load_dwordx4 v[104:107], v11, s[24:27], s49 offen
 ds_read_b64_tr_b16 v[20:21], v3 offset:16928
 v_mfma_f32_16x16x32_bf16 v[140:143], v[48:51], v[124:127], v[140:143]
 buffer_load_dwordx4 v[108:111], v11, s[24:27], s50 offen
 s_add_u32 s24, s24, 4096
 s_addc_u32 s25, s25, 0
 v_mfma_f32_16x16x32_bf16 v[144:147], v[52:55], v[112:115], v[144:147]
 ds_read_b64_tr_b16 v[22:23], v3 offset:21152
 v_mfma_f32_16x16x32_bf16 v[148:151], v[52:55], v[116:119], v[148:151]
 ds_read_b64_tr_b16 v[24:25], v4 offset:16896
 s_add_u32 m0, s46, 8448
 v_mfma_f32_16x16x32_bf16 v[152:155], v[52:55], v[120:123], v[152:155]
 ds_read_b64_tr_b16 v[26:27], v4 offset:21120
 v_mfma_f32_16x16x32_bf16 v[156:159], v[52:55], v[124:127], v[156:159]
 buffer_load_dwordx4 v7, s[28:31], s44 offen offset:0 lds
 v_mfma_f32_16x16x32_bf16 v[160:163], v[56:59], v[112:115], v[160:163]
 ds_read_b64_tr_b16 v[28:29], v4 offset:16928
 v_mfma_f32_16x16x32_bf16 v[164:167], v[56:59], v[116:119], v[164:167]
 ds_read_b64_tr_b16 v[30:31], v4 offset:21152
 v_mfma_f32_16x16x32_bf16 v[168:171], v[56:59], v[120:123], v[168:171]
 buffer_load_dwordx4 v8, s[28:31], s44 offen offset:1056 lds
 v_mfma_f32_16x16x32_bf16 v[172:175], v[56:59], v[124:127], v[172:175]
 ds_read_b64_tr_b16 v[32:33], v5 offset:16896
 v_mfma_f32_16x16x32_bf16 v[176:179], v[60:63], v[112:115], v[176:179]
 ds_read_b64_tr_b16 v[34:35], v5 offset:21120
 buffer_load_dwordx4 v9, s[28:31], s44 offen offset:2112 lds
 s_barrier
 v_mfma_f32_16x16x32_bf16 v[180:183], v[60:63], v[116:119], v[180:183]
 ds_read_b64_tr_b16 v[36:37], v5 offset:16928
 v_mfma_f32_16x16x32_bf16 v[184:187], v[60:63], v[120:123], v[184:187]
 v_mfma_f32_16x16x32_bf16 v[188:191], v[60:63], v[124:127], v[188:191]
 ds_read_b64_tr_b16 v[38:39], v5 offset:21152
 buffer_load_dwordx4 v10, s[28:31], s44 offen offset:3168 lds
 v_mfma_f32_16x16x32_bf16 v[192:195], v[64:67], v[112:115], v[192:195]
 ds_read_b64_tr_b16 v[40:41], v6 offset:16896
 v_mfma_f32_16x16x32_bf16 v[196:199], v[64:67], v[116:119], v[196:199]
 ds_read_b64_tr_b16 v[42:43], v6 offset:21120
 v_mfma_f32_16x16x32_bf16 v[200:203], v[64:67], v[120:123], v[200:203]
 s_add_u32 m0, s46, 12672
 v_mfma_f32_16x16x32_bf16 v[204:207], v[64:67], v[124:127], v[204:207]
 ds_read_b64_tr_b16 v[44:45], v6 offset:16928
 v_mfma_f32_16x16x32_bf16 v[208:211], v[68:71], v[112:115], v[208:211]
 ds_read_b64_tr_b16 v[46:47], v6 offset:21152
 buffer_load_dwordx4 v7, s[28:31], s45 offen offset:0 lds
 v_mfma_f32_16x16x32_bf16 v[212:215], v[68:71], v[116:119], v[212:215]
 v_mfma_f32_16x16x32_bf16 v[216:219], v[68:71], v[120:123], v[216:219]
 v_mfma_f32_16x16x32_bf16 v[220:223], v[68:71], v[124:127], v[220:223]
 buffer_load_dwordx4 v8, s[28:31], s45 offen offset:1056 lds
 v_mfma_f32_16x16x32_bf16 v[224:227], v[72:75], v[112:115], v[224:227]
 v_mfma_f32_16x16x32_bf16 v[228:231], v[72:75], v[116:119], v[228:231]
 buffer_load_dwordx4 v9, s[28:31], s45 offen offset:2112 lds
 v_mfma_f32_16x16x32_bf16 v[232:235], v[72:75], v[120:123], v[232:235]
 v_mfma_f32_16x16x32_bf16 v[236:239], v[72:75], v[124:127], v[236:239]
 v_mfma_f32_16x16x32_bf16 v[240:243], v[76:79], v[112:115], v[240:243]
 buffer_load_dwordx4 v10, s[28:31], s45 offen offset:3168 lds
 s_add_u32 s44, s44, 262144
 s_add_u32 s45, s45, 262144
 v_mfma_f32_16x16x32_bf16 v[244:247], v[76:79], v[116:119], v[244:247]
 v_mfma_f32_16x16x32_bf16 v[248:251], v[76:79], v[120:123], v[248:251]
 v_mfma_f32_16x16x32_bf16 v[252:255], v[76:79], v[124:127], v[252:255]
 s_waitcnt vmcnt(20) lgkmcnt(0)
 v_mfma_f32_16x16x32_bf16 v[128:131], v[16:19], v[80:83], v[128:131]
 buffer_load_dwordx4 v[112:115], v11, s[24:27], s47 offen
 ds_read_b64_tr_b16 v[48:49], v3 offset:25344
 v_mfma_f32_16x16x32_bf16 v[132:135], v[16:19], v[84:87], v[132:135]
 buffer_load_dwordx4 v[116:119], v11, s[24:27], s48 offen
 ds_read_b64_tr_b16 v[50:51], v3 offset:29568
 v_mfma_f32_16x16x32_bf16 v[136:139], v[16:19], v[88:91], v[136:139]
 buffer_load_dwordx4 v[120:123], v11, s[24:27], s49 offen
 ds_read_b64_tr_b16 v[52:53], v3 offset:25376
 v_mfma_f32_16x16x32_bf16 v[140:143], v[16:19], v[92:95], v[140:143]
 buffer_load_dwordx4 v[124:127], v11, s[24:27], s50 offen
 s_add_u32 s24, s24, 4096
 s_addc_u32 s25, s25, 0
 v_mfma_f32_16x16x32_bf16 v[144:147], v[20:23], v[80:83], v[144:147]
 ds_read_b64_tr_b16 v[54:55], v3 offset:29600
 v_mfma_f32_16x16x32_bf16 v[148:151], v[20:23], v[84:87], v[148:151]
 ds_read_b64_tr_b16 v[56:57], v4 offset:25344
 s_add_u32 m0, s46, 16896
 v_mfma_f32_16x16x32_bf16 v[152:155], v[20:23], v[88:91], v[152:155]
 ds_read_b64_tr_b16 v[58:59], v4 offset:29568
 v_mfma_f32_16x16x32_bf16 v[156:159], v[20:23], v[92:95], v[156:159]
 buffer_load_dwordx4 v7, s[28:31], s44 offen offset:0 lds
 v_mfma_f32_16x16x32_bf16 v[160:163], v[24:27], v[80:83], v[160:163]
 ds_read_b64_tr_b16 v[60:61], v4 offset:25376
 v_mfma_f32_16x16x32_bf16 v[164:167], v[24:27], v[84:87], v[164:167]
 ds_read_b64_tr_b16 v[62:63], v4 offset:29600
 s_barrier
 v_mfma_f32_16x16x32_bf16 v[168:171], v[24:27], v[88:91], v[168:171]
 buffer_load_dwordx4 v8, s[28:31], s44 offen offset:1056 lds
 v_mfma_f32_16x16x32_bf16 v[172:175], v[24:27], v[92:95], v[172:175]
 ds_read_b64_tr_b16 v[64:65], v5 offset:25344
 v_mfma_f32_16x16x32_bf16 v[176:179], v[28:31], v[80:83], v[176:179]
 ds_read_b64_tr_b16 v[66:67], v5 offset:29568
 buffer_load_dwordx4 v9, s[28:31], s44 offen offset:2112 lds
 v_mfma_f32_16x16x32_bf16 v[180:183], v[28:31], v[84:87], v[180:183]
 ds_read_b64_tr_b16 v[68:69], v5 offset:25376
 v_mfma_f32_16x16x32_bf16 v[184:187], v[28:31], v[88:91], v[184:187]
 v_mfma_f32_16x16x32_bf16 v[188:191], v[28:31], v[92:95], v[188:191]
 ds_read_b64_tr_b16 v[70:71], v5 offset:29600
 buffer_load_dwordx4 v10, s[28:31], s44 offen offset:3168 lds
 v_mfma_f32_16x16x32_bf16 v[192:195], v[32:35], v[80:83], v[192:195]
 ds_read_b64_tr_b16 v[72:73], v6 offset:25344
 v_mfma_f32_16x16x32_bf16 v[196:199], v[32:35], v[84:87], v[196:199]
 ds_read_b64_tr_b16 v[74:75], v6 offset:29568
 v_mfma_f32_16x16x32_bf16 v[200:203], v[32:35], v[88:91], v[200:203]
 s_add_u32 m0, s46, 21120
 v_mfma_f32_16x16x32_bf16 v[204:207], v[32:35], v[92:95], v[204:207]
 ds_read_b64_tr_b16 v[76:77], v6 offset:25376
 v_mfma_f32_16x16x32_bf16 v[208:211], v[36:39], v[80:83], v[208:211]
 ds_read_b64_tr_b16 v[78:79], v6 offset:29600
 buffer_load_dwordx4 v7, s[28:31], s45 offen offset:0 lds
 v_mfma_f32_16x16x32_bf16 v[212:215], v[36:39], v[84:87], v[212:215]
 v_mfma_f32_16x16x32_bf16 v[216:219], v[36:39], v[88:91], v[216:219]
 v_mfma_f32_16x16x32_bf16 v[220:223], v[36:39], v[92:95], v[220:223]
 buffer_load_dwordx4 v8, s[28:31], s45 offen offset:1056 lds
 v_mfma_f32_16x16x32_bf16 v[224:227], v[40:43], v[80:83], v[224:227]
 v_mfma_f32_16x16x32_bf16 v[228:231], v[40:43], v[84:87], v[228:231]
 buffer_load_dwordx4 v9, s[28:31], s45 offen offset:2112 lds
 v_mfma_f32_16x16x32_bf16 v[232:235], v[40:43], v[88:91], v[232:235]
 v_mfma_f32_16x16x32_bf16 v[236:239], v[40:43], v[92:95], v[236:239]
 v_mfma_f32_16x16x32_bf16 v[240:243], v[44:47], v[80:83], v[240:243]
 buffer_load_dwordx4 v10, s[28:31], s45 offen offset:3168 lds
 s_add_u32 s44, s44, 262144
 s_add_u32 s45, s45, 262144
 v_mfma_f32_16x16x32_bf16 v[244:247], v[44:47], v[84:87], v[244:247]
 v_mfma_f32_16x16x32_bf16 v[248:251], v[44:47], v[88:91], v[248:251]
 v_mfma_f32_16x16x32_bf16 v[252:255], v[44:47], v[92:95], v[252:255]
 s_waitcnt vmcnt(20) lgkmcnt(0)
 v_mfma_f32_16x16x32_bf16 v[128:131], v[48:51], v[96:99], v[128:131]
 buffer_load_dwordx4 v[80:83], v11, s[24:27], s47 offen
 ds_read_b64_tr_b16 v[16:17], v3 offset:0
 v_mfma_f32_16x16x32_bf16 v[132:135], v[48:51], v[100:103], v[132:135]
 buffer_load_dwordx4 v[84:87], v11, s[24:27], s48 offen
 ds_read_b64_tr_b16 v[18:19], v3 offset:4224
 v_mfma_f32_16x16x32_bf16 v[136:139], v[48:51], v[104:107], v[136:139]
 buffer_load_dwordx4 v[88:91], v11, s[24:27], s49 offen
 ds_read_b64_tr_b16 v[20:21], v3 offset:32
 v_mfma_f32_16x16x32_bf16 v[140:143], v[48:51], v[108:111], v[140:143]
 buffer_load_dwordx4 v[92:95], v11, s[24:27], s50 offen
 s_add_u32 s24, s24, 4096
 s_addc_u32 s25, s25, 0
 v_mfma_f32_16x16x32_bf16 v[144:147], v[52:55], v[96:99], v[144:147]
 ds_read_b64_tr_b16 v[22:23], v3 offset:4256
 v_mfma_f32_16x16x32_bf16 v[148:151], v[52:55], v[100:103], v[148:151]
 ds_read_b64_tr_b16 v[24:25], v4 offset:0
 s_add_u32 m0, s46, 25344
 s_barrier
 v_mfma_f32_16x16x32_bf16 v[152:155], v[52:55], v[104:107], v[152:155]
 ds_read_b64_tr_b16 v[26:27], v4 offset:4224
 v_mfma_f32_16x16x32_bf16 v[156:159], v[52:55], v[108:111], v[156:159]
 buffer_load_dwordx4 v7, s[28:31], s44 offen offset:0 lds
 v_mfma_f32_16x16x32_bf16 v[160:163], v[56:59], v[96:99], v[160:163]
 ds_read_b64_tr_b16 v[28:29], v4 offset:32
 v_mfma_f32_16x16x32_bf16 v[164:167], v[56:59], v[100:103], v[164:167]
 ds_read_b64_tr_b16 v[30:31], v4 offset:4256
 v_mfma_f32_16x16x32_bf16 v[168:171], v[56:59], v[104:107], v[168:171]
 buffer_load_dwordx4 v8, s[28:31], s44 offen offset:1056 lds
 v_mfma_f32_16x16x32_bf16 v[172:175], v[56:59], v[108:111], v[172:175]
 ds_read_b64_tr_b16 v[32:33], v5 offset:0
 v_mfma_f32_16x16x32_bf16 v[176:179], v[60:63], v[96:99], v[176:179]
 ds_read_b64_tr_b16 v[34:35], v5 offset:4224
 buffer_load_dwordx4 v9, s[28:31], s44 offen offset:2112 lds
 v_mfma_f32_16x16x32_bf16 v[180:183], v[60:63], v[100:103], v[180:183]
 ds_read_b64_tr_b16 v[36:37], v5 offset:32
 v_mfma_f32_16x16x32_bf16 v[184:187], v[60:63], v[104:107], v[184:187]
 v_mfma_f32_16x16x32_bf16 v[188:191], v[60:63], v[108:111], v[188:191]
 ds_read_b64_tr_b16 v[38:39], v5 offset:4256
 buffer_load_dwordx4 v10, s[28:31], s44 offen offset:3168 lds
 v_mfma_f32_16x16x32_bf16 v[192:195], v[64:67], v[96:99], v[192:195]
 ds_read_b64_tr_b16 v[40:41], v6 offset:0
 v_mfma_f32_16x16x32_bf16 v[196:199], v[64:67], v[100:103], v[196:199]
 ds_read_b64_tr_b16 v[42:43], v6 offset:4224
 v_mfma_f32_16x16x32_bf16 v[200:203], v[64:67], v[104:107], v[200:203]
 s_add_u32 m0, s46, 29568
 v_mfma_f32_16x16x32_bf16 v[204:207], v[64:67], v[108:111], v[204:207]
 ds_read_b64_tr_b16 v[44:45], v6 offset:32
 v_mfma_f32_16x16x32_bf16 v[208:211], v[68:71], v[96:99], v[208:211]
 ds_read_b64_tr_b16 v[46:47], v6 offset:4256
 buffer_load_dwordx4 v7, s[28:31], s45 offen offset:0 lds
 v_mfma_f32_16x16x32_bf16 v[212:215], v[68:71], v[100:103], v[212:215]
 v_mfma_f32_16x16x32_bf16 v[216:219], v[68:71], v[104:107], v[216:219]
 v_mfma_f32_16x16x32_bf16 v[220:223], v[68:71], v[108:111], v[220:223]
 buffer_load_dwordx4 v8, s[28:31], s45 offen offset:1056 lds
 v_mfma_f32_16x16x32_bf16 v[224:227], v[72:75], v[96:99], v[224:227]
 v_mfma_f32_16x16x32_bf16 v[228:231], v[72:75], v[100:103], v[228:231]
 buffer_load_dwordx4 v9, s[28:31], s45 offen offset:2112 lds
 v_mfma_f32_16x16x32_bf16 v[232:235], v[72:75], v[104:107], v[232:235]
 v_mfma_f32_16x16x32_bf16 v[236:239], v[72:75], v[108:111], v[236:239]
 v_mfma_f32_16x16x32_bf16 v[240:243], v[76:79], v[96:99], v[240:243]
 buffer_load_dwordx4 v10, s[28:31], s45 offen offset:3168 lds
 s_add_u32 s44, s44, 262144
 s_add_u32 s45, s45, 262144
 v_mfma_f32_16x16x32_bf16 v[244:247], v[76:79], v[100:103], v[244:247]
 v_mfma_f32_16x16x32_bf16 v[248:251], v[76:79], v[104:107], v[248:251]
 v_mfma_f32_16x16x32_bf16 v[252:255], v[76:79], v[108:111], v[252:255]
 s_waitcnt vmcnt(20) lgkmcnt(0)
 v_mfma_f32_16x16x32_bf16 v[128:131], v[16:19], v[112:115], v[128:131]
 buffer_load_dwordx4 v[96:99], v11, s[24:27], s47 offen
 ds_read_b64_tr_b16 v[48:49], v3 offset:8448
 v_mfma_f32_16x16x32_bf16 v[132:135], v[16:19], v[116:119], v[132:135]
 buffer_load_dwordx4 v[100:103], v11, s[24:27], s48 offen
 ds_read_b64_tr_b16 v[50:51], v3 offset:12672
 v_mfma_f32_16x16x32_bf16 v[136:139], v[16:19], v[120:123], v[136:139]
 buffer_load_dwordx4 v[104:107], v11, s[24:27], s49 offen
 ds_read_b64_tr_b16 v[52:53], v3 offset:8480
 s_barrier
 v_mfma_f32_16x16x32_bf16 v[140:143], v[16:19], v[124:127], v[140:143]
 buffer_load_dwordx4 v[108:111], v11, s[24:27], s50 offen
 s_add_u32 s24, s24, 4096
 s_addc_u32 s25, s25, 0
 v_mfma_f32_16x16x32_bf16 v[144:147], v[20:23], v[112:115], v[144:147]
 ds_read_b64_tr_b16 v[54:55], v3 offset:12704
 v_mfma_f32_16x16x32_bf16 v[148:151], v[20:23], v[116:119], v[148:151]
 ds_read_b64_tr_b16 v[56:57], v4 offset:8448
 s_add_u32 m0, s46, 0
 v_mfma_f32_16x16x32_bf16 v[152:155], v[20:23], v[120:123], v[152:155]
 ds_read_b64_tr_b16 v[58:59], v4 offset:12672
 v_mfma_f32_16x16x32_bf16 v[156:159], v[20:23], v[124:127], v[156:159]
 buffer_load_dwordx4 v7, s[28:31], s44 offen offset:0 lds
 v_mfma_f32_16x16x32_bf16 v[160:163], v[24:27], v[112:115], v[160:163]
 ds_read_b64_tr_b16 v[60:61], v4 offset:8480
 v_mfma_f32_16x16x32_bf16 v[164:167], v[24:27], v[116:119], v[164:167]
 ds_read_b64_tr_b16 v[62:63], v4 offset:12704
 v_mfma_f32_16x16x32_bf16 v[168:171], v[24:27], v[120:123], v[168:171]
 buffer_load_dwordx4 v8, s[28:31], s44 offen offset:1056 lds
 v_mfma_f32_16x16x32_bf16 v[172:175], v[24:27], v[124:127], v[172:175]
 ds_read_b64_tr_b16 v[64:65], v5 offset:8448
 v_mfma_f32_16x16x32_bf16 v[176:179], v[28:31], v[112:115], v[176:179]
 ds_read_b64_tr_b16 v[66:67], v5 offset:12672
 buffer_load_dwordx4 v9, s[28:31], s44 offen offset:2112 lds
 v_mfma_f32_16x16x32_bf16 v[180:183], v[28:31], v[116:119], v[180:183]
 ds_read_b64_tr_b16 v[68:69], v5 offset:8480
 v_mfma_f32_16x16x32_bf16 v[184:187], v[28:31], v[120:123], v[184:187]
 v_mfma_f32_16x16x32_bf16 v[188:191], v[28:31], v[124:127], v[188:191]
 ds_read_b64_tr_b16 v[70:71], v5 offset:12704
 buffer_load_dwordx4 v10, s[28:31], s44 offen offset:3168 lds
 v_mfma_f32_16x16x32_bf16 v[192:195], v[32:35], v[112:115], v[192:195]
 ds_read_b64_tr_b16 v[72:73], v6 offset:8448
 v_mfma_f32_16x16x32_bf16 v[196:199], v[32:35], v[116:119], v[196:199]
 ds_read_b64_tr_b16 v[74:75], v6 offset:12672
 v_mfma_f32_16x16x32_bf16 v[200:203], v[32:35], v[120:123], v[200:203]
 s_add_u32 m0, s46, 4224
 v_mfma_f32_16x16x32_bf16 v[204:207], v[32:35], v[124:127], v[204:207]
 ds_read_b64_tr_b16 v[76:77], v6 offset:8480
 v_mfma_f32_16x16x32_bf16 v[208:211], v[36:39], v[112:115], v[208:211]
 ds_read_b64_tr_b16 v[78:79], v6 offset:12704
 buffer_load_dwordx4 v7, s[28:31], s45 offen offset:0 lds
 v_mfma_f32_16x16x32_bf16 v[212:215], v[36:39], v[116:119], v[212:215]
 v_mfma_f32_16x16x32_bf16 v[216:219], v[36:39], v[120:123], v[216:219]
 v_mfma_f32_16x16x32_bf16 v[220:223], v[36:39], v[124:127], v[220:223]
 buffer_load_dwordx4 v8, s[28:31], s45 offen offset:1056 lds
 v_mfma_f32_16x16x32_bf16 v[224:227], v[40:43], v[112:115], v[224:227]
 v_mfma_f32_16x16x32_bf16 v[228:231], v[40:43], v[116:119], v[228:231]
 buffer_load_dwordx4 v9, s[28:31], s45 offen offset:2112 lds
 v_mfma_f32_16x16x32_bf16 v[232:235], v[40:43], v[120:123], v[232:235]
 v_mfma_f32_16x16x32_bf16 v[236:239], v[40:43], v[124:127], v[236:239]
 v_mfma_f32_16x16x32_bf16 v[240:243], v[44:47], v[112:115], v[240:243]
 buffer_load_dwordx4 v10, s[28:31], s45 offen offset:3168 lds
 s_add_u32 s44, s44, 262144
 s_add_u32 s45, s45, 262144
 v_mfma_f32_16x16x32_bf16 v[244:247], v[44:47], v[116:119], v[244:247]
 v_mfma_f32_16x16x32_bf16 v[248:251], v[44:47], v[120:123], v[248:251]
 v_mfma_f32_16x16x32_bf16 v[252:255], v[44:47], v[124:127], v[252:255]
 s_waitcnt vmcnt(20) lgkmcnt(0)
 s_barrier
 v_mfma_f32_16x16x32_bf16 v[128:131], v[48:51], v[80:83], v[128:131]
 buffer_load_dwordx4 v[112:115], v11, s[24:27], s47 offen
 ds_read_b64_tr_b16 v[16:17], v3 offset:16896
 v_mfma_f32_16x16x32_bf16 v[132:135], v[48:51], v[84:87], v[132:135]
 buffer_load_dwordx4 v[116:119], v11, s[24:27], s48 offen
 ds_read_b64_tr_b16 v[18:19], v3 offset:21120
 v_mfma_f32_16x16x32_bf16 v[136:139], v[48:51], v[88:91], v[136:139]
 buffer_load_dwordx4 v[120:123], v11, s[24:27], s49 offen
 ds_read_b64_tr_b16 v[20:21], v3 offset:16928
 v_mfma_f32_16x16x32_bf16 v[140:143], v[48:51], v[92:95], v[140:143]
 buffer_load_dwordx4 v[124:127], v11, s[24:27], s50 offen
 s_add_u32 s24, s24, 4096
 s_addc_u32 s25, s25, 0
 v_mfma_f32_16x16x32_bf16 v[144:147], v[52:55], v[80:83], v[144:147]
 ds_read_b64_tr_b16 v[22:23], v3 offset:21152
 v_mfma_f32_16x16x32_bf16 v[148:151], v[52:55], v[84:87], v[148:151]
 ds_read_b64_tr_b16 v[24:25], v4 offset:16896
 s_add_u32 m0, s46, 8448
 v_mfma_f32_16x16x32_bf16 v[152:155], v[52:55], v[88:91], v[152:155]
 ds_read_b64_tr_b16 v[26:27], v4 offset:21120
 v_mfma_f32_16x16x32_bf16 v[156:159], v[52:55], v[92:95], v[156:159]
 buffer_load_dwordx4 v7, s[28:31], s44 offen offset:0 lds
 v_mfma_f32_16x16x32_bf16 v[160:163], v[56:59], v[80:83], v[160:163]
 ds_read_b64_tr_b16 v[28:29], v4 offset:16928
 v_mfma_f32_16x16x32_bf16 v[164:167], v[56:59], v[84:87], v[164:167]
 ds_read_b64_tr_b16 v[30:31], v4 offset:21152
 v_mfma_f32_16x16x32_bf16 v[168:171], v[56:59], v[88:91], v[168:171]
 buffer_load_dwordx4 v8, s[28:31], s44 offen offset:1056 lds
 v_mfma_f32_16x16x32_bf16 v[172:175], v[56:59], v[92:95], v[172:175]
 ds_read_b64_tr_b16 v[32:33], v5 offset:16896
 v_mfma_f32_16x16x32_bf16 v[176:179], v[60:63], v[80:83], v[176:179]
 ds_read_b64_tr_b16 v[34:35], v5 offset:21120
 buffer_load_dwordx4 v9, s[28:31], s44 offen offset:2112 lds
 v_mfma_f32_16x16x32_bf16 v[180:183], v[60:63], v[84:87], v[180:183]
 ds_read_b64_tr_b16 v[36:37], v5 offset:16928
 v_mfma_f32_16x16x32_bf16 v[184:187], v[60:63], v[88:91], v[184:187]
 v_mfma_f32_16x16x32_bf16 v[188:191], v[60:63], v[92:95], v[188:191]
 ds_read_b64_tr_b16 v[38:39], v5 offset:21152
 buffer_load_dwordx4 v10, s[28:31], s44 offen offset:3168 lds
 v_mfma_f32_16x16x32_bf16 v[192:195], v[64:67], v[80:83], v[192:195]
 ds_read_b64_tr_b16 v[40:41], v6 offset:16896
 v_mfma_f32_16x16x32_bf16 v[196:199], v[64:67], v[84:87], v[196:199]
 ds_read_b64_tr_b16 v[42:43], v6 offset:21120
 v_mfma_f32_16x16x32_bf16 v[200:203], v[64:67], v[88:91], v[200:203]
 s_add_u32 m0, s46, 12672
 v_mfma_f32_16x16x32_bf16 v[204:207], v[64:67], v[92:95], v[204:207]
 ds_read_b64_tr_b16 v[44:45], v6 offset:16928
 v_mfma_f32_16x16x32_bf16 v[208:211], v[68:71], v[80:83], v[208:211]
 ds_read_b64_tr_b16 v[46:47], v6 offset:21152
 buffer_load_dwordx4 v7, s[28:31], s45 offen offset:0 lds
 v_mfma_f32_16x16x32_bf16 v[212:215], v[68:71], v[84:87], v[212:215]
 v_mfma_f32_16x16x32_bf16 v[216:219], v[68:71], v[88:91], v[216:219]
 v_mfma_f32_16x16x32_bf16 v[220:223], v[68:71], v[92:95], v[220:223]
 buffer_load_dwordx4 v8, s[28:31], s45 offen offset:1056 lds
 v_mfma_f32_16x16x32_bf16 v[224:227], v[72:75], v[80:83], v[224:227]
 v_mfma_f32_16x16x32_bf16 v[228:231], v[72:75], v[84:87], v[228:231]
 buffer_load_dwordx4 v9, s[28:31], s45 offen offset:2112 lds
 v_mfma_f32_16x16x32_bf16 v[232:235], v[72:75], v[88:91], v[232:235]
 v_mfma_f32_16x16x32_bf16 v[236:239], v[72:75], v[92:95], v[236:239]
 v_mfma_f32_16x16x32_bf16 v[240:243], v[76:79], v[80:83], v[240:243]
 buffer_load_dwordx4 v10, s[28:31], s45 offen offset:3168 lds
 s_add_u32 s44, s44, 262144
 s_add_u32 s45, s45, 262144
 s_barrier
 v_mfma_f32_16x16x32_bf16 v[244:247], v[76:79], v[84:87], v[244:247]
 v_mfma_f32_16x16x32_bf16 v[248:251], v[76:79], v[88:91], v[248:251]
 v_mfma_f32_16x16x32_bf16 v[252:255], v[76:79], v[92:95], v[252:255]
 s_waitcnt vmcnt(20) lgkmcnt(0)
 v_mfma_f32_16x16x32_bf16 v[128:131], v[16:19], v[96:99], v[128:131]
 buffer_load_dwordx4 v[80:83], v11, s[24:27], s47 offen
 ds_read_b64_tr_b16 v[48:49], v3 offset:25344
 v_mfma_f32_16x16x32_bf16 v[132:135], v[16:19], v[100:103], v[132:135]
 buffer_load_dwordx4 v[84:87], v11, s[24:27], s48 offen
 ds_read_b64_tr_b16 v[50:51], v3 offset:29568
 v_mfma_f32_16x16x32_bf16 v[136:139], v[16:19], v[104:107], v[136:139]
 buffer_load_dwordx4 v[88:91], v11, s[24:27], s49 offen
 ds_read_b64_tr_b16 v[52:53], v3 offset:25376
 v_mfma_f32_16x16x32_bf16 v[140:143], v[16:19], v[108:111], v[140:143]
 buffer_load_dwordx4 v[92:95], v11, s[24:27], s50 offen
 s_add_u32 s24, s24, 4096
 s_addc_u32 s25, s25, 0
 v_mfma_f32_16x16x32_bf16 v[144:147], v[20:23], v[96:99], v[144:147]
 ds_read_b64_tr_b16 v[54:55], v3 offset:29600
 v_mfma_f32_16x16x32_bf16 v[148:151], v[20:23], v[100:103], v[148:151]
 ds_read_b64_tr_b16 v[56:57], v4 offset:25344
 s_add_u32 m0, s46, 16896
 v_mfma_f32_16x16x32_bf16 v[152:155], v[20:23], v[104:107], v[152:155]
 ds_read_b64_tr_b16 v[58:59], v4 offset:29568
 v_mfma_f32_16x16x32_bf16 v[156:159], v[20:23], v[108:111], v[156:159]
 buffer_load_dwordx4 v7, s[28:31], s44 offen offset:0 lds
 v_mfma_f32_16x16x32_bf16 v[160:163], v[24:27], v[96:99], v[160:163]
 ds_read_b64_tr_b16 v[60:61], v4 offset:25376
 v_mfma_f32_16x16x32_bf16 v[164:167], v[24:27], v[100:103], v[164:167]
 ds_read_b64_tr_b16 v[62:63], v4 offset:29600
 v_mfma_f32_16x16x32_bf16 v[168:171], v[24:27], v[104:107], v[168:171]
 buffer_load_dwordx4 v8, s[28:31], s44 offen offset:1056 lds
 v_mfma_f32_16x16x32_bf16 v[172:175], v[24:27], v[108:111], v[172:175]
 ds_read_b64_tr_b16 v[64:65], v5 offset:25344
 v_mfma_f32_16x16x32_bf16 v[176:179], v[28:31], v[96:99], v[176:179]
 ds_read_b64_tr_b16 v[66:67], v5 offset:29568
 buffer_load_dwordx4 v9, s[28:31], s44 offen offset:2112 lds
 v_mfma_f32_16x16x32_bf16 v[180:183], v[28:31], v[100:103], v[180:183]
 ds_read_b64_tr_b16 v[68:69], v5 offset:25376
 v_mfma_f32_16x16x32_bf16 v[184:187], v[28:31], v[104:107], v[184:187]
 v_mfma_f32_16x16x32_bf16 v[188:191], v[28:31], v[108:111], v[188:191]
 ds_read_b64_tr_b16 v[70:71], v5 offset:29600
 buffer_load_dwordx4 v10, s[28:31], s44 offen offset:3168 lds
 v_mfma_f32_16x16x32_bf16 v[192:195], v[32:35], v[96:99], v[192:195]
 ds_read_b64_tr_b16 v[72:73], v6 offset:25344
 v_mfma_f32_16x16x32_bf16 v[196:199], v[32:35], v[100:103], v[196:199]
 ds_read_b64_tr_b16 v[74:75], v6 offset:29568
 v_mfma_f32_16x16x32_bf16 v[200:203], v[32:35], v[104:107], v[200:203]
 s_add_u32 m0, s46, 21120
 v_mfma_f32_16x16x32_bf16 v[204:207], v[32:35], v[108:111], v[204:207]
 ds_read_b64_tr_b16 v[76:77], v6 offset:25376
 v_mfma_f32_16x16x32_bf16 v[208:211], v[36:39], v[96:99], v[208:211]
 ds_read_b64_tr_b16 v[78:79], v6 offset:29600
 buffer_load_dwordx4 v7, s[28:31], s45 offen offset:0 lds
 v_mfma_f32_16x16x32_bf16 v[212:215], v[36:39], v[100:103], v[212:215]
 v_mfma_f32_16x16x32_bf16 v[216:219], v[36:39], v[104:107], v[216:219]
 v_mfma_f32_16x16x32_bf16 v[220:223], v[36:39], v[108:111], v[220:223]
 buffer_load_dwordx4 v8, s[28:31], s45 offen offset:1056 lds
 v_mfma_f32_16x16x32_bf16 v[224:227], v[40:43], v[96:99], v[224:227]
 v_mfma_f32_16x16x32_bf16 v[228:231], v[40:43], v[100:103], v[228:231]
 buffer_load_dwordx4 v9, s[28:31], s45 offen offset:2112 lds
 s_barrier
 v_mfma_f32_16x16x32_bf16 v[232:235], v[40:43], v[104:107], v[232:235]
 v_mfma_f32_16x16x32_bf16 v[236:239], v[40:43], v[108:111], v[236:239]
 v_mfma_f32_16x16x32_bf16 v[240:243], v[44:47], v[96:99], v[240:243]
 buffer_load_dwordx4 v10, s[28:31], s45 offen offset:3168 lds
 s_add_u32 s44, s44, 262144
 s_add_u32 s45, s45, 262144
 v_mfma_f32_16x16x32_bf16 v[244:247], v[44:47], v[100:103], v[244:247]
 v_mfma_f32_16x16x32_bf16 v[248:251], v[44:47], v[104:107], v[248:251]
 v_mfma_f32_16x16x32_bf16 v[252:255], v[44:47], v[108:111], v[252:255]
 s_waitcnt vmcnt(20) lgkmcnt(0)
 v_mfma_f32_16x16x32_bf16 v[128:131], v[48:51], v[112:115], v[128:131]
 buffer_load_dwordx4 v[96:99], v11, s[24:27], s47 offen
 ds_read_b64_tr_b16 v[16:17], v3 offset:0
 v_mfma_f32_16x16x32_bf16 v[132:135], v[48:51], v[116:119], v[132:135]
 buffer_load_dwordx4 v[100:103], v11, s[24:27], s48 offen
 ds_read_b64_tr_b16 v[18:19], v3 offset:4224
 v_mfma_f32_16x16x32_bf16 v[136:139], v[48:51], v[120:123], v[136:139]
 buffer_load_dwordx4 v[104:107], v11, s[24:27], s49 offen
 ds_read_b64_tr_b16 v[20:21], v3 offset:32
 v_mfma_f32_16x16x32_bf16 v[140:143], v[48:51], v[124:127], v[140:143]
 buffer_load_dwordx4 v[108:111], v11, s[24:27], s50 offen
 s_add_u32 s24, s24, 4096
 s_addc_u32 s25, s25, 0
 v_mfma_f32_16x16x32_bf16 v[144:147], v[52:55], v[112:115], v[144:147]
 ds_read_b64_tr_b16 v[22:23], v3 offset:4256
 v_mfma_f32_16x16x32_bf16 v[148:151], v[52:55], v[116:119], v[148:151]
 ds_read_b64_tr_b16 v[24:25], v4 offset:0
 s_add_u32 m0, s46, 25344
 v_mfma_f32_16x16x32_bf16 v[152:155], v[52:55], v[120:123], v[152:155]
 ds_read_b64_tr_b16 v[26:27], v4 offset:4224
 v_mfma_f32_16x16x32_bf16 v[156:159], v[52:55], v[124:127], v[156:159]
 buffer_load_dwordx4 v7, s[28:31], s44 offen offset:0 lds
 v_mfma_f32_16x16x32_bf16 v[160:163], v[56:59], v[112:115], v[160:163]
 ds_read_b64_tr_b16 v[28:29], v4 offset:32
 v_mfma_f32_16x16x32_bf16 v[164:167], v[56:59], v[116:119], v[164:167]
 ds_read_b64_tr_b16 v[30:31], v4 offset:4256
 v_mfma_f32_16x16x32_bf16 v[168:171], v[56:59], v[120:123], v[168:171]
 buffer_load_dwordx4 v8, s[28:31], s44 offen offset:1056 lds
 v_mfma_f32_16x16x32_bf16 v[172:175], v[56:59], v[124:127], v[172:175]
 ds_read_b64_tr_b16 v[32:33], v5 offset:0
 v_mfma_f32_16x16x32_bf16 v[176:179], v[60:63], v[112:115], v[176:179]
 ds_read_b64_tr_b16 v[34:35], v5 offset:4224
 buffer_load_dwordx4 v9, s[28:31], s44 offen offset:2112 lds
 v_mfma_f32_16x16x32_bf16 v[180:183], v[60:63], v[116:119], v[180:183]
 ds_read_b64_tr_b16 v[36:37], v5 offset:32
 v_mfma_f32_16x16x32_bf16 v[184:187], v[60:63], v[120:123], v[184:187]
 v_mfma_f32_16x16x32_bf16 v[188:191], v[60:63], v[124:127], v[188:191]
 ds_read_b64_tr_b16 v[38:39], v5 offset:4256
 buffer_load_dwordx4 v10, s[28:31], s44 offen offset:3168 lds
 v_mfma_f32_16x16x32_bf16 v[192:195], v[64:67], v[112:115], v[192:195]
 ds_read_b64_tr_b16 v[40:41], v6 offset:0
 v_mfma_f32_16x16x32_bf16 v[196:199], v[64:67], v[116:119], v[196:199]
 ds_read_b64_tr_b16 v[42:43], v6 offset:4224
 v_mfma_f32_16x16x32_bf16 v[200:203], v[64:67], v[120:123], v[200:203]
 s_add_u32 m0, s46, 29568
 v_mfma_f32_16x16x32_bf16 v[204:207], v[64:67], v[124:127], v[204:207]
 ds_read_b64_tr_b16 v[44:45], v6 offset:32
 v_mfma_f32_16x16x32_bf16 v[208:211], v[68:71], v[112:115], v[208:211]
 ds_read_b64_tr_b16 v[46:47], v6 offset:4256
 buffer_load_dwordx4 v7, s[28:31], s45 offen offset:0 lds
 v_mfma_f32_16x16x32_bf16 v[212:215], v[68:71], v[116:119], v[212:215]
 s_barrier
 v_mfma_f32_16x16x32_bf16 v[216:219], v[68:71], v[120:123], v[216:219]
 v_mfma_f32_16x16x32_bf16 v[220:223], v[68:71], v[124:127], v[220:223]
 buffer_load_dwordx4 v8, s[28:31], s45 offen offset:1056 lds
 v_mfma_f32_16x16x32_bf16 v[224:227], v[72:75], v[112:115], v[224:227]
 v_mfma_f32_16x16x32_bf16 v[228:231], v[72:75], v[116:119], v[228:231]
 buffer_load_dwordx4 v9, s[28:31], s45 offen offset:2112 lds
 v_mfma_f32_16x16x32_bf16 v[232:235], v[72:75], v[120:123], v[232:235]
 v_mfma_f32_16x16x32_bf16 v[236:239], v[72:75], v[124:127], v[236:239]
 v_mfma_f32_16x16x32_bf16 v[240:243], v[76:79], v[112:115], v[240:243]
 buffer_load_dwordx4 v10, s[28:31], s45 offen offset:3168 lds
 s_add_u32 s44, s44, 262144
 s_add_u32 s45, s45, 262144
 v_mfma_f32_16x16x32_bf16 v[244:247], v[76:79], v[116:119], v[244:247]
 v_mfma_f32_16x16x32_bf16 v[248:251], v[76:79], v[120:123], v[248:251]
 v_mfma_f32_16x16x32_bf16 v[252:255], v[76:79], v[124:127], v[252:255]
 s_waitcnt vmcnt(20) lgkmcnt(0)
 v_mfma_f32_16x16x32_bf16 v[128:131], v[16:19], v[80:83], v[128:131]
 buffer_load_dwordx4 v[112:115], v11, s[24:27], s47 offen
 ds_read_b64_tr_b16 v[48:49], v3 offset:8448
 v_mfma_f32_16x16x32_bf16 v[132:135], v[16:19], v[84:87], v[132:135]
 buffer_load_dwordx4 v[116:119], v11, s[24:27], s48 offen
 ds_read_b64_tr_b16 v[50:51], v3 offset:12672
 v_mfma_f32_16x16x32_bf16 v[136:139], v[16:19], v[88:91], v[136:139]
 buffer_load_dwordx4 v[120:123], v11, s[24:27], s49 offen
 ds_read_b64_tr_b16 v[52:53], v3 offset:8480
 v_mfma_f32_16x16x32_bf16 v[140:143], v[16:19], v[92:95], v[140:143]
 buffer_load_dwordx4 v[124:127], v11, s[24:27], s50 offen
 s_add_u32 s24, s24, 4096
 s_addc_u32 s25, s25, 0
 v_mfma_f32_16x16x32_bf16 v[144:147], v[20:23], v[80:83], v[144:147]
 ds_read_b64_tr_b16 v[54:55], v3 offset:12704
 v_mfma_f32_16x16x32_bf16 v[148:151], v[20:23], v[84:87], v[148:151]
 ds_read_b64_tr_b16 v[56:57], v4 offset:8448
 s_add_u32 m0, s46, 0
 v_mfma_f32_16x16x32_bf16 v[152:155], v[20:23], v[88:91], v[152:155]
 ds_read_b64_tr_b16 v[58:59], v4 offset:12672
 v_mfma_f32_16x16x32_bf16 v[156:159], v[20:23], v[92:95], v[156:159]
 buffer_load_dwordx4 v7, s[28:31], s44 offen offset:0 lds
 v_mfma_f32_16x16x32_bf16 v[160:163], v[24:27], v[80:83], v[160:163]
 ds_read_b64_tr_b16 v[60:61], v4 offset:8480
 v_mfma_f32_16x16x32_bf16 v[164:167], v[24:27], v[84:87], v[164:167]
 ds_read_b64_tr_b16 v[62:63], v4 offset:12704
 v_mfma_f32_16x16x32_bf16 v[168:171], v[24:27], v[88:91], v[168:171]
 buffer_load_dwordx4 v8, s[28:31], s44 offen offset:1056 lds
 v_mfma_f32_16x16x32_bf16 v[172:175], v[24:27], v[92:95], v[172:175]
 ds_read_b64_tr_b16 v[64:65], v5 offset:8448
 v_mfma_f32_16x16x32_bf16 v[176:179], v[28:31], v[80:83], v[176:179]
 ds_read_b64_tr_b16 v[66:67], v5 offset:12672
 buffer_load_dwordx4 v9, s[28:31], s44 offen offset:2112 lds
 v_mfma_f32_16x16x32_bf16 v[180:183], v[28:31], v[84:87], v[180:183]
 ds_read_b64_tr_b16 v[68:69], v5 offset:8480
 v_mfma_f32_16x16x32_bf16 v[184:187], v[28:31], v[88:91], v[184:187]
 v_mfma_f32_16x16x32_bf16 v[188:191], v[28:31], v[92:95], v[188:191]
 ds_read_b64_tr_b16 v[70:71], v5 offset:12704
 buffer_load_dwordx4 v10, s[28:31], s44 offen offset:3168 lds
 v_mfma_f32_16x16x32_bf16 v[192:195], v[32:35], v[80:83], v[192:195]
 ds_read_b64_tr_b16 v[72:73], v6 offset:8448
 v_mfma_f32_16x16x32_bf16 v[196:199], v[32:35], v[84:87], v[196:199]
 ds_read_b64_tr_b16 v[74:75], v6 offset:12672
 v_mfma_f32_16x16x32_bf16 v[200:203], v[32:35], v[88:91], v[200:203]
 s_add_u32 m0, s46, 4224
 s_barrier
 v_mfma_f32_16x16x32_bf16 v[204:207], v[32:35], v[92:95], v[204:207]
 ds_read_b64_tr_b16 v[76:77], v6 offset:8480
 v_mfma_f32_16x16x32_bf16 v[208:211], v[36:39], v[80:83], v[208:211]
 ds_read_b64_tr_b16 v[78:79], v6 offset:12704
 buffer_load_dwordx4 v7, s[28:31], s45 offen offset:0 lds
 v_mfma_f32_16x16x32_bf16 v[212:215], v[36:39], v[84:87], v[212:215]
 v_mfma_f32_16x16x32_bf16 v[216:219], v[36:39], v[88:91], v[216:219]
 v_mfma_f32_16x16x32_bf16 v[220:223], v[36:39], v[92:95], v[220:223]
 buffer_load_dwordx4 v8, s[28:31], s45 offen offset:1056 lds
 v_mfma_f32_16x16x32_bf16 v[224:227], v[40:43], v[80:83], v[224:227]
 v_mfma_f32_16x16x32_bf16 v[228:231], v[40:43], v[84:87], v[228:231]
 buffer_load_dwordx4 v9, s[28:31], s45 offen offset:2112 lds
 v_mfma_f32_16x16x32_bf16 v[232:235], v[40:43], v[88:91], v[232:235]
 v_mfma_f32_16x16x32_bf16 v[236:239], v[40:43], v[92:95], v[236:239]
 v_mfma_f32_16x16x32_bf16 v[240:243], v[44:47], v[80:83], v[240:243]
 buffer_load_dwordx4 v10, s[28:31], s45 offen offset:3168 lds
 s_add_u32 s44, s44, 262144
 s_add_u32 s45, s45, 262144
 v_mfma_f32_16x16x32_bf16 v[244:247], v[44:47], v[84:87], v[244:247]
 v_mfma_f32_16x16x32_bf16 v[248:251], v[44:47], v[88:91], v[248:251]
 v_mfma_f32_16x16x32_bf16 v[252:255], v[44:47], v[92:95], v[252:255]
 s_waitcnt vmcnt(20) lgkmcnt(0)
 v_mfma_f32_16x16x32_bf16 v[128:131], v[48:51], v[96:99], v[128:131]
 buffer_load_dwordx4 v[80:83], v11, s[24:27], s47 offen
 ds_read_b64_tr_b16 v[16:17], v3 offset:16896
 v_mfma_f32_16x16x32_bf16 v[132:135], v[48:51], v[100:103], v[132:135]
 buffer_load_dwordx4 v[84:87], v11, s[24:27], s48 offen
 ds_read_b64_tr_b16 v[18:19], v3 offset:21120
 v_mfma_f32_16x16x32_bf16 v[136:139], v[48:51], v[104:107], v[136:139]
 buffer_load_dwordx4 v[88:91], v11, s[24:27], s49 offen
 ds_read_b64_tr_b16 v[20:21], v3 offset:16928
 v_mfma_f32_16x16x32_bf16 v[140:143], v[48:51], v[108:111], v[140:143]
 buffer_load_dwordx4 v[92:95], v11, s[24:27], s50 offen
 s_add_u32 s24, s24, 4096
 s_addc_u32 s25, s25, 0
 v_mfma_f32_16x16x32_bf16 v[144:147], v[52:55], v[96:99], v[144:147]
 ds_read_b64_tr_b16 v[22:23], v3 offset:21152
 v_mfma_f32_16x16x32_bf16 v[148:151], v[52:55], v[100:103], v[148:151]
 ds_read_b64_tr_b16 v[24:25], v4 offset:16896
 s_add_u32 m0, s46, 8448
 v_mfma_f32_16x16x32_bf16 v[152:155], v[52:55], v[104:107], v[152:155]
 ds_read_b64_tr_b16 v[26:27], v4 offset:21120
 v_mfma_f32_16x16x32_bf16 v[156:159], v[52:55], v[108:111], v[156:159]
 buffer_load_dwordx4 v7, s[28:31], s44 offen offset:0 lds
 v_mfma_f32_16x16x32_bf16 v[160:163], v[56:59], v[96:99], v[160:163]
 ds_read_b64_tr_b16 v[28:29], v4 offset:16928
 v_mfma_f32_16x16x32_bf16 v[164:167], v[56:59], v[100:103], v[164:167]
 ds_read_b64_tr_b16 v[30:31], v4 offset:21152
 v_mfma_f32_16x16x32_bf16 v[168:171], v[56:59], v[104:107], v[168:171]
 buffer_load_dwordx4 v8, s[28:31], s44 offen offset:1056 lds
 v_mfma_f32_16x16x32_bf16 v[172:175], v[56:59], v[108:111], v[172:175]
 ds_read_b64_tr_b16 v[32:33], v5 offset:16896
 v_mfma_f32_16x16x32_bf16 v[176:179], v[60:63], v[96:99], v[176:179]
 ds_read_b64_tr_b16 v[34:35], v5 offset:21120
 buffer_load_dwordx4 v9, s[28:31], s44 offen offset:2112 lds
 v_mfma_f32_16x16x32_bf16 v[180:183], v[60:63], v[100:103], v[180:183]
 ds_read_b64_tr_b16 v[36:37], v5 offset:16928
 v_mfma_f32_16x16x32_bf16 v[184:187], v[60:63], v[104:107], v[184:187]
 v_mfma_f32_16x16x32_bf16 v[188:191], v[60:63], v[108:111], v[188:191]
 ds_read_b64_tr_b16 v[38:39], v5 offset:21152
 buffer_load_dwordx4 v10, s[28:31], s44 offen offset:3168 lds
 s_barrier
 v_mfma_f32_16x16x32_bf16 v[192:195], v[64:67], v[96:99], v[192:195]
 ds_read_b64_tr_b16 v[40:41], v6 offset:16896
 v_mfma_f32_16x16x32_bf16 v[196:199], v[64:67], v[100:103], v[196:199]
 ds_read_b64_tr_b16 v[42:43], v6 offset:21120
 v_mfma_f32_16x16x32_bf16 v[200:203], v[64:67], v[104:107], v[200:203]
 s_add_u32 m0, s46, 12672
 v_mfma_f32_16x16x32_bf16 v[204:207], v[64:67], v[108:111], v[204:207]
 ds_read_b64_tr_b16 v[44:45], v6 offset:16928
 v_mfma_f32_16x16x32_bf16 v[208:211], v[68:71], v[96:99], v[208:211]
 ds_read_b64_tr_b16 v[46:47], v6 offset:21152
 buffer_load_dwordx4 v7, s[28:31], s45 offen offset:0 lds
 v_mfma_f32_16x16x32_bf16 v[212:215], v[68:71], v[100:103], v[212:215]
 v_mfma_f32_16x16x32_bf16 v[216:219], v[68:71], v[104:107], v[216:219]
 v_mfma_f32_16x16x32_bf16 v[220:223], v[68:71], v[108:111], v[220:223]
 buffer_load_dwordx4 v8, s[28:31], s45 offen offset:1056 lds
 v_mfma_f32_16x16x32_bf16 v[224:227], v[72:75], v[96:99], v[224:227]
 v_mfma_f32_16x16x32_bf16 v[228:231], v[72:75], v[100:103], v[228:231]
 buffer_load_dwordx4 v9, s[28:31], s45 offen offset:2112 lds
 v_mfma_f32_16x16x32_bf16 v[232:235], v[72:75], v[104:107], v[232:235]
 v_mfma_f32_16x16x32_bf16 v[236:239], v[72:75], v[108:111], v[236:239]
 v_mfma_f32_16x16x32_bf16 v[240:243], v[76:79], v[96:99], v[240:243]
 buffer_load_dwordx4 v10, s[28:31], s45 offen offset:3168 lds
 s_add_u32 s44, s44, 262144
 s_add_u32 s45, s45, 262144
 v_mfma_f32_16x16x32_bf16 v[244:247], v[76:79], v[100:103], v[244:247]
 v_mfma_f32_16x16x32_bf16 v[248:251], v[76:79], v[104:107], v[248:251]
 v_mfma_f32_16x16x32_bf16 v[252:255], v[76:79], v[108:111], v[252:255]
 s_waitcnt vmcnt(20) lgkmcnt(0)
 v_mfma_f32_16x16x32_bf16 v[128:131], v[16:19], v[112:115], v[128:131]
 buffer_load_dwordx4 v[96:99], v11, s[24:27], s47 offen
 ds_read_b64_tr_b16 v[48:49], v3 offset:25344
 v_mfma_f32_16x16x32_bf16 v[132:135], v[16:19], v[116:119], v[132:135]
 buffer_load_dwordx4 v[100:103], v11, s[24:27], s48 offen
 ds_read_b64_tr_b16 v[50:51], v3 offset:29568
 v_mfma_f32_16x16x32_bf16 v[136:139], v[16:19], v[120:123], v[136:139]
 buffer_load_dwordx4 v[104:107], v11, s[24:27], s49 offen
 ds_read_b64_tr_b16 v[52:53], v3 offset:25376
 v_mfma_f32_16x16x32_bf16 v[140:143], v[16:19], v[124:127], v[140:143]
 buffer_load_dwordx4 v[108:111], v11, s[24:27], s50 offen
 s_add_u32 s24, s24, 4096
 s_addc_u32 s25, s25, 0
 v_mfma_f32_16x16x32_bf16 v[144:147], v[20:23], v[112:115], v[144:147]
 ds_read_b64_tr_b16 v[54:55], v3 offset:29600
 v_mfma_f32_16x16x32_bf16 v[148:151], v[20:23], v[116:119], v[148:151]
 ds_read_b64_tr_b16 v[56:57], v4 offset:25344
 s_add_u32 m0, s46, 16896
 v_mfma_f32_16x16x32_bf16 v[152:155], v[20:23], v[120:123], v[152:155]
 ds_read_b64_tr_b16 v[58:59], v4 offset:29568
 v_mfma_f32_16x16x32_bf16 v[156:159], v[20:23], v[124:127], v[156:159]
 buffer_load_dwordx4 v7, s[28:31], s44 offen offset:0 lds
 v_mfma_f32_16x16x32_bf16 v[160:163], v[24:27], v[112:115], v[160:163]
 ds_read_b64_tr_b16 v[60:61], v4 offset:25376
 v_mfma_f32_16x16x32_bf16 v[164:167], v[24:27], v[116:119], v[164:167]
 ds_read_b64_tr_b16 v[62:63], v4 offset:29600
 v_mfma_f32_16x16x32_bf16 v[168:171], v[24:27], v[120:123], v[168:171]
 buffer_load_dwordx4 v8, s[28:31], s44 offen offset:1056 lds
 v_mfma_f32_16x16x32_bf16 v[172:175], v[24:27], v[124:127], v[172:175]
 ds_read_b64_tr_b16 v[64:65], v5 offset:25344
 v_mfma_f32_16x16x32_bf16 v[176:179], v[28:31], v[112:115], v[176:179]
 ds_read_b64_tr_b16 v[66:67], v5 offset:29568
 buffer_load_dwordx4 v9, s[28:31], s44 offen offset:2112 lds
 s_barrier
 v_mfma_f32_16x16x32_bf16 v[180:183], v[28:31], v[116:119], v[180:183]
 ds_read_b64_tr_b16 v[68:69], v5 offset:25376
 v_mfma_f32_16x16x32_bf16 v[184:187], v[28:31], v[120:123], v[184:187]
 v_mfma_f32_16x16x32_bf16 v[188:191], v[28:31], v[124:127], v[188:191]
 ds_read_b64_tr_b16 v[70:71], v5 offset:29600
 buffer_load_dwordx4 v10, s[28:31], s44 offen offset:3168 lds
 v_mfma_f32_16x16x32_bf16 v[192:195], v[32:35], v[112:115], v[192:195]
 ds_read_b64_tr_b16 v[72:73], v6 offset:25344
 v_mfma_f32_16x16x32_bf16 v[196:199], v[32:35], v[116:119], v[196:199]
 ds_read_b64_tr_b16 v[74:75], v6 offset:29568
 v_mfma_f32_16x16x32_bf16 v[200:203], v[32:35], v[120:123], v[200:203]
 s_add_u32 m0, s46, 21120
 v_mfma_f32_16x16x32_bf16 v[204:207], v[32:35], v[124:127], v[204:207]
 ds_read_b64_tr_b16 v[76:77], v6 offset:25376
 v_mfma_f32_16x16x32_bf16 v[208:211], v[36:39], v[112:115], v[208:211]
 ds_read_b64_tr_b16 v[78:79], v6 offset:29600
 buffer_load_dwordx4 v7, s[28:31], s45 offen offset:0 lds
 v_mfma_f32_16x16x32_bf16 v[212:215], v[36:39], v[116:119], v[212:215]
 v_mfma_f32_16x16x32_bf16 v[216:219], v[36:39], v[120:123], v[216:219]
 v_mfma_f32_16x16x32_bf16 v[220:223], v[36:39], v[124:127], v[220:223]
 buffer_load_dwordx4 v8, s[28:31], s45 offen offset:1056 lds
 v_mfma_f32_16x16x32_bf16 v[224:227], v[40:43], v[112:115], v[224:227]
 v_mfma_f32_16x16x32_bf16 v[228:231], v[40:43], v[116:119], v[228:231]
 buffer_load_dwordx4 v9, s[28:31], s45 offen offset:2112 lds
 v_mfma_f32_16x16x32_bf16 v[232:235], v[40:43], v[120:123], v[232:235]
 v_mfma_f32_16x16x32_bf16 v[236:239], v[40:43], v[124:127], v[236:239]
 v_mfma_f32_16x16x32_bf16 v[240:243], v[44:47], v[112:115], v[240:243]
 buffer_load_dwordx4 v10, s[28:31], s45 offen offset:3168 lds
 s_add_u32 s44, s44, 262144
 s_add_u32 s45, s45, 262144
 v_mfma_f32_16x16x32_bf16 v[244:247], v[44:47], v[116:119], v[244:247]
 v_mfma_f32_16x16x32_bf16 v[248:251], v[44:47], v[120:123], v[248:251]
 v_mfma_f32_16x16x32_bf16 v[252:255], v[44:47], v[124:127], v[252:255]
 s_waitcnt vmcnt(20) lgkmcnt(0)
 v_mfma_f32_16x16x32_bf16 v[128:131], v[48:51], v[80:83], v[128:131]
 buffer_load_dwordx4 v[112:115], v11, s[24:27], s47 offen
 ds_read_b64_tr_b16 v[16:17], v3 offset:0
 v_mfma_f32_16x16x32_bf16 v[132:135], v[48:51], v[84:87], v[132:135]
 buffer_load_dwordx4 v[116:119], v11, s[24:27], s48 offen
 ds_read_b64_tr_b16 v[18:19], v3 offset:4224
 v_mfma_f32_16x16x32_bf16 v[136:139], v[48:51], v[88:91], v[136:139]
 buffer_load_dwordx4 v[120:123], v11, s[24:27], s49 offen
 ds_read_b64_tr_b16 v[20:21], v3 offset:32
 v_mfma_f32_16x16x32_bf16 v[140:143], v[48:51], v[92:95], v[140:143]
 buffer_load_dwordx4 v[124:127], v11, s[24:27], s50 offen
 s_add_u32 s24, s24, 4096
 s_addc_u32 s25, s25, 0
 v_mfma_f32_16x16x32_bf16 v[144:147], v[52:55], v[80:83], v[144:147]
 ds_read_b64_tr_b16 v[22:23], v3 offset:4256
 v_mfma_f32_16x16x32_bf16 v[148:151], v[52:55], v[84:87], v[148:151]
 ds_read_b64_tr_b16 v[24:25], v4 offset:0
 s_add_u32 m0, s46, 25344
 v_mfma_f32_16x16x32_bf16 v[152:155], v[52:55], v[88:91], v[152:155]
 ds_read_b64_tr_b16 v[26:27], v4 offset:4224
 v_mfma_f32_16x16x32_bf16 v[156:159], v[52:55], v[92:95], v[156:159]
 buffer_load_dwordx4 v7, s[28:31], s44 offen offset:0 lds
 v_mfma_f32_16x16x32_bf16 v[160:163], v[56:59], v[80:83], v[160:163]
 ds_read_b64_tr_b16 v[28:29], v4 offset:32
 v_mfma_f32_16x16x32_bf16 v[164:167], v[56:59], v[84:87], v[164:167]
 ds_read_b64_tr_b16 v[30:31], v4 offset:4256
 s_barrier
 v_mfma_f32_16x16x32_bf16 v[168:171], v[56:59], v[88:91], v[168:171]
 buffer_load_dwordx4 v8, s[28:31], s44 offen offset:1056 lds
 v_mfma_f32_16x16x32_bf16 v[172:175], v[56:59], v[92:95], v[172:175]
 ds_read_b64_tr_b16 v[32:33], v5 offset:0
 v_mfma_f32_16x16x32_bf16 v[176:179], v[60:63], v[80:83], v[176:179]
 ds_read_b64_tr_b16 v[34:35], v5 offset:4224
 buffer_load_dwordx4 v9, s[28:31], s44 offen offset:2112 lds
 v_mfma_f32_16x16x32_bf16 v[180:183], v[60:63], v[84:87], v[180:183]
 ds_read_b64_tr_b16 v[36:37], v5 offset:32
 v_mfma_f32_16x16x32_bf16 v[184:187], v[60:63], v[88:91], v[184:187]
 v_mfma_f32_16x16x32_bf16 v[188:191], v[60:63], v[92:95], v[188:191]
 ds_read_b64_tr_b16 v[38:39], v5 offset:4256
 buffer_load_dwordx4 v10, s[28:31], s44 offen offset:3168 lds
 v_mfma_f32_16x16x32_bf16 v[192:195], v[64:67], v[80:83], v[192:195]
 ds_read_b64_tr_b16 v[40:41], v6 offset:0
 v_mfma_f32_16x16x32_bf16 v[196:199], v[64:67], v[84:87], v[196:199]
 ds_read_b64_tr_b16 v[42:43], v6 offset:4224
 v_mfma_f32_16x16x32_bf16 v[200:203], v[64:67], v[88:91], v[200:203]
 s_add_u32 m0, s46, 29568
 v_mfma_f32_16x16x32_bf16 v[204:207], v[64:67], v[92:95], v[204:207]
 ds_read_b64_tr_b16 v[44:45], v6 offset:32
 v_mfma_f32_16x16x32_bf16 v[208:211], v[68:71], v[80:83], v[208:211]
 ds_read_b64_tr_b16 v[46:47], v6 offset:4256
 buffer_load_dwordx4 v7, s[28:31], s45 offen offset:0 lds
 v_mfma_f32_16x16x32_bf16 v[212:215], v[68:71], v[84:87], v[212:215]
 v_mfma_f32_16x16x32_bf16 v[216:219], v[68:71], v[88:91], v[216:219]
 v_mfma_f32_16x16x32_bf16 v[220:223], v[68:71], v[92:95], v[220:223]
 buffer_load_dwordx4 v8, s[28:31], s45 offen offset:1056 lds
 v_mfma_f32_16x16x32_bf16 v[224:227], v[72:75], v[80:83], v[224:227]
 v_mfma_f32_16x16x32_bf16 v[228:231], v[72:75], v[84:87], v[228:231]
 buffer_load_dwordx4 v9, s[28:31], s45 offen offset:2112 lds
 v_mfma_f32_16x16x32_bf16 v[232:235], v[72:75], v[88:91], v[232:235]
 v_mfma_f32_16x16x32_bf16 v[236:239], v[72:75], v[92:95], v[236:239]
 v_mfma_f32_16x16x32_bf16 v[240:243], v[76:79], v[80:83], v[240:243]
 buffer_load_dwordx4 v10, s[28:31], s45 offen offset:3168 lds
 s_add_u32 s44, s44, 262144
 s_add_u32 s45, s45, 262144
 v_mfma_f32_16x16x32_bf16 v[244:247], v[76:79], v[84:87], v[244:247]
 v_mfma_f32_16x16x32_bf16 v[248:251], v[76:79], v[88:91], v[248:251]
 v_mfma_f32_16x16x32_bf16 v[252:255], v[76:79], v[92:95], v[252:255]
 s_waitcnt vmcnt(20) lgkmcnt(0)
 v_mfma_f32_16x16x32_bf16 v[128:131], v[16:19], v[96:99], v[128:131]
 buffer_load_dwordx4 v[80:83], v11, s[24:27], s47 offen
 ds_read_b64_tr_b16 v[48:49], v3 offset:8448
 v_mfma_f32_16x16x32_bf16 v[132:135], v[16:19], v[100:103], v[132:135]
 buffer_load_dwordx4 v[84:87], v11, s[24:27], s48 offen
 ds_read_b64_tr_b16 v[50:51], v3 offset:12672
 v_mfma_f32_16x16x32_bf16 v[136:139], v[16:19], v[104:107], v[136:139]
 buffer_load_dwordx4 v[88:91], v11, s[24:27], s49 offen
 ds_read_b64_tr_b16 v[52:53], v3 offset:8480
 v_mfma_f32_16x16x32_bf16 v[140:143], v[16:19], v[108:111], v[140:143]
 buffer_load_dwordx4 v[92:95], v11, s[24:27], s50 offen
 s_add_u32 s24, s24, 4096
 s_addc_u32 s25, s25, 0
 v_mfma_f32_16x16x32_bf16 v[144:147], v[20:23], v[96:99], v[144:147]
 ds_read_b64_tr_b16 v[54:55], v3 offset:12704
 v_mfma_f32_16x16x32_bf16 v[148:151], v[20:23], v[100:103], v[148:151]
 ds_read_b64_tr_b16 v[56:57], v4 offset:8448
 s_add_u32 m0, s46, 0
 s_barrier
 v_mfma_f32_16x16x32_bf16 v[152:155], v[20:23], v[104:107], v[152:155]
 ds_read_b64_tr_b16 v[58:59], v4 offset:12672
 v_mfma_f32_16x16x32_bf16 v[156:159], v[20:23], v[108:111], v[156:159]
 buffer_load_dwordx4 v7, s[28:31], s44 offen offset:0 lds
 v_mfma_f32_16x16x32_bf16 v[160:163], v[24:27], v[96:99], v[160:163]
 ds_read_b64_tr_b16 v[60:61], v4 offset:8480
 v_mfma_f32_16x16x32_bf16 v[164:167], v[24:27], v[100:103], v[164:167]
 ds_read_b64_tr_b16 v[62:63], v4 offset:12704
 v_mfma_f32_16x16x32_bf16 v[168:171], v[24:27], v[104:107], v[168:171]
 buffer_load_dwordx4 v8, s[28:31], s44 offen offset:1056 lds
 v_mfma_f32_16x16x32_bf16 v[172:175], v[24:27], v[108:111], v[172:175]
 ds_read_b64_tr_b16 v[64:65], v5 offset:8448
 v_mfma_f32_16x16x32_bf16 v[176:179], v[28:31], v[96:99], v[176:179]
 ds_read_b64_tr_b16 v[66:67], v5 offset:12672
 buffer_load_dwordx4 v9, s[28:31], s44 offen offset:2112 lds
 v_mfma_f32_16x16x32_bf16 v[180:183], v[28:31], v[100:103], v[180:183]
 ds_read_b64_tr_b16 v[68:69], v5 offset:8480
 v_mfma_f32_16x16x32_bf16 v[184:187], v[28:31], v[104:107], v[184:187]
 v_mfma_f32_16x16x32_bf16 v[188:191], v[28:31], v[108:111], v[188:191]
 ds_read_b64_tr_b16 v[70:71], v5 offset:12704
 buffer_load_dwordx4 v10, s[28:31], s44 offen offset:3168 lds
 v_mfma_f32_16x16x32_bf16 v[192:195], v[32:35], v[96:99], v[192:195]
 ds_read_b64_tr_b16 v[72:73], v6 offset:8448
 v_mfma_f32_16x16x32_bf16 v[196:199], v[32:35], v[100:103], v[196:199]
 ds_read_b64_tr_b16 v[74:75], v6 offset:12672
 v_mfma_f32_16x16x32_bf16 v[200:203], v[32:35], v[104:107], v[200:203]
 s_add_u32 m0, s46, 4224
 v_mfma_f32_16x16x32_bf16 v[204:207], v[32:35], v[108:111], v[204:207]
 ds_read_b64_tr_b16 v[76:77], v6 offset:8480
 v_mfma_f32_16x16x32_bf16 v[208:211], v[36:39], v[96:99], v[208:211]
 ds_read_b64_tr_b16 v[78:79], v6 offset:12704
 buffer_load_dwordx4 v7, s[28:31], s45 offen offset:0 lds
 v_mfma_f32_16x16x32_bf16 v[212:215], v[36:39], v[100:103], v[212:215]
 v_mfma_f32_16x16x32_bf16 v[216:219], v[36:39], v[104:107], v[216:219]
 v_mfma_f32_16x16x32_bf16 v[220:223], v[36:39], v[108:111], v[220:223]
 buffer_load_dwordx4 v8, s[28:31], s45 offen offset:1056 lds
 v_mfma_f32_16x16x32_bf16 v[224:227], v[40:43], v[96:99], v[224:227]
 v_mfma_f32_16x16x32_bf16 v[228:231], v[40:43], v[100:103], v[228:231]
 buffer_load_dwordx4 v9, s[28:31], s45 offen offset:2112 lds
 v_mfma_f32_16x16x32_bf16 v[232:235], v[40:43], v[104:107], v[232:235]
 v_mfma_f32_16x16x32_bf16 v[236:239], v[40:43], v[108:111], v[236:239]
 v_mfma_f32_16x16x32_bf16 v[240:243], v[44:47], v[96:99], v[240:243]
 buffer_load_dwordx4 v10, s[28:31], s45 offen offset:3168 lds
 s_add_u32 s44, s44, 262144
 s_add_u32 s45, s45, 262144
 v_mfma_f32_16x16x32_bf16 v[244:247], v[44:47], v[100:103], v[244:247]
 v_mfma_f32_16x16x32_bf16 v[248:251], v[44:47], v[104:107], v[248:251]
 v_mfma_f32_16x16x32_bf16 v[252:255], v[44:47], v[108:111], v[252:255]
 s_waitcnt vmcnt(20) lgkmcnt(0)
 v_mfma_f32_16x16x32_bf16 v[128:131], v[48:51], v[112:115], v[128:131]
 buffer_load_dwordx4 v[96:99], v11, s[24:27], s47 offen
 ds_read_b64_tr_b16 v[16:17], v3 offset:16896
 v_mfma_f32_16x16x32_bf16 v[132:135], v[48:51], v[116:119], v[132:135]
 buffer_load_dwordx4 v[100:103], v11, s[24:27], s48 offen
 ds_read_b64_tr_b16 v[18:19], v3 offset:21120
 v_mfma_f32_16x16x32_bf16 v[136:139], v[48:51], v[120:123], v[136:139]
 buffer_load_dwordx4 v[104:107], v11, s[24:27], s49 offen
 ds_read_b64_tr_b16 v[20:21], v3 offset:16928
 s_barrier
 v_mfma_f32_16x16x32_bf16 v[140:143], v[48:51], v[124:127], v[140:143]
 buffer_load_dwordx4 v[108:111], v11, s[24:27], s50 offen
 s_add_u32 s24, s24, 4096
 s_addc_u32 s25, s25, 0
 v_mfma_f32_16x16x32_bf16 v[144:147], v[52:55], v[112:115], v[144:147]
 ds_read_b64_tr_b16 v[22:23], v3 offset:21152
 v_mfma_f32_16x16x32_bf16 v[148:151], v[52:55], v[116:119], v[148:151]
 ds_read_b64_tr_b16 v[24:25], v4 offset:16896
 s_add_u32 m0, s46, 8448
 v_mfma_f32_16x16x32_bf16 v[152:155], v[52:55], v[120:123], v[152:155]
 ds_read_b64_tr_b16 v[26:27], v4 offset:21120
 v_mfma_f32_16x16x32_bf16 v[156:159], v[52:55], v[124:127], v[156:159]
 buffer_load_dwordx4 v7, s[28:31], s44 offen offset:0 lds
 v_mfma_f32_16x16x32_bf16 v[160:163], v[56:59], v[112:115], v[160:163]
 ds_read_b64_tr_b16 v[28:29], v4 offset:16928
 v_mfma_f32_16x16x32_bf16 v[164:167], v[56:59], v[116:119], v[164:167]
 ds_read_b64_tr_b16 v[30:31], v4 offset:21152
 v_mfma_f32_16x16x32_bf16 v[168:171], v[56:59], v[120:123], v[168:171]
 buffer_load_dwordx4 v8, s[28:31], s44 offen offset:1056 lds
 v_mfma_f32_16x16x32_bf16 v[172:175], v[56:59], v[124:127], v[172:175]
 ds_read_b64_tr_b16 v[32:33], v5 offset:16896
 v_mfma_f32_16x16x32_bf16 v[176:179], v[60:63], v[112:115], v[176:179]
 ds_read_b64_tr_b16 v[34:35], v5 offset:21120
 buffer_load_dwordx4 v9, s[28:31], s44 offen offset:2112 lds
 v_mfma_f32_16x16x32_bf16 v[180:183], v[60:63], v[116:119], v[180:183]
 ds_read_b64_tr_b16 v[36:37], v5 offset:16928
 v_mfma_f32_16x16x32_bf16 v[184:187], v[60:63], v[120:123], v[184:187]
 v_mfma_f32_16x16x32_bf16 v[188:191], v[60:63], v[124:127], v[188:191]
 ds_read_b64_tr_b16 v[38:39], v5 offset:21152
 buffer_load_dwordx4 v10, s[28:31], s44 offen offset:3168 lds
 v_mfma_f32_16x16x32_bf16 v[192:195], v[64:67], v[112:115], v[192:195]
 ds_read_b64_tr_b16 v[40:41], v6 offset:16896
 v_mfma_f32_16x16x32_bf16 v[196:199], v[64:67], v[116:119], v[196:199]
 ds_read_b64_tr_b16 v[42:43], v6 offset:21120
 v_mfma_f32_16x16x32_bf16 v[200:203], v[64:67], v[120:123], v[200:203]
 s_add_u32 m0, s46, 12672
 v_mfma_f32_16x16x32_bf16 v[204:207], v[64:67], v[124:127], v[204:207]
 ds_read_b64_tr_b16 v[44:45], v6 offset:16928
 v_mfma_f32_16x16x32_bf16 v[208:211], v[68:71], v[112:115], v[208:211]
 ds_read_b64_tr_b16 v[46:47], v6 offset:21152
 buffer_load_dwordx4 v7, s[28:31], s45 offen offset:0 lds
 v_mfma_f32_16x16x32_bf16 v[212:215], v[68:71], v[116:119], v[212:215]
 v_mfma_f32_16x16x32_bf16 v[216:219], v[68:71], v[120:123], v[216:219]
 v_mfma_f32_16x16x32_bf16 v[220:223], v[68:71], v[124:127], v[220:223]
 buffer_load_dwordx4 v8, s[28:31], s45 offen offset:1056 lds
 v_mfma_f32_16x16x32_bf16 v[224:227], v[72:75], v[112:115], v[224:227]
 v_mfma_f32_16x16x32_bf16 v[228:231], v[72:75], v[116:119], v[228:231]
 buffer_load_dwordx4 v9, s[28:31], s45 offen offset:2112 lds
 v_mfma_f32_16x16x32_bf16 v[232:235], v[72:75], v[120:123], v[232:235]
 v_mfma_f32_16x16x32_bf16 v[236:239], v[72:75], v[124:127], v[236:239]
 v_mfma_f32_16x16x32_bf16 v[240:243], v[76:79], v[112:115], v[240:243]
 buffer_load_dwordx4 v10, s[28:31], s45 offen offset:3168 lds
 s_add_u32 s44, s44, 262144
 s_add_u32 s45, s45, 262144
 v_mfma_f32_16x16x32_bf16 v[244:247], v[76:79], v[116:119], v[244:247]
 v_mfma_f32_16x16x32_bf16 v[248:251], v[76:79], v[120:123], v[248:251]
 v_mfma_f32_16x16x32_bf16 v[252:255], v[76:79], v[124:127], v[252:255]
 s_waitcnt vmcnt(20) lgkmcnt(0)
 s_barrier
 v_mfma_f32_16x16x32_bf16 v[128:131], v[16:19], v[80:83], v[128:131]
 buffer_load_dwordx4 v[112:115], v11, s[24:27], s47 offen
 ds_read_b64_tr_b16 v[48:49], v3 offset:25344
 v_mfma_f32_16x16x32_bf16 v[132:135], v[16:19], v[84:87], v[132:135]
 buffer_load_dwordx4 v[116:119], v11, s[24:27], s48 offen
 ds_read_b64_tr_b16 v[50:51], v3 offset:29568
 v_mfma_f32_16x16x32_bf16 v[136:139], v[16:19], v[88:91], v[136:139]
 buffer_load_dwordx4 v[120:123], v11, s[24:27], s49 offen
 ds_read_b64_tr_b16 v[52:53], v3 offset:25376
 v_mfma_f32_16x16x32_bf16 v[140:143], v[16:19], v[92:95], v[140:143]
 buffer_load_dwordx4 v[124:127], v11, s[24:27], s50 offen
 s_add_u32 s24, s24, 4096
 s_addc_u32 s25, s25, 0
 v_mfma_f32_16x16x32_bf16 v[144:147], v[20:23], v[80:83], v[144:147]
 ds_read_b64_tr_b16 v[54:55], v3 offset:29600
 v_mfma_f32_16x16x32_bf16 v[148:151], v[20:23], v[84:87], v[148:151]
 ds_read_b64_tr_b16 v[56:57], v4 offset:25344
 s_add_u32 m0, s46, 16896
 v_mfma_f32_16x16x32_bf16 v[152:155], v[20:23], v[88:91], v[152:155]
 ds_read_b64_tr_b16 v[58:59], v4 offset:29568
 v_mfma_f32_16x16x32_bf16 v[156:159], v[20:23], v[92:95], v[156:159]
 buffer_load_dwordx4 v7, s[28:31], s44 offen offset:0 lds
 v_mfma_f32_16x16x32_bf16 v[160:163], v[24:27], v[80:83], v[160:163]
 ds_read_b64_tr_b16 v[60:61], v4 offset:25376
 v_mfma_f32_16x16x32_bf16 v[164:167], v[24:27], v[84:87], v[164:167]
 ds_read_b64_tr_b16 v[62:63], v4 offset:29600
 v_mfma_f32_16x16x32_bf16 v[168:171], v[24:27], v[88:91], v[168:171]
 buffer_load_dwordx4 v8, s[28:31], s44 offen offset:1056 lds
 v_mfma_f32_16x16x32_bf16 v[172:175], v[24:27], v[92:95], v[172:175]
 ds_read_b64_tr_b16 v[64:65], v5 offset:25344
 v_mfma_f32_16x16x32_bf16 v[176:179], v[28:31], v[80:83], v[176:179]
 ds_read_b64_tr_b16 v[66:67], v5 offset:29568
 buffer_load_dwordx4 v9, s[28:31], s44 offen offset:2112 lds
 v_mfma_f32_16x16x32_bf16 v[180:183], v[28:31], v[84:87], v[180:183]
 ds_read_b64_tr_b16 v[68:69], v5 offset:25376
 v_mfma_f32_16x16x32_bf16 v[184:187], v[28:31], v[88:91], v[184:187]
 v_mfma_f32_16x16x32_bf16 v[188:191], v[28:31], v[92:95], v[188:191]
 ds_read_b64_tr_b16 v[70:71], v5 offset:29600
 buffer_load_dwordx4 v10, s[28:31], s44 offen offset:3168 lds
 v_mfma_f32_16x16x32_bf16 v[192:195], v[32:35], v[80:83], v[192:195]
 ds_read_b64_tr_b16 v[72:73], v6 offset:25344
 v_mfma_f32_16x16x32_bf16 v[196:199], v[32:35], v[84:87], v[196:199]
 ds_read_b64_tr_b16 v[74:75], v6 offset:29568
 v_mfma_f32_16x16x32_bf16 v[200:203], v[32:35], v[88:91], v[200:203]
 s_add_u32 m0, s46, 21120
 v_mfma_f32_16x16x32_bf16 v[204:207], v[32:35], v[92:95], v[204:207]
 ds_read_b64_tr_b16 v[76:77], v6 offset:25376
 v_mfma_f32_16x16x32_bf16 v[208:211], v[36:39], v[80:83], v[208:211]
 ds_read_b64_tr_b16 v[78:79], v6 offset:29600
 buffer_load_dwordx4 v7, s[28:31], s45 offen offset:0 lds
 v_mfma_f32_16x16x32_bf16 v[212:215], v[36:39], v[84:87], v[212:215]
 v_mfma_f32_16x16x32_bf16 v[216:219], v[36:39], v[88:91], v[216:219]
 v_mfma_f32_16x16x32_bf16 v[220:223], v[36:39], v[92:95], v[220:223]
 buffer_load_dwordx4 v8, s[28:31], s45 offen offset:1056 lds
 v_mfma_f32_16x16x32_bf16 v[224:227], v[40:43], v[80:83], v[224:227]
 v_mfma_f32_16x16x32_bf16 v[228:231], v[40:43], v[84:87], v[228:231]
 buffer_load_dwordx4 v9, s[28:31], s45 offen offset:2112 lds
 v_mfma_f32_16x16x32_bf16 v[232:235], v[40:43], v[88:91], v[232:235]
 v_mfma_f32_16x16x32_bf16 v[236:239], v[40:43], v[92:95], v[236:239]
 v_mfma_f32_16x16x32_bf16 v[240:243], v[44:47], v[80:83], v[240:243]
 buffer_load_dwordx4 v10, s[28:31], s45 offen offset:3168 lds
 s_add_u32 s44, s44, 262144
 s_add_u32 s45, s45, 262144
 s_barrier
 v_mfma_f32_16x16x32_bf16 v[244:247], v[44:47], v[84:87], v[244:247]
 v_mfma_f32_16x16x32_bf16 v[248:251], v[44:47], v[88:91], v[248:251]
 v_mfma_f32_16x16x32_bf16 v[252:255], v[44:47], v[92:95], v[252:255]
 s_waitcnt vmcnt(20) lgkmcnt(0)
 v_mfma_f32_16x16x32_bf16 v[128:131], v[48:51], v[96:99], v[128:131]
 buffer_load_dwordx4 v[80:83], v11, s[24:27], s47 offen
 ds_read_b64_tr_b16 v[16:17], v3 offset:0
 v_mfma_f32_16x16x32_bf16 v[132:135], v[48:51], v[100:103], v[132:135]
 buffer_load_dwordx4 v[84:87], v11, s[24:27], s48 offen
 ds_read_b64_tr_b16 v[18:19], v3 offset:4224
 v_mfma_f32_16x16x32_bf16 v[136:139], v[48:51], v[104:107], v[136:139]
 buffer_load_dwordx4 v[88:91], v11, s[24:27], s49 offen
 ds_read_b64_tr_b16 v[20:21], v3 offset:32
 v_mfma_f32_16x16x32_bf16 v[140:143], v[48:51], v[108:111], v[140:143]
 buffer_load_dwordx4 v[92:95], v11, s[24:27], s50 offen
 s_add_u32 s24, s24, 4096
 s_addc_u32 s25, s25, 0
 v_mfma_f32_16x16x32_bf16 v[144:147], v[52:55], v[96:99], v[144:147]
 ds_read_b64_tr_b16 v[22:23], v3 offset:4256
 v_mfma_f32_16x16x32_bf16 v[148:151], v[52:55], v[100:103], v[148:151]
 ds_read_b64_tr_b16 v[24:25], v4 offset:0
 s_add_u32 m0, s46, 25344
 v_mfma_f32_16x16x32_bf16 v[152:155], v[52:55], v[104:107], v[152:155]
 ds_read_b64_tr_b16 v[26:27], v4 offset:4224
 v_mfma_f32_16x16x32_bf16 v[156:159], v[52:55], v[108:111], v[156:159]
 buffer_load_dwordx4 v7, s[28:31], s44 offen offset:0 lds
 v_mfma_f32_16x16x32_bf16 v[160:163], v[56:59], v[96:99], v[160:163]
 ds_read_b64_tr_b16 v[28:29], v4 offset:32
 v_mfma_f32_16x16x32_bf16 v[164:167], v[56:59], v[100:103], v[164:167]
 ds_read_b64_tr_b16 v[30:31], v4 offset:4256
 v_mfma_f32_16x16x32_bf16 v[168:171], v[56:59], v[104:107], v[168:171]
 buffer_load_dwordx4 v8, s[28:31], s44 offen offset:1056 lds
 v_mfma_f32_16x16x32_bf16 v[172:175], v[56:59], v[108:111], v[172:175]
 ds_read_b64_tr_b16 v[32:33], v5 offset:0
 v_mfma_f32_16x16x32_bf16 v[176:179], v[60:63], v[96:99], v[176:179]
 ds_read_b64_tr_b16 v[34:35], v5 offset:4224
 buffer_load_dwordx4 v9, s[28:31], s44 offen offset:2112 lds
 v_mfma_f32_16x16x32_bf16 v[180:183], v[60:63], v[100:103], v[180:183]
 ds_read_b64_tr_b16 v[36:37], v5 offset:32
 v_mfma_f32_16x16x32_bf16 v[184:187], v[60:63], v[104:107], v[184:187]
 v_mfma_f32_16x16x32_bf16 v[188:191], v[60:63], v[108:111], v[188:191]
 ds_read_b64_tr_b16 v[38:39], v5 offset:4256
 buffer_load_dwordx4 v10, s[28:31], s44 offen offset:3168 lds
 v_mfma_f32_16x16x32_bf16 v[192:195], v[64:67], v[96:99], v[192:195]
 ds_read_b64_tr_b16 v[40:41], v6 offset:0
 v_mfma_f32_16x16x32_bf16 v[196:199], v[64:67], v[100:103], v[196:199]
 ds_read_b64_tr_b16 v[42:43], v6 offset:4224
 v_mfma_f32_16x16x32_bf16 v[200:203], v[64:67], v[104:107], v[200:203]
 s_add_u32 m0, s46, 29568
 v_mfma_f32_16x16x32_bf16 v[204:207], v[64:67], v[108:111], v[204:207]
 ds_read_b64_tr_b16 v[44:45], v6 offset:32
 v_mfma_f32_16x16x32_bf16 v[208:211], v[68:71], v[96:99], v[208:211]
 ds_read_b64_tr_b16 v[46:47], v6 offset:4256
 buffer_load_dwordx4 v7, s[28:31], s45 offen offset:0 lds
 v_mfma_f32_16x16x32_bf16 v[212:215], v[68:71], v[100:103], v[212:215]
 v_mfma_f32_16x16x32_bf16 v[216:219], v[68:71], v[104:107], v[216:219]
 v_mfma_f32_16x16x32_bf16 v[220:223], v[68:71], v[108:111], v[220:223]
 buffer_load_dwordx4 v8, s[28:31], s45 offen offset:1056 lds
 v_mfma_f32_16x16x32_bf16 v[224:227], v[72:75], v[96:99], v[224:227]
 v_mfma_f32_16x16x32_bf16 v[228:231], v[72:75], v[100:103], v[228:231]
 buffer_load_dwordx4 v9, s[28:31], s45 offen offset:2112 lds
 s_barrier
 v_mfma_f32_16x16x32_bf16 v[232:235], v[72:75], v[104:107], v[232:235]
 v_mfma_f32_16x16x32_bf16 v[236:239], v[72:75], v[108:111], v[236:239]
 v_mfma_f32_16x16x32_bf16 v[240:243], v[76:79], v[96:99], v[240:243]
 buffer_load_dwordx4 v10, s[28:31], s45 offen offset:3168 lds
 s_add_u32 s44, s44, 262144
 s_add_u32 s45, s45, 262144
 v_mfma_f32_16x16x32_bf16 v[244:247], v[76:79], v[100:103], v[244:247]
 v_mfma_f32_16x16x32_bf16 v[248:251], v[76:79], v[104:107], v[248:251]
 v_mfma_f32_16x16x32_bf16 v[252:255], v[76:79], v[108:111], v[252:255]
 s_waitcnt vmcnt(20) lgkmcnt(0)
 v_mfma_f32_16x16x32_bf16 v[128:131], v[16:19], v[112:115], v[128:131]
 buffer_load_dwordx4 v[96:99], v11, s[24:27], s47 offen
 ds_read_b64_tr_b16 v[48:49], v3 offset:8448
 v_mfma_f32_16x16x32_bf16 v[132:135], v[16:19], v[116:119], v[132:135]
 buffer_load_dwordx4 v[100:103], v11, s[24:27], s48 offen
 ds_read_b64_tr_b16 v[50:51], v3 offset:12672
 v_mfma_f32_16x16x32_bf16 v[136:139], v[16:19], v[120:123], v[136:139]
 buffer_load_dwordx4 v[104:107], v11, s[24:27], s49 offen
 ds_read_b64_tr_b16 v[52:53], v3 offset:8480
 v_mfma_f32_16x16x32_bf16 v[140:143], v[16:19], v[124:127], v[140:143]
 buffer_load_dwordx4 v[108:111], v11, s[24:27], s50 offen
 s_add_u32 s24, s24, 4096
 s_addc_u32 s25, s25, 0
 v_mfma_f32_16x16x32_bf16 v[144:147], v[20:23], v[112:115], v[144:147]
 ds_read_b64_tr_b16 v[54:55], v3 offset:12704
 v_mfma_f32_16x16x32_bf16 v[148:151], v[20:23], v[116:119], v[148:151]
 ds_read_b64_tr_b16 v[56:57], v4 offset:8448
 s_add_u32 m0, s46, 0
 v_mfma_f32_16x16x32_bf16 v[152:155], v[20:23], v[120:123], v[152:155]
 ds_read_b64_tr_b16 v[58:59], v4 offset:12672
 v_mfma_f32_16x16x32_bf16 v[156:159], v[20:23], v[124:127], v[156:159]
 buffer_load_dwordx4 v7, s[28:31], s44 offen offset:0 lds
 v_mfma_f32_16x16x32_bf16 v[160:163], v[24:27], v[112:115], v[160:163]
 ds_read_b64_tr_b16 v[60:61], v4 offset:8480
 v_mfma_f32_16x16x32_bf16 v[164:167], v[24:27], v[116:119], v[164:167]
 ds_read_b64_tr_b16 v[62:63], v4 offset:12704
 v_mfma_f32_16x16x32_bf16 v[168:171], v[24:27], v[120:123], v[168:171]
 buffer_load_dwordx4 v8, s[28:31], s44 offen offset:1056 lds
 v_mfma_f32_16x16x32_bf16 v[172:175], v[24:27], v[124:127], v[172:175]
 ds_read_b64_tr_b16 v[64:65], v5 offset:8448
 v_mfma_f32_16x16x32_bf16 v[176:179], v[28:31], v[112:115], v[176:179]
 ds_read_b64_tr_b16 v[66:67], v5 offset:12672
 buffer_load_dwordx4 v9, s[28:31], s44 offen offset:2112 lds
 v_mfma_f32_16x16x32_bf16 v[180:183], v[28:31], v[116:119], v[180:183]
 ds_read_b64_tr_b16 v[68:69], v5 offset:8480
 v_mfma_f32_16x16x32_bf16 v[184:187], v[28:31], v[120:123], v[184:187]
 v_mfma_f32_16x16x32_bf16 v[188:191], v[28:31], v[124:127], v[188:191]
 ds_read_b64_tr_b16 v[70:71], v5 offset:12704
 buffer_load_dwordx4 v10, s[28:31], s44 offen offset:3168 lds
 v_mfma_f32_16x16x32_bf16 v[192:195], v[32:35], v[112:115], v[192:195]
 ds_read_b64_tr_b16 v[72:73], v6 offset:8448
 v_mfma_f32_16x16x32_bf16 v[196:199], v[32:35], v[116:119], v[196:199]
 ds_read_b64_tr_b16 v[74:75], v6 offset:12672
 v_mfma_f32_16x16x32_bf16 v[200:203], v[32:35], v[120:123], v[200:203]
 s_add_u32 m0, s46, 4224
 v_mfma_f32_16x16x32_bf16 v[204:207], v[32:35], v[124:127], v[204:207]
 ds_read_b64_tr_b16 v[76:77], v6 offset:8480
 v_mfma_f32_16x16x32_bf16 v[208:211], v[36:39], v[112:115], v[208:211]
 ds_read_b64_tr_b16 v[78:79], v6 offset:12704
 buffer_load_dwordx4 v7, s[28:31], s45 offen offset:0 lds
 v_mfma_f32_16x16x32_bf16 v[212:215], v[36:39], v[116:119], v[212:215]
 s_barrier
 v_mfma_f32_16x16x32_bf16 v[216:219], v[36:39], v[120:123], v[216:219]
 v_mfma_f32_16x16x32_bf16 v[220:223], v[36:39], v[124:127], v[220:223]
 buffer_load_dwordx4 v8, s[28:31], s45 offen offset:1056 lds
 v_mfma_f32_16x16x32_bf16 v[224:227], v[40:43], v[112:115], v[224:227]
 v_mfma_f32_16x16x32_bf16 v[228:231], v[40:43], v[116:119], v[228:231]
 buffer_load_dwordx4 v9, s[28:31], s45 offen offset:2112 lds
 v_mfma_f32_16x16x32_bf16 v[232:235], v[40:43], v[120:123], v[232:235]
 v_mfma_f32_16x16x32_bf16 v[236:239], v[40:43], v[124:127], v[236:239]
 v_mfma_f32_16x16x32_bf16 v[240:243], v[44:47], v[112:115], v[240:243]
 buffer_load_dwordx4 v10, s[28:31], s45 offen offset:3168 lds
 s_add_u32 s44, s44, 262144
 s_add_u32 s45, s45, 262144
 v_mfma_f32_16x16x32_bf16 v[244:247], v[44:47], v[116:119], v[244:247]
 v_mfma_f32_16x16x32_bf16 v[248:251], v[44:47], v[120:123], v[248:251]
 v_mfma_f32_16x16x32_bf16 v[252:255], v[44:47], v[124:127], v[252:255]
 s_waitcnt vmcnt(20) lgkmcnt(0)
 v_mfma_f32_16x16x32_bf16 v[128:131], v[48:51], v[80:83], v[128:131]
 buffer_load_dwordx4 v[112:115], v11, s[24:27], s47 offen
 ds_read_b64_tr_b16 v[16:17], v3 offset:16896
 v_mfma_f32_16x16x32_bf16 v[132:135], v[48:51], v[84:87], v[132:135]
 buffer_load_dwordx4 v[116:119], v11, s[24:27], s48 offen
 ds_read_b64_tr_b16 v[18:19], v3 offset:21120
 v_mfma_f32_16x16x32_bf16 v[136:139], v[48:51], v[88:91], v[136:139]
 buffer_load_dwordx4 v[120:123], v11, s[24:27], s49 offen
 ds_read_b64_tr_b16 v[20:21], v3 offset:16928
 v_mfma_f32_16x16x32_bf16 v[140:143], v[48:51], v[92:95], v[140:143]
 buffer_load_dwordx4 v[124:127], v11, s[24:27], s50 offen
 s_add_u32 s24, s24, 4096
 s_addc_u32 s25, s25, 0
 v_mfma_f32_16x16x32_bf16 v[144:147], v[52:55], v[80:83], v[144:147]
 ds_read_b64_tr_b16 v[22:23], v3 offset:21152
 v_mfma_f32_16x16x32_bf16 v[148:151], v[52:55], v[84:87], v[148:151]
 ds_read_b64_tr_b16 v[24:25], v4 offset:16896
 s_add_u32 m0, s46, 8448
 v_mfma_f32_16x16x32_bf16 v[152:155], v[52:55], v[88:91], v[152:155]
 ds_read_b64_tr_b16 v[26:27], v4 offset:21120
 v_mfma_f32_16x16x32_bf16 v[156:159], v[52:55], v[92:95], v[156:159]
 buffer_load_dwordx4 v7, s[28:31], s44 offen offset:0 lds
 v_mfma_f32_16x16x32_bf16 v[160:163], v[56:59], v[80:83], v[160:163]
 ds_read_b64_tr_b16 v[28:29], v4 offset:16928
 v_mfma_f32_16x16x32_bf16 v[164:167], v[56:59], v[84:87], v[164:167]
 ds_read_b64_tr_b16 v[30:31], v4 offset:21152
 v_mfma_f32_16x16x32_bf16 v[168:171], v[56:59], v[88:91], v[168:171]
 buffer_load_dwordx4 v8, s[28:31], s44 offen offset:1056 lds
 v_mfma_f32_16x16x32_bf16 v[172:175], v[56:59], v[92:95], v[172:175]
 ds_read_b64_tr_b16 v[32:33], v5 offset:16896
 v_mfma_f32_16x16x32_bf16 v[176:179], v[60:63], v[80:83], v[176:179]
 ds_read_b64_tr_b16 v[34:35], v5 offset:21120
 buffer_load_dwordx4 v9, s[28:31], s44 offen offset:2112 lds
 v_mfma_f32_16x16x32_bf16 v[180:183], v[60:63], v[84:87], v[180:183]
 ds_read_b64_tr_b16 v[36:37], v5 offset:16928
 v_mfma_f32_16x16x32_bf16 v[184:187], v[60:63], v[88:91], v[184:187]
 v_mfma_f32_16x16x32_bf16 v[188:191], v[60:63], v[92:95], v[188:191]
 ds_read_b64_tr_b16 v[38:39], v5 offset:21152
 buffer_load_dwordx4 v10, s[28:31], s44 offen offset:3168 lds
 v_mfma_f32_16x16x32_bf16 v[192:195], v[64:67], v[80:83], v[192:195]
 ds_read_b64_tr_b16 v[40:41], v6 offset:16896
 v_mfma_f32_16x16x32_bf16 v[196:199], v[64:67], v[84:87], v[196:199]
 ds_read_b64_tr_b16 v[42:43], v6 offset:21120
 v_mfma_f32_16x16x32_bf16 v[200:203], v[64:67], v[88:91], v[200:203]
 s_add_u32 m0, s46, 12672
 s_barrier
 v_mfma_f32_16x16x32_bf16 v[204:207], v[64:67], v[92:95], v[204:207]
 ds_read_b64_tr_b16 v[44:45], v6 offset:16928
 v_mfma_f32_16x16x32_bf16 v[208:211], v[68:71], v[80:83], v[208:211]
 ds_read_b64_tr_b16 v[46:47], v6 offset:21152
 buffer_load_dwordx4 v7, s[28:31], s45 offen offset:0 lds
 v_mfma_f32_16x16x32_bf16 v[212:215], v[68:71], v[84:87], v[212:215]
 v_mfma_f32_16x16x32_bf16 v[216:219], v[68:71], v[88:91], v[216:219]
 v_mfma_f32_16x16x32_bf16 v[220:223], v[68:71], v[92:95], v[220:223]
 buffer_load_dwordx4 v8, s[28:31], s45 offen offset:1056 lds
 v_mfma_f32_16x16x32_bf16 v[224:227], v[72:75], v[80:83], v[224:227]
 v_mfma_f32_16x16x32_bf16 v[228:231], v[72:75], v[84:87], v[228:231]
 buffer_load_dwordx4 v9, s[28:31], s45 offen offset:2112 lds
 v_mfma_f32_16x16x32_bf16 v[232:235], v[72:75], v[88:91], v[232:235]
 v_mfma_f32_16x16x32_bf16 v[236:239], v[72:75], v[92:95], v[236:239]
 v_mfma_f32_16x16x32_bf16 v[240:243], v[76:79], v[80:83], v[240:243]
 buffer_load_dwordx4 v10, s[28:31], s45 offen offset:3168 lds
 s_add_u32 s44, s44, 262144
 s_add_u32 s45, s45, 262144
 v_mfma_f32_16x16x32_bf16 v[244:247], v[76:79], v[84:87], v[244:247]
 v_mfma_f32_16x16x32_bf16 v[248:251], v[76:79], v[88:91], v[248:251]
 v_mfma_f32_16x16x32_bf16 v[252:255], v[76:79], v[92:95], v[252:255]
 s_waitcnt vmcnt(20) lgkmcnt(0)
 v_mfma_f32_16x16x32_bf16 v[128:131], v[16:19], v[96:99], v[128:131]
 buffer_load_dwordx4 v[80:83], v11, s[24:27], s47 offen
 ds_read_b64_tr_b16 v[48:49], v3 offset:25344
 v_mfma_f32_16x16x32_bf16 v[132:135], v[16:19], v[100:103], v[132:135]
 buffer_load_dwordx4 v[84:87], v11, s[24:27], s48 offen
 ds_read_b64_tr_b16 v[50:51], v3 offset:29568
 v_mfma_f32_16x16x32_bf16 v[136:139], v[16:19], v[104:107], v[136:139]
 buffer_load_dwordx4 v[88:91], v11, s[24:27], s49 offen
 ds_read_b64_tr_b16 v[52:53], v3 offset:25376
 v_mfma_f32_16x16x32_bf16 v[140:143], v[16:19], v[108:111], v[140:143]
 buffer_load_dwordx4 v[92:95], v11, s[24:27], s50 offen
 s_add_u32 s24, s24, 4096
 s_addc_u32 s25, s25, 0
 v_mfma_f32_16x16x32_bf16 v[144:147], v[20:23], v[96:99], v[144:147]
 ds_read_b64_tr_b16 v[54:55], v3 offset:29600
 v_mfma_f32_16x16x32_bf16 v[148:151], v[20:23], v[100:103], v[148:151]
 ds_read_b64_tr_b16 v[56:57], v4 offset:25344
 s_add_u32 m0, s46, 16896
 v_mfma_f32_16x16x32_bf16 v[152:155], v[20:23], v[104:107], v[152:155]
 ds_read_b64_tr_b16 v[58:59], v4 offset:29568
 v_mfma_f32_16x16x32_bf16 v[156:159], v[20:23], v[108:111], v[156:159]
 buffer_load_dwordx4 v7, s[28:31], s44 offen offset:0 lds
 v_mfma_f32_16x16x32_bf16 v[160:163], v[24:27], v[96:99], v[160:163]
 ds_read_b64_tr_b16 v[60:61], v4 offset:25376
 v_mfma_f32_16x16x32_bf16 v[164:167], v[24:27], v[100:103], v[164:167]
 ds_read_b64_tr_b16 v[62:63], v4 offset:29600
 v_mfma_f32_16x16x32_bf16 v[168:171], v[24:27], v[104:107], v[168:171]
 buffer_load_dwordx4 v8, s[28:31], s44 offen offset:1056 lds
 v_mfma_f32_16x16x32_bf16 v[172:175], v[24:27], v[108:111], v[172:175]
 ds_read_b64_tr_b16 v[64:65], v5 offset:25344
 v_mfma_f32_16x16x32_bf16 v[176:179], v[28:31], v[96:99], v[176:179]
 ds_read_b64_tr_b16 v[66:67], v5 offset:29568
 buffer_load_dwordx4 v9, s[28:31], s44 offen offset:2112 lds
 v_mfma_f32_16x16x32_bf16 v[180:183], v[28:31], v[100:103], v[180:183]
 ds_read_b64_tr_b16 v[68:69], v5 offset:25376
 v_mfma_f32_16x16x32_bf16 v[184:187], v[28:31], v[104:107], v[184:187]
 v_mfma_f32_16x16x32_bf16 v[188:191], v[28:31], v[108:111], v[188:191]
 ds_read_b64_tr_b16 v[70:71], v5 offset:29600
 buffer_load_dwordx4 v10, s[28:31], s44 offen offset:3168 lds
 s_barrier
 v_mfma_f32_16x16x32_bf16 v[192:195], v[32:35], v[96:99], v[192:195]
 ds_read_b64_tr_b16 v[72:73], v6 offset:25344
 v_mfma_f32_16x16x32_bf16 v[196:199], v[32:35], v[100:103], v[196:199]
 ds_read_b64_tr_b16 v[74:75], v6 offset:29568
 v_mfma_f32_16x16x32_bf16 v[200:203], v[32:35], v[104:107], v[200:203]
 s_add_u32 m0, s46, 21120
 v_mfma_f32_16x16x32_bf16 v[204:207], v[32:35], v[108:111], v[204:207]
 ds_read_b64_tr_b16 v[76:77], v6 offset:25376
 v_mfma_f32_16x16x32_bf16 v[208:211], v[36:39], v[96:99], v[208:211]
 ds_read_b64_tr_b16 v[78:79], v6 offset:29600
 buffer_load_dwordx4 v7, s[28:31], s45 offen offset:0 lds
 v_mfma_f32_16x16x32_bf16 v[212:215], v[36:39], v[100:103], v[212:215]
 v_mfma_f32_16x16x32_bf16 v[216:219], v[36:39], v[104:107], v[216:219]
 v_mfma_f32_16x16x32_bf16 v[220:223], v[36:39], v[108:111], v[220:223]
 buffer_load_dwordx4 v8, s[28:31], s45 offen offset:1056 lds
 v_mfma_f32_16x16x32_bf16 v[224:227], v[40:43], v[96:99], v[224:227]
 v_mfma_f32_16x16x32_bf16 v[228:231], v[40:43], v[100:103], v[228:231]
 buffer_load_dwordx4 v9, s[28:31], s45 offen offset:2112 lds
 v_mfma_f32_16x16x32_bf16 v[232:235], v[40:43], v[104:107], v[232:235]
 v_mfma_f32_16x16x32_bf16 v[236:239], v[40:43], v[108:111], v[236:239]
 v_mfma_f32_16x16x32_bf16 v[240:243], v[44:47], v[96:99], v[240:243]
 buffer_load_dwordx4 v10, s[28:31], s45 offen offset:3168 lds
 s_add_u32 s44, s44, 262144
 s_add_u32 s45, s45, 262144
 v_mfma_f32_16x16x32_bf16 v[244:247], v[44:47], v[100:103], v[244:247]
 v_mfma_f32_16x16x32_bf16 v[248:251], v[44:47], v[104:107], v[248:251]
 v_mfma_f32_16x16x32_bf16 v[252:255], v[44:47], v[108:111], v[252:255]
 s_waitcnt vmcnt(20) lgkmcnt(0)
 v_mfma_f32_16x16x32_bf16 v[128:131], v[48:51], v[112:115], v[128:131]
 buffer_load_dwordx4 v[96:99], v11, s[24:27], s47 offen
 ds_read_b64_tr_b16 v[16:17], v3 offset:0
 v_mfma_f32_16x16x32_bf16 v[132:135], v[48:51], v[116:119], v[132:135]
 buffer_load_dwordx4 v[100:103], v11, s[24:27], s48 offen
 ds_read_b64_tr_b16 v[18:19], v3 offset:4224
 v_mfma_f32_16x16x32_bf16 v[136:139], v[48:51], v[120:123], v[136:139]
 buffer_load_dwordx4 v[104:107], v11, s[24:27], s49 offen
 ds_read_b64_tr_b16 v[20:21], v3 offset:32
 v_mfma_f32_16x16x32_bf16 v[140:143], v[48:51], v[124:127], v[140:143]
 buffer_load_dwordx4 v[108:111], v11, s[24:27], s50 offen
 s_add_u32 s24, s24, 4096
 s_addc_u32 s25, s25, 0
 v_mfma_f32_16x16x32_bf16 v[144:147], v[52:55], v[112:115], v[144:147]
 ds_read_b64_tr_b16 v[22:23], v3 offset:4256
 v_mfma_f32_16x16x32_bf16 v[148:151], v[52:55], v[116:119], v[148:151]
 ds_read_b64_tr_b16 v[24:25], v4 offset:0
 s_add_u32 m0, s46, 25344
 v_mfma_f32_16x16x32_bf16 v[152:155], v[52:55], v[120:123], v[152:155]
 ds_read_b64_tr_b16 v[26:27], v4 offset:4224
 v_mfma_f32_16x16x32_bf16 v[156:159], v[52:55], v[124:127], v[156:159]
 buffer_load_dwordx4 v7, s[28:31], s44 offen offset:0 lds
 v_mfma_f32_16x16x32_bf16 v[160:163], v[56:59], v[112:115], v[160:163]
 ds_read_b64_tr_b16 v[28:29], v4 offset:32
 v_mfma_f32_16x16x32_bf16 v[164:167], v[56:59], v[116:119], v[164:167]
 ds_read_b64_tr_b16 v[30:31], v4 offset:4256
 v_mfma_f32_16x16x32_bf16 v[168:171], v[56:59], v[120:123], v[168:171]
 buffer_load_dwordx4 v8, s[28:31], s44 offen offset:1056 lds
 v_mfma_f32_16x16x32_bf16 v[172:175], v[56:59], v[124:127], v[172:175]
 ds_read_b64_tr_b16 v[32:33], v5 offset:0
 v_mfma_f32_16x16x32_bf16 v[176:179], v[60:63], v[112:115], v[176:179]
 ds_read_b64_tr_b16 v[34:35], v5 offset:4224
 buffer_load_dwordx4 v9, s[28:31], s44 offen offset:2112 lds
 s_barrier
 v_mfma_f32_16x16x32_bf16 v[180:183], v[60:63], v[116:119], v[180:183]
 ds_read_b64_tr_b16 v[36:37], v5 offset:32
 v_mfma_f32_16x16x32_bf16 v[184:187], v[60:63], v[120:123], v[184:187]
 v_mfma_f32_16x16x32_bf16 v[188:191], v[60:63], v[124:127], v[188:191]
 ds_read_b64_tr_b16 v[38:39], v5 offset:4256
 buffer_load_dwordx4 v10, s[28:31], s44 offen offset:3168 lds
 v_mfma_f32_16x16x32_bf16 v[192:195], v[64:67], v[112:115], v[192:195]
 ds_read_b64_tr_b16 v[40:41], v6 offset:0
 v_mfma_f32_16x16x32_bf16 v[196:199], v[64:67], v[116:119], v[196:199]
 ds_read_b64_tr_b16 v[42:43], v6 offset:4224
 v_mfma_f32_16x16x32_bf16 v[200:203], v[64:67], v[120:123], v[200:203]
 s_add_u32 m0, s46, 29568
 v_mfma_f32_16x16x32_bf16 v[204:207], v[64:67], v[124:127], v[204:207]
 ds_read_b64_tr_b16 v[44:45], v6 offset:32
 v_mfma_f32_16x16x32_bf16 v[208:211], v[68:71], v[112:115], v[208:211]
 ds_read_b64_tr_b16 v[46:47], v6 offset:4256
 buffer_load_dwordx4 v7, s[28:31], s45 offen offset:0 lds
 v_mfma_f32_16x16x32_bf16 v[212:215], v[68:71], v[116:119], v[212:215]
 v_mfma_f32_16x16x32_bf16 v[216:219], v[68:71], v[120:123], v[216:219]
 v_mfma_f32_16x16x32_bf16 v[220:223], v[68:71], v[124:127], v[220:223]
 buffer_load_dwordx4 v8, s[28:31], s45 offen offset:1056 lds
 v_mfma_f32_16x16x32_bf16 v[224:227], v[72:75], v[112:115], v[224:227]
 v_mfma_f32_16x16x32_bf16 v[228:231], v[72:75], v[116:119], v[228:231]
 buffer_load_dwordx4 v9, s[28:31], s45 offen offset:2112 lds
 v_mfma_f32_16x16x32_bf16 v[232:235], v[72:75], v[120:123], v[232:235]
 v_mfma_f32_16x16x32_bf16 v[236:239], v[72:75], v[124:127], v[236:239]
 v_mfma_f32_16x16x32_bf16 v[240:243], v[76:79], v[112:115], v[240:243]
 buffer_load_dwordx4 v10, s[28:31], s45 offen offset:3168 lds
 s_add_u32 s44, s44, 262144
 s_add_u32 s45, s45, 262144
 v_mfma_f32_16x16x32_bf16 v[244:247], v[76:79], v[116:119], v[244:247]
 v_mfma_f32_16x16x32_bf16 v[248:251], v[76:79], v[120:123], v[248:251]
 v_mfma_f32_16x16x32_bf16 v[252:255], v[76:79], v[124:127], v[252:255]
 s_waitcnt vmcnt(20) lgkmcnt(0)
 v_mfma_f32_16x16x32_bf16 v[128:131], v[16:19], v[80:83], v[128:131]
 buffer_load_dwordx4 v[112:115], v11, s[24:27], s47 offen
 ds_read_b64_tr_b16 v[48:49], v3 offset:8448
 v_mfma_f32_16x16x32_bf16 v[132:135], v[16:19], v[84:87], v[132:135]
 buffer_load_dwordx4 v[116:119], v11, s[24:27], s48 offen
 ds_read_b64_tr_b16 v[50:51], v3 offset:12672
 v_mfma_f32_16x16x32_bf16 v[136:139], v[16:19], v[88:91], v[136:139]
 buffer_load_dwordx4 v[120:123], v11, s[24:27], s49 offen
 ds_read_b64_tr_b16 v[52:53], v3 offset:8480
 v_mfma_f32_16x16x32_bf16 v[140:143], v[16:19], v[92:95], v[140:143]
 buffer_load_dwordx4 v[124:127], v11, s[24:27], s50 offen
 s_add_u32 s24, s24, 4096
 s_addc_u32 s25, s25, 0
 v_mfma_f32_16x16x32_bf16 v[144:147], v[20:23], v[80:83], v[144:147]
 ds_read_b64_tr_b16 v[54:55], v3 offset:12704
 v_mfma_f32_16x16x32_bf16 v[148:151], v[20:23], v[84:87], v[148:151]
 ds_read_b64_tr_b16 v[56:57], v4 offset:8448
 s_add_u32 s59, s22, 0
 s_and_b32 s59, s59, 7
 s_lshl_b32 s59, s59, 18
 s_lshl_b32 s44, s51, 16
 s_add_u32 s44, s44, s59
 s_add_u32 s45, s44, 32768
 v_mfma_f32_16x16x32_bf16 v[152:155], v[20:23], v[88:91], v[152:155]
 ds_read_b64_tr_b16 v[58:59], v4 offset:12672
 v_mfma_f32_16x16x32_bf16 v[156:159], v[20:23], v[92:95], v[156:159]
 s_add_u32 m0, s46, 0
 v_mfma_f32_16x16x32_bf16 v[160:163], v[24:27], v[80:83], v[160:163]
 ds_read_b64_tr_b16 v[60:61], v4 offset:8480
 v_mfma_f32_16x16x32_bf16 v[164:167], v[24:27], v[84:87], v[164:167]
 ds_read_b64_tr_b16 v[62:63], v4 offset:12704
 buffer_load_dwordx4 v7, s[32:35], s44 offen offset:0 lds
 s_barrier
 v_mfma_f32_16x16x32_bf16 v[168:171], v[24:27], v[88:91], v[168:171]
 v_mfma_f32_16x16x32_bf16 v[172:175], v[24:27], v[92:95], v[172:175]
 ds_read_b64_tr_b16 v[64:65], v5 offset:8448
 v_mfma_f32_16x16x32_bf16 v[176:179], v[28:31], v[80:83], v[176:179]
 ds_read_b64_tr_b16 v[66:67], v5 offset:12672
 buffer_load_dwordx4 v8, s[32:35], s44 offen offset:1056 lds
 v_mfma_f32_16x16x32_bf16 v[180:183], v[28:31], v[84:87], v[180:183]
 ds_read_b64_tr_b16 v[68:69], v5 offset:8480
 v_mfma_f32_16x16x32_bf16 v[184:187], v[28:31], v[88:91], v[184:187]
 buffer_load_dwordx4 v9, s[32:35], s44 offen offset:2112 lds
 v_mfma_f32_16x16x32_bf16 v[188:191], v[28:31], v[92:95], v[188:191]
 ds_read_b64_tr_b16 v[70:71], v5 offset:12704
 v_mfma_f32_16x16x32_bf16 v[192:195], v[32:35], v[80:83], v[192:195]
 ds_read_b64_tr_b16 v[72:73], v6 offset:8448
 buffer_load_dwordx4 v10, s[32:35], s44 offen offset:3168 lds
 v_mfma_f32_16x16x32_bf16 v[196:199], v[32:35], v[84:87], v[196:199]
 ds_read_b64_tr_b16 v[74:75], v6 offset:12672
 v_mfma_f32_16x16x32_bf16 v[200:203], v[32:35], v[88:91], v[200:203]
 v_mfma_f32_16x16x32_bf16 v[204:207], v[32:35], v[92:95], v[204:207]
 ds_read_b64_tr_b16 v[76:77], v6 offset:8480
 s_add_u32 m0, s46, 4224
 v_mfma_f32_16x16x32_bf16 v[208:211], v[36:39], v[80:83], v[208:211]
 ds_read_b64_tr_b16 v[78:79], v6 offset:12704
 v_mfma_f32_16x16x32_bf16 v[212:215], v[36:39], v[84:87], v[212:215]
 buffer_load_dwordx4 v7, s[32:35], s45 offen offset:0 lds
 v_mfma_f32_16x16x32_bf16 v[216:219], v[36:39], v[88:91], v[216:219]
 v_mfma_f32_16x16x32_bf16 v[220:223], v[36:39], v[92:95], v[220:223]
 buffer_load_dwordx4 v8, s[32:35], s45 offen offset:1056 lds
 v_mfma_f32_16x16x32_bf16 v[224:227], v[40:43], v[80:83], v[224:227]
 v_mfma_f32_16x16x32_bf16 v[228:231], v[40:43], v[84:87], v[228:231]
 v_mfma_f32_16x16x32_bf16 v[232:235], v[40:43], v[88:91], v[232:235]
 buffer_load_dwordx4 v9, s[32:35], s45 offen offset:2112 lds
 v_mfma_f32_16x16x32_bf16 v[236:239], v[40:43], v[92:95], v[236:239]
 v_mfma_f32_16x16x32_bf16 v[240:243], v[44:47], v[80:83], v[240:243]
 buffer_load_dwordx4 v10, s[32:35], s45 offen offset:3168 lds
 s_add_u32 s44, s44, 262144
 s_add_u32 s45, s45, 262144
 v_mfma_f32_16x16x32_bf16 v[244:247], v[44:47], v[84:87], v[244:247]
 v_mfma_f32_16x16x32_bf16 v[248:251], v[44:47], v[88:91], v[248:251]
 v_mfma_f32_16x16x32_bf16 v[252:255], v[44:47], v[92:95], v[252:255]
 s_waitcnt vmcnt(20) lgkmcnt(0)
 v_mfma_f32_16x16x32_bf16 v[128:131], v[48:51], v[96:99], v[128:131]
 buffer_load_dwordx4 v[80:83], v11, s[24:27], s47 offen
 ds_read_b64_tr_b16 v[16:17], v3 offset:16896
 v_mfma_f32_16x16x32_bf16 v[132:135], v[48:51], v[100:103], v[132:135]
 buffer_load_dwordx4 v[84:87], v11, s[24:27], s48 offen
 ds_read_b64_tr_b16 v[18:19], v3 offset:21120
 v_mfma_f32_16x16x32_bf16 v[136:139], v[48:51], v[104:107], v[136:139]
 buffer_load_dwordx4 v[88:91], v11, s[24:27], s49 offen
 ds_read_b64_tr_b16 v[20:21], v3 offset:16928
 v_mfma_f32_16x16x32_bf16 v[140:143], v[48:51], v[108:111], v[140:143]
 buffer_load_dwordx4 v[92:95], v11, s[24:27], s50 offen
 s_add_u32 s24, s24, 4096
 s_addc_u32 s25, s25, 0
 v_mfma_f32_16x16x32_bf16 v[144:147], v[52:55], v[96:99], v[144:147]
 ds_read_b64_tr_b16 v[22:23], v3 offset:21152
 v_mfma_f32_16x16x32_bf16 v[148:151], v[52:55], v[100:103], v[148:151]
 ds_read_b64_tr_b16 v[24:25], v4 offset:16896
 s_add_u32 s59, s22, 1
 s_and_b32 s59, s59, 7
 s_lshl_b32 s59, s59, 18
 s_lshl_b32 s44, s51, 16
 s_add_u32 s44, s44, s59
 s_add_u32 s45, s44, 32768
 s_barrier
 v_mfma_f32_16x16x32_bf16 v[152:155], v[52:55], v[104:107], v[152:155]
 ds_read_b64_tr_b16 v[26:27], v4 offset:21120
 v_mfma_f32_16x16x32_bf16 v[156:159], v[52:55], v[108:111], v[156:159]
 s_add_u32 m0, s46, 8448
 v_mfma_f32_16x16x32_bf16 v[160:163], v[56:59], v[96:99], v[160:163]
 ds_read_b64_tr_b16 v[28:29], v4 offset:16928
 v_mfma_f32_16x16x32_bf16 v[164:167], v[56:59], v[100:103], v[164:167]
 ds_read_b64_tr_b16 v[30:31], v4 offset:21152
 buffer_load_dwordx4 v7, s[32:35], s44 offen offset:0 lds
 v_mfma_f32_16x16x32_bf16 v[168:171], v[56:59], v[104:107], v[168:171]
 v_mfma_f32_16x16x32_bf16 v[172:175], v[56:59], v[108:111], v[172:175]
 ds_read_b64_tr_b16 v[32:33], v5 offset:16896
 v_mfma_f32_16x16x32_bf16 v[176:179], v[60:63], v[96:99], v[176:179]
 ds_read_b64_tr_b16 v[34:35], v5 offset:21120
 buffer_load_dwordx4 v8, s[32:35], s44 offen offset:1056 lds
 v_mfma_f32_16x16x32_bf16 v[180:183], v[60:63], v[100:103], v[180:183]
 ds_read_b64_tr_b16 v[36:37], v5 offset:16928
 v_mfma_f32_16x16x32_bf16 v[184:187], v[60:63], v[104:107], v[184:187]
 buffer_load_dwordx4 v9, s[32:35], s44 offen offset:2112 lds
 v_mfma_f32_16x16x32_bf16 v[188:191], v[60:63], v[108:111], v[188:191]
 ds_read_b64_tr_b16 v[38:39], v5 offset:21152
 v_mfma_f32_16x16x32_bf16 v[192:195], v[64:67], v[96:99], v[192:195]
 ds_read_b64_tr_b16 v[40:41], v6 offset:16896
 buffer_load_dwordx4 v10, s[32:35], s44 offen offset:3168 lds
 v_mfma_f32_16x16x32_bf16 v[196:199], v[64:67], v[100:103], v[196:199]
 ds_read_b64_tr_b16 v[42:43], v6 offset:21120
 v_mfma_f32_16x16x32_bf16 v[200:203], v[64:67], v[104:107], v[200:203]
 v_mfma_f32_16x16x32_bf16 v[204:207], v[64:67], v[108:111], v[204:207]
 ds_read_b64_tr_b16 v[44:45], v6 offset:16928
 s_add_u32 m0, s46, 12672
 v_mfma_f32_16x16x32_bf16 v[208:211], v[68:71], v[96:99], v[208:211]
 ds_read_b64_tr_b16 v[46:47], v6 offset:21152
 v_mfma_f32_16x16x32_bf16 v[212:215], v[68:71], v[100:103], v[212:215]
 buffer_load_dwordx4 v7, s[32:35], s45 offen offset:0 lds
 v_mfma_f32_16x16x32_bf16 v[216:219], v[68:71], v[104:107], v[216:219]
 v_mfma_f32_16x16x32_bf16 v[220:223], v[68:71], v[108:111], v[220:223]
 buffer_load_dwordx4 v8, s[32:35], s45 offen offset:1056 lds
 v_mfma_f32_16x16x32_bf16 v[224:227], v[72:75], v[96:99], v[224:227]
 v_mfma_f32_16x16x32_bf16 v[228:231], v[72:75], v[100:103], v[228:231]
 v_mfma_f32_16x16x32_bf16 v[232:235], v[72:75], v[104:107], v[232:235]
 buffer_load_dwordx4 v9, s[32:35], s45 offen offset:2112 lds
 v_mfma_f32_16x16x32_bf16 v[236:239], v[72:75], v[108:111], v[236:239]
 v_mfma_f32_16x16x32_bf16 v[240:243], v[76:79], v[96:99], v[240:243]
 buffer_load_dwordx4 v10, s[32:35], s45 offen offset:3168 lds
 s_add_u32 s44, s44, 262144
 s_add_u32 s45, s45, 262144
 v_mfma_f32_16x16x32_bf16 v[244:247], v[76:79], v[100:103], v[244:247]
 v_mfma_f32_16x16x32_bf16 v[248:251], v[76:79], v[104:107], v[248:251]
 v_mfma_f32_16x16x32_bf16 v[252:255], v[76:79], v[108:111], v[252:255]
 s_waitcnt vmcnt(20) lgkmcnt(0)
 v_mfma_f32_16x16x32_bf16 v[128:131], v[16:19], v[112:115], v[128:131]
 ds_read_b64_tr_b16 v[48:49], v3 offset:25344
 v_mfma_f32_16x16x32_bf16 v[132:135], v[16:19], v[116:119], v[132:135]
 ds_read_b64_tr_b16 v[50:51], v3 offset:29568
 v_mfma_f32_16x16x32_bf16 v[136:139], v[16:19], v[120:123], v[136:139]
 ds_read_b64_tr_b16 v[52:53], v3 offset:25376
 s_barrier
 v_mfma_f32_16x16x32_bf16 v[140:143], v[16:19], v[124:127], v[140:143]
 v_mfma_f32_16x16x32_bf16 v[144:147], v[20:23], v[112:115], v[144:147]
 ds_read_b64_tr_b16 v[54:55], v3 offset:29600
 v_mfma_f32_16x16x32_bf16 v[148:151], v[20:23], v[116:119], v[148:151]
 ds_read_b64_tr_b16 v[56:57], v4 offset:25344
 s_add_u32 s59, s22, 2
 s_and_b32 s59, s59, 7
 s_lshl_b32 s59, s59, 18
 s_lshl_b32 s44, s51, 16
 s_add_u32 s44, s44, s59
 s_add_u32 s45, s44, 32768
 v_mfma_f32_16x16x32_bf16 v[152:155], v[20:23], v[120:123], v[152:155]
 ds_read_b64_tr_b16 v[58:59], v4 offset:29568
 v_mfma_f32_16x16x32_bf16 v[156:159], v[20:23], v[124:127], v[156:159]
 s_add_u32 m0, s46, 16896
 v_mfma_f32_16x16x32_bf16 v[160:163], v[24:27], v[112:115], v[160:163]
 ds_read_b64_tr_b16 v[60:61], v4 offset:25376
 v_mfma_f32_16x16x32_bf16 v[164:167], v[24:27], v[116:119], v[164:167]
 ds_read_b64_tr_b16 v[62:63], v4 offset:29600
 buffer_load_dwordx4 v7, s[32:35], s44 offen offset:0 lds
 v_mfma_f32_16x16x32_bf16 v[168:171], v[24:27], v[120:123], v[168:171]
 v_mfma_f32_16x16x32_bf16 v[172:175], v[24:27], v[124:127], v[172:175]
 ds_read_b64_tr_b16 v[64:65], v5 offset:25344
 v_mfma_f32_16x16x32_bf16 v[176:179], v[28:31], v[112:115], v[176:179]
 ds_read_b64_tr_b16 v[66:67], v5 offset:29568
 buffer_load_dwordx4 v8, s[32:35], s44 offen offset:1056 lds
 v_mfma_f32_16x16x32_bf16 v[180:183], v[28:31], v[116:119], v[180:183]
 ds_read_b64_tr_b16 v[68:69], v5 offset:25376
 v_mfma_f32_16x16x32_bf16 v[184:187], v[28:31], v[120:123], v[184:187]
 buffer_load_dwordx4 v9, s[32:35], s44 offen offset:2112 lds
 v_mfma_f32_16x16x32_bf16 v[188:191], v[28:31], v[124:127], v[188:191]
 ds_read_b64_tr_b16 v[70:71], v5 offset:29600
 v_mfma_f32_16x16x32_bf16 v[192:195], v[32:35], v[112:115], v[192:195]
 ds_read_b64_tr_b16 v[72:73], v6 offset:25344
 buffer_load_dwordx4 v10, s[32:35], s44 offen offset:3168 lds
 v_mfma_f32_16x16x32_bf16 v[196:199], v[32:35], v[116:119], v[196:199]
 ds_read_b64_tr_b16 v[74:75], v6 offset:29568
 v_mfma_f32_16x16x32_bf16 v[200:203], v[32:35], v[120:123], v[200:203]
 v_mfma_f32_16x16x32_bf16 v[204:207], v[32:35], v[124:127], v[204:207]
 ds_read_b64_tr_b16 v[76:77], v6 offset:25376
 s_add_u32 m0, s46, 21120
 v_mfma_f32_16x16x32_bf16 v[208:211], v[36:39], v[112:115], v[208:211]
 ds_read_b64_tr_b16 v[78:79], v6 offset:29600
 v_mfma_f32_16x16x32_bf16 v[212:215], v[36:39], v[116:119], v[212:215]
 buffer_load_dwordx4 v7, s[32:35], s45 offen offset:0 lds
 v_mfma_f32_16x16x32_bf16 v[216:219], v[36:39], v[120:123], v[216:219]
 v_mfma_f32_16x16x32_bf16 v[220:223], v[36:39], v[124:127], v[220:223]
 buffer_load_dwordx4 v8, s[32:35], s45 offen offset:1056 lds
 v_mfma_f32_16x16x32_bf16 v[224:227], v[40:43], v[112:115], v[224:227]
 v_mfma_f32_16x16x32_bf16 v[228:231], v[40:43], v[116:119], v[228:231]
 v_mfma_f32_16x16x32_bf16 v[232:235], v[40:43], v[120:123], v[232:235]
 buffer_load_dwordx4 v9, s[32:35], s45 offen offset:2112 lds
 v_mfma_f32_16x16x32_bf16 v[236:239], v[40:43], v[124:127], v[236:239]
 v_mfma_f32_16x16x32_bf16 v[240:243], v[44:47], v[112:115], v[240:243]
 buffer_load_dwordx4 v10, s[32:35], s45 offen offset:3168 lds
 s_add_u32 s44, s44, 262144
 s_add_u32 s45, s45, 262144
 v_mfma_f32_16x16x32_bf16 v[244:247], v[44:47], v[116:119], v[244:247]
 v_mfma_f32_16x16x32_bf16 v[248:251], v[44:47], v[120:123], v[248:251]
 v_mfma_f32_16x16x32_bf16 v[252:255], v[44:47], v[124:127], v[252:255]
 s_barrier
 s_waitcnt vmcnt(16) lgkmcnt(0)
 v_mfma_f32_16x16x32_bf16 v[128:131], v[48:51], v[80:83], v[128:131]
 s_add_u32 s58, s22, 0
 s_and_b32 s58, s58, 7
 s_lshl_b32 s58, s58, 12
 s_add_u32 s24, s62, s58
 s_addc_u32 s25, s63, 0
 ds_read_b64_tr_b16 v[16:17], v3 offset:0
 v_mfma_f32_16x16x32_bf16 v[132:135], v[48:51], v[84:87], v[132:135]
 buffer_load_dwordx4 v[96:99], v11, s[24:27], s47 offen sc1
 ds_read_b64_tr_b16 v[18:19], v3 offset:4224
 v_mfma_f32_16x16x32_bf16 v[136:139], v[48:51], v[88:91], v[136:139]
 buffer_load_dwordx4 v[100:103], v11, s[24:27], s48 offen sc1
 ds_read_b64_tr_b16 v[20:21], v3 offset:32
 v_mfma_f32_16x16x32_bf16 v[140:143], v[48:51], v[92:95], v[140:143]
 buffer_load_dwordx4 v[104:107], v11, s[24:27], s49 offen sc1
 v_mfma_f32_16x16x32_bf16 v[144:147], v[52:55], v[80:83], v[144:147]
 buffer_load_dwordx4 v[108:111], v11, s[24:27], s50 offen sc1
 s_add_u32 s24, s24, 4096
 s_addc_u32 s25, s25, 0
 ds_read_b64_tr_b16 v[22:23], v3 offset:4256
 v_mfma_f32_16x16x32_bf16 v[148:151], v[52:55], v[84:87], v[148:151]
 ds_read_b64_tr_b16 v[24:25], v4 offset:0
 s_add_u32 s59, s22, 3
 s_and_b32 s59, s59, 7
 s_lshl_b32 s59, s59, 18
 s_lshl_b32 s44, s51, 16
 s_add_u32 s44, s44, s59
 s_add_u32 s45, s44, 32768
 v_mfma_f32_16x16x32_bf16 v[152:155], v[52:55], v[88:91], v[152:155]
 ds_read_b64_tr_b16 v[26:27], v4 offset:4224
 v_mfma_f32_16x16x32_bf16 v[156:159], v[52:55], v[92:95], v[156:159]
 s_add_u32 m0, s46, 25344
 v_mfma_f32_16x16x32_bf16 v[160:163], v[56:59], v[80:83], v[160:163]
 ds_read_b64_tr_b16 v[28:29], v4 offset:32
 v_mfma_f32_16x16x32_bf16 v[164:167], v[56:59], v[84:87], v[164:167]
 ds_read_b64_tr_b16 v[30:31], v4 offset:4256
 buffer_load_dwordx4 v7, s[32:35], s44 offen offset:0 lds
 v_mfma_f32_16x16x32_bf16 v[168:171], v[56:59], v[88:91], v[168:171]
 v_mfma_f32_16x16x32_bf16 v[172:175], v[56:59], v[92:95], v[172:175]
 ds_read_b64_tr_b16 v[32:33], v5 offset:0
 v_mfma_f32_16x16x32_bf16 v[176:179], v[60:63], v[80:83], v[176:179]
 ds_read_b64_tr_b16 v[34:35], v5 offset:4224
 buffer_load_dwordx4 v8, s[32:35], s44 offen offset:1056 lds
 v_mfma_f32_16x16x32_bf16 v[180:183], v[60:63], v[84:87], v[180:183]
 ds_read_b64_tr_b16 v[36:37], v5 offset:32
 v_mfma_f32_16x16x32_bf16 v[184:187], v[60:63], v[88:91], v[184:187]
 buffer_load_dwordx4 v9, s[32:35], s44 offen offset:2112 lds
 v_mfma_f32_16x16x32_bf16 v[188:191], v[60:63], v[92:95], v[188:191]
 ds_read_b64_tr_b16 v[38:39], v5 offset:4256
 v_mfma_f32_16x16x32_bf16 v[192:195], v[64:67], v[80:83], v[192:195]
 ds_read_b64_tr_b16 v[40:41], v6 offset:0
 buffer_load_dwordx4 v10, s[32:35], s44 offen offset:3168 lds
 v_mfma_f32_16x16x32_bf16 v[196:199], v[64:67], v[84:87], v[196:199]
 ds_read_b64_tr_b16 v[42:43], v6 offset:4224
 v_mfma_f32_16x16x32_bf16 v[200:203], v[64:67], v[88:91], v[200:203]
 v_mfma_f32_16x16x32_bf16 v[204:207], v[64:67], v[92:95], v[204:207]
 ds_read_b64_tr_b16 v[44:45], v6 offset:32
 s_add_u32 m0, s46, 29568
 v_mfma_f32_16x16x32_bf16 v[208:211], v[68:71], v[80:83], v[208:211]
 ds_read_b64_tr_b16 v[46:47], v6 offset:4256
 v_mfma_f32_16x16x32_bf16 v[212:215], v[68:71], v[84:87], v[212:215]
 buffer_load_dwordx4 v7, s[32:35], s45 offen offset:0 lds
 v_mfma_f32_16x16x32_bf16 v[216:219], v[68:71], v[88:91], v[216:219]
 v_mfma_f32_16x16x32_bf16 v[220:223], v[68:71], v[92:95], v[220:223]
 buffer_load_dwordx4 v8, s[32:35], s45 offen offset:1056 lds
 v_mfma_f32_16x16x32_bf16 v[224:227], v[72:75], v[80:83], v[224:227]
 v_mfma_f32_16x16x32_bf16 v[228:231], v[72:75], v[84:87], v[228:231]
 v_mfma_f32_16x16x32_bf16 v[232:235], v[72:75], v[88:91], v[232:235]
 buffer_load_dwordx4 v9, s[32:35], s45 offen offset:2112 lds
 v_mfma_f32_16x16x32_bf16 v[236:239], v[72:75], v[92:95], v[236:239]
 v_mfma_f32_16x16x32_bf16 v[240:243], v[76:79], v[80:83], v[240:243]
 buffer_load_dwordx4 v10, s[32:35], s45 offen offset:3168 lds
 s_add_u32 s44, s44, 262144
 s_add_u32 s45, s45, 262144
 v_mfma_f32_16x16x32_bf16 v[244:247], v[76:79], v[84:87], v[244:247]
 v_mfma_f32_16x16x32_bf16 v[248:251], v[76:79], v[88:91], v[248:251]
 v_mfma_f32_16x16x32_bf16 v[252:255], v[76:79], v[92:95], v[252:255]
 s_waitcnt vmcnt(8) lgkmcnt(0)
 v_mfma_f32_16x16x32_bf16 v[128:131], v[16:19], v[96:99], v[128:131]
 ds_read_b64_tr_b16 v[48:49], v3 offset:8448
 v_mfma_f32_16x16x32_bf16 v[132:135], v[16:19], v[100:103], v[132:135]
 ds_read_b64_tr_b16 v[50:51], v3 offset:12672
 v_mfma_f32_16x16x32_bf16 v[136:139], v[16:19], v[104:107], v[136:139]
 ds_read_b64_tr_b16 v[52:53], v3 offset:8480
 v_mfma_f32_16x16x32_bf16 v[140:143], v[16:19], v[108:111], v[140:143]
 v_mfma_f32_16x16x32_bf16 v[144:147], v[20:23], v[96:99], v[144:147]
 ds_read_b64_tr_b16 v[54:55], v3 offset:12704
 v_mfma_f32_16x16x32_bf16 v[148:151], v[20:23], v[100:103], v[148:151]
 ds_read_b64_tr_b16 v[56:57], v4 offset:8448
 s_add_u32 s59, s22, 4
 s_and_b32 s59, s59, 7
 s_lshl_b32 s59, s59, 18
 s_lshl_b32 s44, s51, 16
 s_add_u32 s44, s44, s59
 s_add_u32 s45, s44, 32768
 v_mfma_f32_16x16x32_bf16 v[152:155], v[20:23], v[104:107], v[152:155]
 ds_read_b64_tr_b16 v[58:59], v4 offset:12672
 v_mfma_f32_16x16x32_bf16 v[156:159], v[20:23], v[108:111], v[156:159]
 s_add_u32 m0, s46, 0
 v_mfma_f32_16x16x32_bf16 v[160:163], v[24:27], v[96:99], v[160:163]
 ds_read_b64_tr_b16 v[60:61], v4 offset:8480
 v_mfma_f32_16x16x32_bf16 v[164:167], v[24:27], v[100:103], v[164:167]
 ds_read_b64_tr_b16 v[62:63], v4 offset:12704
 buffer_load_dwordx4 v7, s[32:35], s44 offen offset:0 lds
 v_mfma_f32_16x16x32_bf16 v[168:171], v[24:27], v[104:107], v[168:171]
 v_mfma_f32_16x16x32_bf16 v[172:175], v[24:27], v[108:111], v[172:175]
 ds_read_b64_tr_b16 v[64:65], v5 offset:8448
 v_mfma_f32_16x16x32_bf16 v[176:179], v[28:31], v[96:99], v[176:179]
 ds_read_b64_tr_b16 v[66:67], v5 offset:12672
 buffer_load_dwordx4 v8, s[32:35], s44 offen offset:1056 lds
 v_mfma_f32_16x16x32_bf16 v[180:183], v[28:31], v[100:103], v[180:183]
 ds_read_b64_tr_b16 v[68:69], v5 offset:8480
 v_mfma_f32_16x16x32_bf16 v[184:187], v[28:31], v[104:107], v[184:187]
 buffer_load_dwordx4 v9, s[32:35], s44 offen offset:2112 lds
 v_mfma_f32_16x16x32_bf16 v[188:191], v[28:31], v[108:111], v[188:191]
 ds_read_b64_tr_b16 v[70:71], v5 offset:12704
 v_mfma_f32_16x16x32_bf16 v[192:195], v[32:35], v[96:99], v[192:195]
 ds_read_b64_tr_b16 v[72:73], v6 offset:8448
 buffer_load_dwordx4 v10, s[32:35], s44 offen offset:3168 lds
 v_mfma_f32_16x16x32_bf16 v[196:199], v[32:35], v[100:103], v[196:199]
 ds_read_b64_tr_b16 v[74:75], v6 offset:12672
 v_mfma_f32_16x16x32_bf16 v[200:203], v[32:35], v[104:107], v[200:203]
 v_mfma_f32_16x16x32_bf16 v[204:207], v[32:35], v[108:111], v[204:207]
 ds_read_b64_tr_b16 v[76:77], v6 offset:8480
 s_add_u32 m0, s46, 4224
 v_mfma_f32_16x16x32_bf16 v[208:211], v[36:39], v[96:99], v[208:211]
 ds_read_b64_tr_b16 v[78:79], v6 offset:12704
 v_mfma_f32_16x16x32_bf16 v[212:215], v[36:39], v[100:103], v[212:215]
 buffer_load_dwordx4 v7, s[32:35], s45 offen offset:0 lds
 v_mfma_f32_16x16x32_bf16 v[216:219], v[36:39], v[104:107], v[216:219]
 v_mfma_f32_16x16x32_bf16 v[220:223], v[36:39], v[108:111], v[220:223]
 buffer_load_dwordx4 v8, s[32:35], s45 offen offset:1056 lds
 v_mfma_f32_16x16x32_bf16 v[224:227], v[40:43], v[96:99], v[224:227]
 v_mfma_f32_16x16x32_bf16 v[228:231], v[40:43], v[100:103], v[228:231]
 v_mfma_f32_16x16x32_bf16 v[232:235], v[40:43], v[104:107], v[232:235]
 buffer_load_dwordx4 v9, s[32:35], s45 offen offset:2112 lds
 v_mfma_f32_16x16x32_bf16 v[236:239], v[40:43], v[108:111], v[236:239]
 v_mfma_f32_16x16x32_bf16 v[240:243], v[44:47], v[96:99], v[240:243]
 buffer_load_dwordx4 v10, s[32:35], s45 offen offset:3168 lds
 s_add_u32 s44, s44, 262144
 s_add_u32 s45, s45, 262144
 v_mfma_f32_16x16x32_bf16 v[244:247], v[44:47], v[100:103], v[244:247]
 v_mfma_f32_16x16x32_bf16 v[248:251], v[44:47], v[104:107], v[248:251]
 v_mfma_f32_16x16x32_bf16 v[252:255], v[44:47], v[108:111], v[252:255]
 s_cmp_lg_u32 s51, 0
 s_cbranch_scc1 L_fused_kernel_polled
 s_lshl_b32 s52, s21, 8
 v_mov_b32 v12, s52
 s_mov_b32 s53, 0
L_fused_kernel_poll:
 global_load_dword v13, v12, s[18:19] sc1
 s_waitcnt vmcnt(0)
 v_readfirstlane_b32 s54, v13
 s_add_u32 s53, s53, 1
 s_cmp_ge_u32 s54, 8
 s_cbranch_scc1 L_fused_kernel_polled
 s_sleep 2
 s_cmp_lt_u32 s53, 1048576
 s_cbranch_scc1 L_fused_kernel_poll
L_fused_kernel_polled:
 s_barrier
 s_add_u32 s58, s22, 1
 s_and_b32 s58, s58, 7
 s_lshl_b32 s58, s58, 12
 s_add_u32 s24, s62, s58
 s_addc_u32 s25, s63, 0
 buffer_load_dwordx4 v[112:115], v11, s[24:27], s47 offen sc1
 buffer_load_dwordx4 v[116:119], v11, s[24:27], s48 offen sc1
 buffer_load_dwordx4 v[120:123], v11, s[24:27], s49 offen sc1
 buffer_load_dwordx4 v[124:127], v11, s[24:27], s50 offen sc1
 s_add_u32 s24, s24, 4096
 s_addc_u32 s25, s25, 0
 s_add_u32 s58, s22, 2
 s_and_b32 s58, s58, 7
 s_lshl_b32 s58, s58, 12
 s_add_u32 s24, s62, s58
 s_addc_u32 s25, s63, 0
 buffer_load_dwordx4 v[80:83], v11, s[24:27], s47 offen sc1
 buffer_load_dwordx4 v[84:87], v11, s[24:27], s48 offen sc1
 buffer_load_dwordx4 v[88:91], v11, s[24:27], s49 offen sc1
 buffer_load_dwordx4 v[92:95], v11, s[24:27], s50 offen sc1
 s_add_u32 s24, s24, 4096
 s_addc_u32 s25, s25, 0
 s_add_u32 s58, s22, 3
 s_and_b32 s58, s58, 7
 s_lshl_b32 s58, s58, 12
 s_add_u32 s24, s62, s58
 s_addc_u32 s25, s63, 0
 buffer_load_dwordx4 v[96:99], v11, s[24:27], s47 offen sc1
 buffer_load_dwordx4 v[100:103], v11, s[24:27], s48 offen sc1
 buffer_load_dwordx4 v[104:107], v11, s[24:27], s49 offen sc1
 buffer_load_dwordx4 v[108:111], v11, s[24:27], s50 offen sc1
 s_add_u32 s24, s24, 4096
 s_addc_u32 s25, s25, 0
 s_waitcnt vmcnt(8) lgkmcnt(0)
 v_mfma_f32_16x16x32_bf16 v[128:131], v[48:51], v[112:115], v[128:131]
 ds_read_b64_tr_b16 v[16:17], v3 offset:16896
 v_mfma_f32_16x16x32_bf16 v[132:135], v[48:51], v[116:119], v[132:135]
 ds_read_b64_tr_b16 v[18:19], v3 offset:21120
 v_mfma_f32_16x16x32_bf16 v[136:139], v[48:51], v[120:123], v[136:139]
 ds_read_b64_tr_b16 v[20:21], v3 offset:16928
 v_mfma_f32_16x16x32_bf16 v[140:143], v[48:51], v[124:127], v[140:143]
 v_mfma_f32_16x16x32_bf16 v[144:147], v[52:55], v[112:115], v[144:147]
 ds_read_b64_tr_b16 v[22:23], v3 offset:21152
 v_mfma_f32_16x16x32_bf16 v[148:151], v[52:55], v[116:119], v[148:151]
 ds_read_b64_tr_b16 v[24:25], v4 offset:16896
 s_add_u32 s59, s22, 5
 s_and_b32 s59, s59, 7
 s_lshl_b32 s59, s59, 18
 s_lshl_b32 s44, s51, 16
 s_add_u32 s44, s44, s59
 s_add_u32 s45, s44, 32768
 v_mfma_f32_16x16x32_bf16 v[152:155], v[52:55], v[120:123], v[152:155]
 ds_read_b64_tr_b16 v[26:27], v4 offset:21120
 v_mfma_f32_16x16x32_bf16 v[156:159], v[52:55], v[124:127], v[156:159]
 s_add_u32 m0, s46, 8448
 v_mfma_f32_16x16x32_bf16 v[160:163], v[56:59], v[112:115], v[160:163]
 ds_read_b64_tr_b16 v[28:29], v4 offset:16928
 v_mfma_f32_16x16x32_bf16 v[164:167], v[56:59], v[116:119], v[164:167]
 ds_read_b64_tr_b16 v[30:31], v4 offset:21152
 buffer_load_dwordx4 v7, s[32:35], s44 offen offset:0 lds
 v_mfma_f32_16x16x32_bf16 v[168:171], v[56:59], v[120:123], v[168:171]
 v_mfma_f32_16x16x32_bf16 v[172:175], v[56:59], v[124:127], v[172:175]
 ds_read_b64_tr_b16 v[32:33], v5 offset:16896
 v_mfma_f32_16x16x32_bf16 v[176:179], v[60:63], v[112:115], v[176:179]
 ds_read_b64_tr_b16 v[34:35], v5 offset:21120
 buffer_load_dwordx4 v8, s[32:35], s44 offen offset:1056 lds
 v_mfma_f32_16x16x32_bf16 v[180:183], v[60:63], v[116:119], v[180:183]
 ds_read_b64_tr_b16 v[36:37], v5 offset:16928
 v_mfma_f32_16x16x32_bf16 v[184:187], v[60:63], v[120:123], v[184:187]
 buffer_load_dwordx4 v9, s[32:35], s44 offen offset:2112 lds
 v_mfma_f32_16x16x32_bf16 v[188:191], v[60:63], v[124:127], v[188:191]
 ds_read_b64_tr_b16 v[38:39], v5 offset:21152
 v_mfma_f32_16x16x32_bf16 v[192:195], v[64:67], v[112:115], v[192:195]
 ds_read_b64_tr_b16 v[40:41], v6 offset:16896
 buffer_load_dwordx4 v10, s[32:35], s44 offen offset:3168 lds
 v_mfma_f32_16x16x32_bf16 v[196:199], v[64:67], v[116:119], v[196:199]
 ds_read_b64_tr_b16 v[42:43], v6 offset:21120
 v_mfma_f32_16x16x32_bf16 v[200:203], v[64:67], v[120:123], v[200:203]
 v_mfma_f32_16x16x32_bf16 v[204:207], v[64:67], v[124:127], v[204:207]
 ds_read_b64_tr_b16 v[44:45], v6 offset:16928
 s_add_u32 m0, s46, 12672
 v_mfma_f32_16x16x32_bf16 v[208:211], v[68:71], v[112:115], v[208:211]
 ds_read_b64_tr_b16 v[46:47], v6 offset:21152
 v_mfma_f32_16x16x32_bf16 v[212:215], v[68:71], v[116:119], v[212:215]
 buffer_load_dwordx4 v7, s[32:35], s45 offen offset:0 lds
 v_mfma_f32_16x16x32_bf16 v[216:219], v[68:71], v[120:123], v[216:219]
 v_mfma_f32_16x16x32_bf16 v[220:223], v[68:71], v[124:127], v[220:223]
 buffer_load_dwordx4 v8, s[32:35], s45 offen offset:1056 lds
 v_mfma_f32_16x16x32_bf16 v[224:227], v[72:75], v[112:115], v[224:227]
 v_mfma_f32_16x16x32_bf16 v[228:231], v[72:75], v[116:119], v[228:231]
 v_mfma_f32_16x16x32_bf16 v[232:235], v[72:75], v[120:123], v[232:235]
 buffer_load_dwordx4 v9, s[32:35], s45 offen offset:2112 lds
 v_mfma_f32_16x16x32_bf16 v[236:239], v[72:75], v[124:127], v[236:239]
 v_mfma_f32_16x16x32_bf16 v[240:243], v[76:79], v[112:115], v[240:243]
 buffer_load_dwordx4 v10, s[32:35], s45 offen offset:3168 lds
 s_add_u32 s44, s44, 262144
 s_add_u32 s45, s45, 262144
 v_mfma_f32_16x16x32_bf16 v[244:247], v[76:79], v[116:119], v[244:247]
 v_mfma_f32_16x16x32_bf16 v[248:251], v[76:79], v[120:123], v[248:251]
 v_mfma_f32_16x16x32_bf16 v[252:255], v[76:79], v[124:127], v[252:255]
 s_add_u32 s58, s22, 4
 s_and_b32 s58, s58, 7
 s_lshl_b32 s58, s58, 12
 s_add_u32 s24, s62, s58
 s_addc_u32 s25, s63, 0
 buffer_load_dwordx4 v[112:115], v11, s[24:27], s47 offen sc1
 buffer_load_dwordx4 v[116:119], v11, s[24:27], s48 offen sc1
 buffer_load_dwordx4 v[120:123], v11, s[24:27], s49 offen sc1
 buffer_load_dwordx4 v[124:127], v11, s[24:27], s50 offen sc1
 s_add_u32 s24, s24, 4096
 s_addc_u32 s25, s25, 0
 s_waitcnt vmcnt(16) lgkmcnt(0)
 v_mfma_f32_16x16x32_bf16 v[128:131], v[16:19], v[80:83], v[128:131]
 ds_read_b64_tr_b16 v[48:49], v3 offset:25344
 v_mfma_f32_16x16x32_bf16 v[132:135], v[16:19], v[84:87], v[132:135]
 ds_read_b64_tr_b16 v[50:51], v3 offset:29568
 v_mfma_f32_16x16x32_bf16 v[136:139], v[16:19], v[88:91], v[136:139]
 ds_read_b64_tr_b16 v[52:53], v3 offset:25376
 v_mfma_f32_16x16x32_bf16 v[140:143], v[16:19], v[92:95], v[140:143]
 v_mfma_f32_16x16x32_bf16 v[144:147], v[20:23], v[80:83], v[144:147]
 ds_read_b64_tr_b16 v[54:55], v3 offset:29600
 v_mfma_f32_16x16x32_bf16 v[148:151], v[20:23], v[84:87], v[148:151]
 ds_read_b64_tr_b16 v[56:57], v4 offset:25344
 s_add_u32 s59, s22, 6
 s_and_b32 s59, s59, 7
 s_lshl_b32 s59, s59, 18
 s_lshl_b32 s44, s51, 16
 s_add_u32 s44, s44, s59
 s_add_u32 s45, s44, 32768
 v_mfma_f32_16x16x32_bf16 v[152:155], v[20:23], v[88:91], v[152:155]
 ds_read_b64_tr_b16 v[58:59], v4 offset:29568
 v_mfma_f32_16x16x32_bf16 v[156:159], v[20:23], v[92:95], v[156:159]
 s_add_u32 m0, s46, 16896
 v_mfma_f32_16x16x32_bf16 v[160:163], v[24:27], v[80:83], v[160:163]
 ds_read_b64_tr_b16 v[60:61], v4 offset:25376
 v_mfma_f32_16x16x32_bf16 v[164:167], v[24:27], v[84:87], v[164:167]
 ds_read_b64_tr_b16 v[62:63], v4 offset:29600
 buffer_load_dwordx4 v7, s[32:35], s44 offen offset:0 lds
 v_mfma_f32_16x16x32_bf16 v[168:171], v[24:27], v[88:91], v[168:171]
 v_mfma_f32_16x16x32_bf16 v[172:175], v[24:27], v[92:95], v[172:175]
 ds_read_b64_tr_b16 v[64:65], v5 offset:25344
 v_mfma_f32_16x16x32_bf16 v[176:179], v[28:31], v[80:83], v[176:179]
 ds_read_b64_tr_b16 v[66:67], v5 offset:29568
 buffer_load_dwordx4 v8, s[32:35], s44 offen offset:1056 lds
 v_mfma_f32_16x16x32_bf16 v[180:183], v[28:31], v[84:87], v[180:183]
 ds_read_b64_tr_b16 v[68:69], v5 offset:25376
 v_mfma_f32_16x16x32_bf16 v[184:187], v[28:31], v[88:91], v[184:187]
 buffer_load_dwordx4 v9, s[32:35], s44 offen offset:2112 lds
 v_mfma_f32_16x16x32_bf16 v[188:191], v[28:31], v[92:95], v[188:191]
 ds_read_b64_tr_b16 v[70:71], v5 offset:29600
 v_mfma_f32_16x16x32_bf16 v[192:195], v[32:35], v[80:83], v[192:195]
 ds_read_b64_tr_b16 v[72:73], v6 offset:25344
 buffer_load_dwordx4 v10, s[32:35], s44 offen offset:3168 lds
 v_mfma_f32_16x16x32_bf16 v[196:199], v[32:35], v[84:87], v[196:199]
 ds_read_b64_tr_b16 v[74:75], v6 offset:29568
 v_mfma_f32_16x16x32_bf16 v[200:203], v[32:35], v[88:91], v[200:203]
 v_mfma_f32_16x16x32_bf16 v[204:207], v[32:35], v[92:95], v[204:207]
 ds_read_b64_tr_b16 v[76:77], v6 offset:25376
 s_add_u32 m0, s46, 21120
 v_mfma_f32_16x16x32_bf16 v[208:211], v[36:39], v[80:83], v[208:211]
 ds_read_b64_tr_b16 v[78:79], v6 offset:29600
 v_mfma_f32_16x16x32_bf16 v[212:215], v[36:39], v[84:87], v[212:215]
 buffer_load_dwordx4 v7, s[32:35], s45 offen offset:0 lds
 v_mfma_f32_16x16x32_bf16 v[216:219], v[36:39], v[88:91], v[216:219]
 v_mfma_f32_16x16x32_bf16 v[220:223], v[36:39], v[92:95], v[220:223]
 buffer_load_dwordx4 v8, s[32:35], s45 offen offset:1056 lds
 v_mfma_f32_16x16x32_bf16 v[224:227], v[40:43], v[80:83], v[224:227]
 v_mfma_f32_16x16x32_bf16 v[228:231], v[40:43], v[84:87], v[228:231]
 v_mfma_f32_16x16x32_bf16 v[232:235], v[40:43], v[88:91], v[232:235]
 buffer_load_dwordx4 v9, s[32:35], s45 offen offset:2112 lds
 v_mfma_f32_16x16x32_bf16 v[236:239], v[40:43], v[92:95], v[236:239]
 v_mfma_f32_16x16x32_bf16 v[240:243], v[44:47], v[80:83], v[240:243]
 buffer_load_dwordx4 v10, s[32:35], s45 offen offset:3168 lds
 s_add_u32 s44, s44, 262144
 s_add_u32 s45, s45, 262144
 v_mfma_f32_16x16x32_bf16 v[244:247], v[44:47], v[84:87], v[244:247]
 v_mfma_f32_16x16x32_bf16 v[248:251], v[44:47], v[88:91], v[248:251]
 v_mfma_f32_16x16x32_bf16 v[252:255], v[44:47], v[92:95], v[252:255]
 s_add_u32 s58, s22, 5
 s_and_b32 s58, s58, 7
 s_lshl_b32 s58, s58, 12
 s_add_u32 s24, s62, s58
 s_addc_u32 s25, s63, 0
 buffer_load_dwordx4 v[80:83], v11, s[24:27], s47 offen sc1
 buffer_load_dwordx4 v[84:87], v11, s[24:27], s48 offen sc1
 buffer_load_dwordx4 v[88:91], v11, s[24:27], s49 offen sc1
 buffer_load_dwordx4 v[92:95], v11, s[24:27], s50 offen sc1
 s_add_u32 s24, s24, 4096
 s_addc_u32 s25, s25, 0
 s_waitcnt vmcnt(24) lgkmcnt(0)
 v_mfma_f32_16x16x32_bf16 v[128:131], v[48:51], v[96:99], v[128:131]
 ds_read_b64_tr_b16 v[16:17], v3 offset:0
 v_mfma_f32_16x16x32_bf16 v[132:135], v[48:51], v[100:103], v[132:135]
 ds_read_b64_tr_b16 v[18:19], v3 offset:4224
 v_mfma_f32_16x16x32_bf16 v[136:139], v[48:51], v[104:107], v[136:139]
 ds_read_b64_tr_b16 v[20:21], v3 offset:32
 v_mfma_f32_16x16x32_bf16 v[140:143], v[48:51], v[108:111], v[140:143]
 v_mfma_f32_16x16x32_bf16 v[144:147], v[52:55], v[96:99], v[144:147]
 ds_read_b64_tr_b16 v[22:23], v3 offset:4256
 v_mfma_f32_16x16x32_bf16 v[148:151], v[52:55], v[100:103], v[148:151]
 ds_read_b64_tr_b16 v[24:25], v4 offset:0
 s_add_u32 s59, s22, 7
 s_and_b32 s59, s59, 7
 s_lshl_b32 s59, s59, 18
 s_lshl_b32 s44, s51, 16
 s_add_u32 s44, s44, s59
 s_add_u32 s45, s44, 32768
 v_mfma_f32_16x16x32_bf16 v[152:155], v[52:55], v[104:107], v[152:155]
 ds_read_b64_tr_b16 v[26:27], v4 offset:4224
 v_mfma_f32_16x16x32_bf16 v[156:159], v[52:55], v[108:111], v[156:159]
 s_add_u32 m0, s46, 25344
 v_mfma_f32_16x16x32_bf16 v[160:163], v[56:59], v[96:99], v[160:163]
 ds_read_b64_tr_b16 v[28:29], v4 offset:32
 v_mfma_f32_16x16x32_bf16 v[164:167], v[56:59], v[100:103], v[164:167]
 ds_read_b64_tr_b16 v[30:31], v4 offset:4256
 buffer_load_dwordx4 v7, s[32:35], s44 offen offset:0 lds
 v_mfma_f32_16x16x32_bf16 v[168:171], v[56:59], v[104:107], v[168:171]
 v_mfma_f32_16x16x32_bf16 v[172:175], v[56:59], v[108:111], v[172:175]
 ds_read_b64_tr_b16 v[32:33], v5 offset:0
 v_mfma_f32_16x16x32_bf16 v[176:179], v[60:63], v[96:99], v[176:179]
 ds_read_b64_tr_b16 v[34:35], v5 offset:4224
 buffer_load_dwordx4 v8, s[32:35], s44 offen offset:1056 lds
 v_mfma_f32_16x16x32_bf16 v[180:183], v[60:63], v[100:103], v[180:183]
 ds_read_b64_tr_b16 v[36:37], v5 offset:32
 v_mfma_f32_16x16x32_bf16 v[184:187], v[60:63], v[104:107], v[184:187]
 buffer_load_dwordx4 v9, s[32:35], s44 offen offset:2112 lds
 v_mfma_f32_16x16x32_bf16 v[188:191], v[60:63], v[108:111], v[188:191]
 ds_read_b64_tr_b16 v[38:39], v5 offset:4256
 v_mfma_f32_16x16x32_bf16 v[192:195], v[64:67], v[96:99], v[192:195]
 ds_read_b64_tr_b16 v[40:41], v6 offset:0
 buffer_load_dwordx4 v10, s[32:35], s44 offen offset:3168 lds
 v_mfma_f32_16x16x32_bf16 v[196:199], v[64:67], v[100:103], v[196:199]
 ds_read_b64_tr_b16 v[42:43], v6 offset:4224
 v_mfma_f32_16x16x32_bf16 v[200:203], v[64:67], v[104:107], v[200:203]
 v_mfma_f32_16x16x32_bf16 v[204:207], v[64:67], v[108:111], v[204:207]
 ds_read_b64_tr_b16 v[44:45], v6 offset:32
 s_add_u32 m0, s46, 29568
 v_mfma_f32_16x16x32_bf16 v[208:211], v[68:71], v[96:99], v[208:211]
 ds_read_b64_tr_b16 v[46:47], v6 offset:4256
 v_mfma_f32_16x16x32_bf16 v[212:215], v[68:71], v[100:103], v[212:215]
 buffer_load_dwordx4 v7, s[32:35], s45 offen offset:0 lds
 v_mfma_f32_16x16x32_bf16 v[216:219], v[68:71], v[104:107], v[216:219]
 v_mfma_f32_16x16x32_bf16 v[220:223], v[68:71], v[108:111], v[220:223]
 buffer_load_dwordx4 v8, s[32:35], s45 offen offset:1056 lds
 v_mfma_f32_16x16x32_bf16 v[224:227], v[72:75], v[96:99], v[224:227]
 v_mfma_f32_16x16x32_bf16 v[228:231], v[72:75], v[100:103], v[228:231]
 v_mfma_f32_16x16x32_bf16 v[232:235], v[72:75], v[104:107], v[232:235]
 buffer_load_dwordx4 v9, s[32:35], s45 offen offset:2112 lds
 v_mfma_f32_16x16x32_bf16 v[236:239], v[72:75], v[108:111], v[236:239]
 v_mfma_f32_16x16x32_bf16 v[240:243], v[76:79], v[96:99], v[240:243]
 buffer_load_dwordx4 v10, s[32:35], s45 offen offset:3168 lds
 s_add_u32 s44, s44, 262144
 s_add_u32 s45, s45, 262144
 v_mfma_f32_16x16x32_bf16 v[244:247], v[76:79], v[100:103], v[244:247]
 v_mfma_f32_16x16x32_bf16 v[248:251], v[76:79], v[104:107], v[248:251]
 v_mfma_f32_16x16x32_bf16 v[252:255], v[76:79], v[108:111], v[252:255]
 s_add_u32 s58, s22, 6
 s_and_b32 s58, s58, 7
 s_lshl_b32 s58, s58, 12
 s_add_u32 s24, s62, s58
 s_addc_u32 s25, s63, 0
 buffer_load_dwordx4 v[96:99], v11, s[24:27], s47 offen sc1
 buffer_load_dwordx4 v[100:103], v11, s[24:27], s48 offen sc1
 buffer_load_dwordx4 v[104:107], v11, s[24:27], s49 offen sc1
 buffer_load_dwordx4 v[108:111], v11, s[24:27], s50 offen sc1
 s_add_u32 s24, s24, 4096
 s_addc_u32 s25, s25, 0
 s_waitcnt vmcnt(24) lgkmcnt(0)
 v_mfma_f32_16x16x32_bf16 v[128:131], v[16:19], v[112:115], v[128:131]
 ds_read_b64_tr_b16 v[48:49], v3 offset:8448
 v_mfma_f32_16x16x32_bf16 v[132:135], v[16:19], v[116:119], v[132:135]
 ds_read_b64_tr_b16 v[50:51], v3 offset:12672
 v_mfma_f32_16x16x32_bf16 v[136:139], v[16:19], v[120:123], v[136:139]
 ds_read_b64_tr_b16 v[52:53], v3 offset:8480
 v_mfma_f32_16x16x32_bf16 v[140:143], v[16:19], v[124:127], v[140:143]
 v_mfma_f32_16x16x32_bf16 v[144:147], v[20:23], v[112:115], v[144:147]
 ds_read_b64_tr_b16 v[54:55], v3 offset:12704
 v_mfma_f32_16x16x32_bf16 v[148:151], v[20:23], v[116:119], v[148:151]
 ds_read_b64_tr_b16 v[56:57], v4 offset:8448
 v_mfma_f32_16x16x32_bf16 v[152:155], v[20:23], v[120:123], v[152:155]
 ds_read_b64_tr_b16 v[58:59], v4 offset:12672
 v_mfma_f32_16x16x32_bf16 v[156:159], v[20:23], v[124:127], v[156:159]
 v_mfma_f32_16x16x32_bf16 v[160:163], v[24:27], v[112:115], v[160:163]
 ds_read_b64_tr_b16 v[60:61], v4 offset:8480
 v_mfma_f32_16x16x32_bf16 v[164:167], v[24:27], v[116:119], v[164:167]
 ds_read_b64_tr_b16 v[62:63], v4 offset:12704
 v_mfma_f32_16x16x32_bf16 v[168:171], v[24:27], v[120:123], v[168:171]
 v_mfma_f32_16x16x32_bf16 v[172:175], v[24:27], v[124:127], v[172:175]
 ds_read_b64_tr_b16 v[64:65], v5 offset:8448
 v_mfma_f32_16x16x32_bf16 v[176:179], v[28:31], v[112:115], v[176:179]
 ds_read_b64_tr_b16 v[66:67], v5 offset:12672
 v_mfma_f32_16x16x32_bf16 v[180:183], v[28:31], v[116:119], v[180:183]
 ds_read_b64_tr_b16 v[68:69], v5 offset:8480
 v_mfma_f32_16x16x32_bf16 v[184:187], v[28:31], v[120:123], v[184:187]
 v_mfma_f32_16x16x32_bf16 v[188:191], v[28:31], v[124:127], v[188:191]
 ds_read_b64_tr_b16 v[70:71], v5 offset:12704
 v_mfma_f32_16x16x32_bf16 v[192:195], v[32:35], v[112:115], v[192:195]
 ds_read_b64_tr_b16 v[72:73], v6 offset:8448
 v_mfma_f32_16x16x32_bf16 v[196:199], v[32:35], v[116:119], v[196:199]
 ds_read_b64_tr_b16 v[74:75], v6 offset:12672
 v_mfma_f32_16x16x32_bf16 v[200:203], v[32:35], v[120:123], v[200:203]
 v_mfma_f32_16x16x32_bf16 v[204:207], v[32:35], v[124:127], v[204:207]
 ds_read_b64_tr_b16 v[76:77], v6 offset:8480
 v_mfma_f32_16x16x32_bf16 v[208:211], v[36:39], v[112:115], v[208:211]
 ds_read_b64_tr_b16 v[78:79], v6 offset:12704
 v_mfma_f32_16x16x32_bf16 v[212:215], v[36:39], v[116:119], v[212:215]
 v_mfma_f32_16x16x32_bf16 v[216:219], v[36:39], v[120:123], v[216:219]
 v_mfma_f32_16x16x32_bf16 v[220:223], v[36:39], v[124:127], v[220:223]
 v_mfma_f32_16x16x32_bf16 v[224:227], v[40:43], v[112:115], v[224:227]
 v_mfma_f32_16x16x32_bf16 v[228:231], v[40:43], v[116:119], v[228:231]
 v_mfma_f32_16x16x32_bf16 v[232:235], v[40:43], v[120:123], v[232:235]
 v_mfma_f32_16x16x32_bf16 v[236:239], v[40:43], v[124:127], v[236:239]
 v_mfma_f32_16x16x32_bf16 v[240:243], v[44:47], v[112:115], v[240:243]
 v_mfma_f32_16x16x32_bf16 v[244:247], v[44:47], v[116:119], v[244:247]
 v_mfma_f32_16x16x32_bf16 v[248:251], v[44:47], v[120:123], v[248:251]
 v_mfma_f32_16x16x32_bf16 v[252:255], v[44:47], v[124:127], v[252:255]
 s_add_u32 s58, s22, 7
 s_and_b32 s58, s58, 7
 s_lshl_b32 s58, s58, 12
 s_add_u32 s24, s62, s58
 s_addc_u32 s25, s63, 0
 buffer_load_dwordx4 v[112:115], v11, s[24:27], s47 offen sc1
 buffer_load_dwordx4 v[116:119], v11, s[24:27], s48 offen sc1
 buffer_load_dwordx4 v[120:123], v11, s[24:27], s49 offen sc1
 buffer_load_dwordx4 v[124:127], v11, s[24:27], s50 offen sc1
 s_add_u32 s24, s24, 4096
 s_addc_u32 s25, s25, 0
 s_waitcnt vmcnt(16) lgkmcnt(0)
 v_mfma_f32_16x16x32_bf16 v[128:131], v[48:51], v[80:83], v[128:131]
 ds_read_b64_tr_b16 v[16:17], v3 offset:16896
 v_mfma_f32_16x16x32_bf16 v[132:135], v[48:51], v[84:87], v[132:135]
 ds_read_b64_tr_b16 v[18:19], v3 offset:21120
 v_mfma_f32_16x16x32_bf16 v[136:139], v[48:51], v[88:91], v[136:139]
 ds_read_b64_tr_b16 v[20:21], v3 offset:16928
 v_mfma_f32_16x16x32_bf16 v[140:143], v[48:51], v[92:95], v[140:143]
 v_mfma_f32_16x16x32_bf16 v[144:147], v[52:55], v[80:83], v[144:147]
 ds_read_b64_tr_b16 v[22:23], v3 offset:21152
 v_mfma_f32_16x16x32_bf16 v[148:151], v[52:55], v[84:87], v[148:151]
 ds_read_b64_tr_b16 v[24:25], v4 offset:16896
 v_mfma_f32_16x16x32_bf16 v[152:155], v[52:55], v[88:91], v[152:155]
 ds_read_b64_tr_b16 v[26:27], v4 offset:21120
 v_mfma_f32_16x16x32_bf16 v[156:159], v[52:55], v[92:95], v[156:159]
 v_mfma_f32_16x16x32_bf16 v[160:163], v[56:59], v[80:83], v[160:163]
 ds_read_b64_tr_b16 v[28:29], v4 offset:16928
 v_mfma_f32_16x16x32_bf16 v[164:167], v[56:59], v[84:87], v[164:167]
 ds_read_b64_tr_b16 v[30:31], v4 offset:21152
 v_mfma_f32_16x16x32_bf16 v[168:171], v[56:59], v[88:91], v[168:171]
 v_mfma_f32_16x16x32_bf16 v[172:175], v[56:59], v[92:95], v[172:175]
 ds_read_b64_tr_b16 v[32:33], v5 offset:16896
 v_mfma_f32_16x16x32_bf16 v[176:179], v[60:63], v[80:83], v[176:179]
 ds_read_b64_tr_b16 v[34:35], v5 offset:21120
 v_mfma_f32_16x16x32_bf16 v[180:183], v[60:63], v[84:87], v[180:183]
 ds_read_b64_tr_b16 v[36:37], v5 offset:16928
 v_mfma_f32_16x16x32_bf16 v[184:187], v[60:63], v[88:91], v[184:187]
 v_mfma_f32_16x16x32_bf16 v[188:191], v[60:63], v[92:95], v[188:191]
 ds_read_b64_tr_b16 v[38:39], v5 offset:21152
 v_mfma_f32_16x16x32_bf16 v[192:195], v[64:67], v[80:83], v[192:195]
 ds_read_b64_tr_b16 v[40:41], v6 offset:16896
 v_mfma_f32_16x16x32_bf16 v[196:199], v[64:67], v[84:87], v[196:199]
 ds_read_b64_tr_b16 v[42:43], v6 offset:21120
 v_mfma_f32_16x16x32_bf16 v[200:203], v[64:67], v[88:91], v[200:203]
 v_mfma_f32_16x16x32_bf16 v[204:207], v[64:67], v[92:95], v[204:207]
 ds_read_b64_tr_b16 v[44:45], v6 offset:16928
 v_mfma_f32_16x16x32_bf16 v[208:211], v[68:71], v[80:83], v[208:211]
 ds_read_b64_tr_b16 v[46:47], v6 offset:21152
 v_mfma_f32_16x16x32_bf16 v[212:215], v[68:71], v[84:87], v[212:215]
 v_mfma_f32_16x16x32_bf16 v[216:219], v[68:71], v[88:91], v[216:219]
 v_mfma_f32_16x16x32_bf16 v[220:223], v[68:71], v[92:95], v[220:223]
 v_mfma_f32_16x16x32_bf16 v[224:227], v[72:75], v[80:83], v[224:227]
 v_mfma_f32_16x16x32_bf16 v[228:231], v[72:75], v[84:87], v[228:231]
 v_mfma_f32_16x16x32_bf16 v[232:235], v[72:75], v[88:91], v[232:235]
 v_mfma_f32_16x16x32_bf16 v[236:239], v[72:75], v[92:95], v[236:239]
 v_mfma_f32_16x16x32_bf16 v[240:243], v[76:79], v[80:83], v[240:243]
 v_mfma_f32_16x16x32_bf16 v[244:247], v[76:79], v[84:87], v[244:247]
 v_mfma_f32_16x16x32_bf16 v[248:251], v[76:79], v[88:91], v[248:251]
 v_mfma_f32_16x16x32_bf16 v[252:255], v[76:79], v[92:95], v[252:255]
 s_waitcnt vmcnt(4) lgkmcnt(0)
 v_mfma_f32_16x16x32_bf16 v[128:131], v[16:19], v[96:99], v[128:131]
 ds_read_b64_tr_b16 v[48:49], v3 offset:25344
 v_mfma_f32_16x16x32_bf16 v[132:135], v[16:19], v[100:103], v[132:135]
 ds_read_b64_tr_b16 v[50:51], v3 offset:29568
 v_mfma_f32_16x16x32_bf16 v[136:139], v[16:19], v[104:107], v[136:139]
 ds_read_b64_tr_b16 v[52:53], v3 offset:25376
 v_mfma_f32_16x16x32_bf16 v[140:143], v[16:19], v[108:111], v[140:143]
 v_mfma_f32_16x16x32_bf16 v[144:147], v[20:23], v[96:99], v[144:147]
 ds_read_b64_tr_b16 v[54:55], v3 offset:29600
 v_mfma_f32_16x16x32_bf16 v[148:151], v[20:23], v[100:103], v[148:151]
 ds_read_b64_tr_b16 v[56:57], v4 offset:25344
 v_mfma_f32_16x16x32_bf16 v[152:155], v[20:23], v[104:107], v[152:155]
 ds_read_b64_tr_b16 v[58:59], v4 offset:29568
 v_mfma_f32_16x16x32_bf16 v[156:159], v[20:23], v[108:111], v[156:159]
 v_mfma_f32_16x16x32_bf16 v[160:163], v[24:27], v[96:99], v[160:163]
 ds_read_b64_tr_b16 v[60:61], v4 offset:25376
 v_mfma_f32_16x16x32_bf16 v[164:167], v[24:27], v[100:103], v[164:167]
 ds_read_b64_tr_b16 v[62:63], v4 offset:29600
 v_mfma_f32_16x16x32_bf16 v[168:171], v[24:27], v[104:107], v[168:171]
 v_mfma_f32_16x16x32_bf16 v[172:175], v[24:27], v[108:111], v[172:175]
 ds_read_b64_tr_b16 v[64:65], v5 offset:25344
 v_mfma_f32_16x16x32_bf16 v[176:179], v[28:31], v[96:99], v[176:179]
 ds_read_b64_tr_b16 v[66:67], v5 offset:29568
 v_mfma_f32_16x16x32_bf16 v[180:183], v[28:31], v[100:103], v[180:183]
 ds_read_b64_tr_b16 v[68:69], v5 offset:25376
 v_mfma_f32_16x16x32_bf16 v[184:187], v[28:31], v[104:107], v[184:187]
 v_mfma_f32_16x16x32_bf16 v[188:191], v[28:31], v[108:111], v[188:191]
 ds_read_b64_tr_b16 v[70:71], v5 offset:29600
 v_mfma_f32_16x16x32_bf16 v[192:195], v[32:35], v[96:99], v[192:195]
 ds_read_b64_tr_b16 v[72:73], v6 offset:25344
 v_mfma_f32_16x16x32_bf16 v[196:199], v[32:35], v[100:103], v[196:199]
 ds_read_b64_tr_b16 v[74:75], v6 offset:29568
 v_mfma_f32_16x16x32_bf16 v[200:203], v[32:35], v[104:107], v[200:203]
 v_mfma_f32_16x16x32_bf16 v[204:207], v[32:35], v[108:111], v[204:207]
 ds_read_b64_tr_b16 v[76:77], v6 offset:25376
 v_mfma_f32_16x16x32_bf16 v[208:211], v[36:39], v[96:99], v[208:211]
 ds_read_b64_tr_b16 v[78:79], v6 offset:29600
 v_mfma_f32_16x16x32_bf16 v[212:215], v[36:39], v[100:103], v[212:215]
 v_mfma_f32_16x16x32_bf16 v[216:219], v[36:39], v[104:107], v[216:219]
 v_mfma_f32_16x16x32_bf16 v[220:223], v[36:39], v[108:111], v[220:223]
 v_mfma_f32_16x16x32_bf16 v[224:227], v[40:43], v[96:99], v[224:227]
 v_mfma_f32_16x16x32_bf16 v[228:231], v[40:43], v[100:103], v[228:231]
 v_mfma_f32_16x16x32_bf16 v[232:235], v[40:43], v[104:107], v[232:235]
 v_mfma_f32_16x16x32_bf16 v[236:239], v[40:43], v[108:111], v[236:239]
 v_mfma_f32_16x16x32_bf16 v[240:243], v[44:47], v[96:99], v[240:243]
 v_mfma_f32_16x16x32_bf16 v[244:247], v[44:47], v[100:103], v[244:247]
 v_mfma_f32_16x16x32_bf16 v[248:251], v[44:47], v[104:107], v[248:251]
 v_mfma_f32_16x16x32_bf16 v[252:255], v[44:47], v[108:111], v[252:255]
 s_waitcnt vmcnt(0) lgkmcnt(0)
 s_barrier
 v_and_b32 v12, 15, v0
 s_lshl_b32 s52, s51, 4
 v_add_u32 v12, s52, v12
 v_lshlrev_b32 v12, 11, v12
 v_bfe_u32 v13, v0, 4, 1
 v_lshl_add_u32 v12, v13, 5, v12
 v_lshrrev_b32 v13, 5, v0
 v_lshl_add_u32 v12, v13, 4, v12
 buffer_load_dwordx4 v[16:19], v12, s[40:43], 0 offen offset:0
 buffer_load_dwordx4 v[20:23], v12, s[40:43], 0 offen offset:64
 buffer_load_dwordx4 v[24:27], v12, s[40:43], 0 offen offset:128
 buffer_load_dwordx4 v[28:31], v12, s[40:43], 0 offen offset:192
 v_lshlrev_b32 v13, 4, v0
 s_add_u32 s52, s51, 1
 s_and_b32 s52, s52, 3
 s_mul_i32 s52, s52, 24576
 s_add_u32 s52, s52, 0
 v_add_u32 v3, s52, v13
 s_add_u32 s52, s51, 2
 s_and_b32 s52, s52, 3
 s_mul_i32 s52, s52, 24576
 s_add_u32 s52, s52, 8192
 v_add_u32 v4, s52, v13
 s_add_u32 s52, s51, 3
 s_and_b32 s52, s52, 3
 s_mul_i32 s52, s52, 24576
 s_add_u32 s52, s52, 16384
 v_add_u32 v5, s52, v13
 v_mfma_f32_16x16x32_bf16 v[132:135], v[48:51], v[116:119], v[132:135]
 v_mfma_f32_16x16x32_bf16 v[148:151], v[52:55], v[116:119], v[148:151]
 v_mfma_f32_16x16x32_bf16 v[164:167], v[56:59], v[116:119], v[164:167]
 v_mfma_f32_16x16x32_bf16 v[180:183], v[60:63], v[116:119], v[180:183]
 v_mfma_f32_16x16x32_bf16 v[196:199], v[64:67], v[116:119], v[196:199]
 v_mfma_f32_16x16x32_bf16 v[212:215], v[68:71], v[116:119], v[212:215]
 v_mfma_f32_16x16x32_bf16 v[228:231], v[72:75], v[116:119], v[228:231]
 v_mfma_f32_16x16x32_bf16 v[244:247], v[76:79], v[116:119], v[244:247]
 v_mfma_f32_16x16x32_bf16 v[136:139], v[48:51], v[120:123], v[136:139]
 v_mfma_f32_16x16x32_bf16 v[152:155], v[52:55], v[120:123], v[152:155]
 v_mfma_f32_16x16x32_bf16 v[168:171], v[56:59], v[120:123], v[168:171]
 v_mfma_f32_16x16x32_bf16 v[184:187], v[60:63], v[120:123], v[184:187]
 v_mfma_f32_16x16x32_bf16 v[200:203], v[64:67], v[120:123], v[200:203]
 v_mfma_f32_16x16x32_bf16 v[216:219], v[68:71], v[120:123], v[216:219]
 v_mfma_f32_16x16x32_bf16 v[232:235], v[72:75], v[120:123], v[232:235]
 v_mfma_f32_16x16x32_bf16 v[248:251], v[76:79], v[120:123], v[248:251]
 v_mfma_f32_16x16x32_bf16 v[140:143], v[48:51], v[124:127], v[140:143]
 ds_write_b128 v3, v[132:135] offset:0
 v_mfma_f32_16x16x32_bf16 v[156:159], v[52:55], v[124:127], v[156:159]
 ds_write_b128 v3, v[148:151] offset:1024
 v_mfma_f32_16x16x32_bf16 v[172:175], v[56:59], v[124:127], v[172:175]
 ds_write_b128 v3, v[164:167] offset:2048
 v_mfma_f32_16x16x32_bf16 v[188:191], v[60:63], v[124:127], v[188:191]
 ds_write_b128 v3, v[180:183] offset:3072
 v_mfma_f32_16x16x32_bf16 v[204:207], v[64:67], v[124:127], v[204:207]
 ds_write_b128 v3, v[196:199] offset:4096
 v_mfma_f32_16x16x32_bf16 v[220:223], v[68:71], v[124:127], v[220:223]
 ds_write_b128 v3, v[212:215] offset:5120
 v_mfma_f32_16x16x32_bf16 v[236:239], v[72:75], v[124:127], v[236:239]
 ds_write_b128 v3, v[228:231] offset:6144
 v_mfma_f32_16x16x32_bf16 v[252:255], v[76:79], v[124:127], v[252:255]
 ds_write_b128 v3, v[244:247] offset:7168
 v_mfma_f32_16x16x32_bf16 v[128:131], v[48:51], v[112:115], v[128:131]
 ds_write_b128 v4, v[136:139] offset:0
 v_mfma_f32_16x16x32_bf16 v[144:147], v[52:55], v[112:115], v[144:147]
 ds_write_b128 v4, v[152:155] offset:1024
 v_mfma_f32_16x16x32_bf16 v[160:163], v[56:59], v[112:115], v[160:163]
 ds_write_b128 v4, v[168:171] offset:2048
 v_mfma_f32_16x16x32_bf16 v[176:179], v[60:63], v[112:115], v[176:179]
 ds_write_b128 v4, v[184:187] offset:3072
 v_mfma_f32_16x16x32_bf16 v[192:195], v[64:67], v[112:115], v[192:195]
 ds_write_b128 v4, v[200:203] offset:4096
 v_mfma_f32_16x16x32_bf16 v[208:211], v[68:71], v[112:115], v[208:211]
 ds_write_b128 v4, v[216:219] offset:5120
 v_mfma_f32_16x16x32_bf16 v[224:227], v[72:75], v[112:115], v[224:227]
 ds_write_b128 v4, v[232:235] offset:6144
 v_mfma_f32_16x16x32_bf16 v[240:243], v[76:79], v[112:115], v[240:243]
 ds_write_b128 v4, v[248:251] offset:7168
 s_nop 7
 s_nop 1
 ds_write_b128 v5, v[140:143] offset:0
 ds_write_b128 v5, v[156:159] offset:1024
 ds_write_b128 v5, v[172:175] offset:2048
 ds_write_b128 v5, v[188:191] offset:3072
 ds_write_b128 v5, v[204:207] offset:4096
 ds_write_b128 v5, v[220:223] offset:5120
 ds_write_b128 v5, v[236:239] offset:6144
 ds_write_b128 v5, v[252:255] offset:7168
 s_waitcnt lgkmcnt(0)
 s_barrier
 s_mul_i32 s52, s51, 24576
 v_add_u32 v14, s52, v13
 s_mov_b32 s60, 0xffff0000
 ds_read_b128 v[32:35], v14 offset:0
 ds_read_b128 v[64:67], v14 offset:8192
 ds_read_b128 v[96:99], v14 offset:16384
 ds_read_b128 v[36:39], v14 offset:1024
 ds_read_b128 v[68:71], v14 offset:9216
 ds_read_b128 v[100:103], v14 offset:17408
 ds_read_b128 v[40:43], v14 offset:2048
 ds_read_b128 v[72:75], v14 offset:10240
 ds_read_b128 v[104:107], v14 offset:18432
 ds_read_b128 v[44:47], v14 offset:3072
 ds_read_b128 v[76:79], v14 offset:11264
 ds_read_b128 v[108:111], v14 offset:19456
 ds_read_b128 v[48:51], v14 offset:4096
 ds_read_b128 v[80:83], v14 offset:12288
 ds_read_b128 v[112:115], v14 offset:20480
 ds_read_b128 v[52:55], v14 offset:5120
 ds_read_b128 v[84:87], v14 offset:13312
 ds_read_b128 v[116:119], v14 offset:21504
 ds_read_b128 v[56:59], v14 offset:6144
 ds_read_b128 v[88:91], v14 offset:14336
 ds_read_b128 v[120:123], v14 offset:22528
 ds_read_b128 v[60:63], v14 offset:7168
 ds_read_b128 v[92:95], v14 offset:15360
 ds_read_b128 v[124:127], v14 offset:23552
 s_waitcnt vmcnt(0)
 s_waitcnt lgkmcnt(15)
 v_add_f32 v32, v32, v64
 v_add_f32 v128, v128, v96
 v_add_f32 v33, v33, v65
 v_add_f32 v129, v129, v97
 v_add_f32 v34, v34, v66
 v_add_f32 v130, v130, v98
 v_add_f32 v35, v35, v67
 v_add_f32 v131, v131, v99
 v_add_f32 v128, v128, v32
 v_add_f32 v129, v129, v33
 v_add_f32 v130, v130, v34
 v_add_f32 v131, v131, v35
 v_add_f32 v36, v36, v68
 v_add_f32 v144, v144, v100
 v_add_f32 v37, v37, v69
 v_add_f32 v145, v145, v101
 v_add_f32 v38, v38, v70
 v_add_f32 v146, v146, v102
 v_add_f32 v39, v39, v71
 v_add_f32 v147, v147, v103
 v_add_f32 v144, v144, v36
 v_add_f32 v145, v145, v37
 v_add_f32 v146, v146, v38
 v_add_f32 v147, v147, v39
 s_nop 1
 v_permlane16_swap_b32 v128, v144
 v_permlane16_swap_b32 v129, v145
 v_permlane16_swap_b32 v130, v146
 v_permlane16_swap_b32 v131, v147
 s_nop 1
 v_lshlrev_b32 v13, 16, v16
 v_and_b32 v15, s60, v16
 v_add_f32 v128, v128, v13
 v_add_f32 v129, v129, v15
 v_cvt_pk_bf16_f32 v16, v128, v129
 v_lshlrev_b32 v13, 16, v17
 v_and_b32 v15, s60, v17
 v_add_f32 v130, v130, v13
 v_add_f32 v131, v131, v15
 v_cvt_pk_bf16_f32 v17, v130, v131
 v_lshlrev_b32 v13, 16, v18
 v_and_b32 v15, s60, v18
 v_add_f32 v144, v144, v13
 v_add_f32 v145, v145, v15
 v_cvt_pk_bf16_f32 v18, v144, v145
 v_lshlrev_b32 v13, 16, v19
 v_and_b32 v15, s60, v19
 v_add_f32 v146, v146, v13
 v_add_f32 v147, v147, v15
 v_cvt_pk_bf16_f32 v19, v146, v147
 buffer_store_dwordx4 v[16:19], v12, s[36:39], 0 offen offset:0
 s_waitcnt lgkmcnt(12)
 v_add_f32 v40, v40, v72
 v_add_f32 v160, v160, v104
 v_add_f32 v41, v41, v73
 v_add_f32 v161, v161, v105
 v_add_f32 v42, v42, v74
 v_add_f32 v162, v162, v106
 v_add_f32 v43, v43, v75
 v_add_f32 v163, v163, v107
 v_add_f32 v160, v160, v40
 v_add_f32 v161, v161, v41
 v_add_f32 v162, v162, v42
 v_add_f32 v163, v163, v43
 v_add_f32 v44, v44, v76
 v_add_f32 v176, v176, v108
 v_add_f32 v45, v45, v77
 v_add_f32 v177, v177, v109
 v_add_f32 v46, v46, v78
 v_add_f32 v178, v178, v110
 v_add_f32 v47, v47, v79
 v_add_f32 v179, v179, v111
 v_add_f32 v176, v176, v44
 v_add_f32 v177, v177, v45
 v_add_f32 v178, v178, v46
 v_add_f32 v179, v179, v47
 s_nop 1
 v_permlane16_swap_b32 v160, v176
 v_permlane16_swap_b32 v161, v177
 v_permlane16_swap_b32 v162, v178
 v_permlane16_swap_b32 v163, v179
 s_nop 1
 v_lshlrev_b32 v13, 16, v20
 v_and_b32 v15, s60, v20
 v_add_f32 v160, v160, v13
 v_add_f32 v161, v161, v15
 v_cvt_pk_bf16_f32 v20, v160, v161
 v_lshlrev_b32 v13, 16, v21
 v_and_b32 v15, s60, v21
 v_add_f32 v162, v162, v13
 v_add_f32 v163, v163, v15
 v_cvt_pk_bf16_f32 v21, v162, v163
 v_lshlrev_b32 v13, 16, v22
 v_and_b32 v15, s60, v22
 v_add_f32 v176, v176, v13
 v_add_f32 v177, v177, v15
 v_cvt_pk_bf16_f32 v22, v176, v177
 v_lshlrev_b32 v13, 16, v23
 v_and_b32 v15, s60, v23
 v_add_f32 v178, v178, v13
 v_add_f32 v179, v179, v15
 v_cvt_pk_bf16_f32 v23, v178, v179
 buffer_store_dwordx4 v[20:23], v12, s[36:39], 0 offen offset:64
 s_waitcnt lgkmcnt(6)
 v_add_f32 v48, v48, v80
 v_add_f32 v192, v192, v112
 v_add_f32 v49, v49, v81
 v_add_f32 v193, v193, v113
 v_add_f32 v50, v50, v82
 v_add_f32 v194, v194, v114
 v_add_f32 v51, v51, v83
 v_add_f32 v195, v195, v115
 v_add_f32 v192, v192, v48
 v_add_f32 v193, v193, v49
 v_add_f32 v194, v194, v50
 v_add_f32 v195, v195, v51
 v_add_f32 v52, v52, v84
 v_add_f32 v208, v208, v116
 v_add_f32 v53, v53, v85
 v_add_f32 v209, v209, v117
 v_add_f32 v54, v54, v86
 v_add_f32 v210, v210, v118
 v_add_f32 v55, v55, v87
 v_add_f32 v211, v211, v119
 v_add_f32 v208, v208, v52
 v_add_f32 v209, v209, v53
 v_add_f32 v210, v210, v54
 v_add_f32 v211, v211, v55
 s_nop 1
 v_permlane16_swap_b32 v192, v208
 v_permlane16_swap_b32 v193, v209
 v_permlane16_swap_b32 v194, v210
 v_permlane16_swap_b32 v195, v211
 s_nop 1
 v_lshlrev_b32 v13, 16, v24
 v_and_b32 v15, s60, v24
 v_add_f32 v192, v192, v13
 v_add_f32 v193, v193, v15
 v_cvt_pk_bf16_f32 v24, v192, v193
 v_lshlrev_b32 v13, 16, v25
 v_and_b32 v15, s60, v25
 v_add_f32 v194, v194, v13
 v_add_f32 v195, v195, v15
 v_cvt_pk_bf16_f32 v25, v194, v195
 v_lshlrev_b32 v13, 16, v26
 v_and_b32 v15, s60, v26
 v_add_f32 v208, v208, v13
 v_add_f32 v209, v209, v15
 v_cvt_pk_bf16_f32 v26, v208, v209
 v_lshlrev_b32 v13, 16, v27
 v_and_b32 v15, s60, v27
 v_add_f32 v210, v210, v13
 v_add_f32 v211, v211, v15
 v_cvt_pk_bf16_f32 v27, v210, v211
 buffer_store_dwordx4 v[24:27], v12, s[36:39], 0 offen offset:128
 s_waitcnt lgkmcnt(0)
 v_add_f32 v56, v56, v88
 v_add_f32 v224, v224, v120
 v_add_f32 v57, v57, v89
 v_add_f32 v225, v225, v121
 v_add_f32 v58, v58, v90
 v_add_f32 v226, v226, v122
 v_add_f32 v59, v59, v91
 v_add_f32 v227, v227, v123
 v_add_f32 v224, v224, v56
 v_add_f32 v225, v225, v57
 v_add_f32 v226, v226, v58
 v_add_f32 v227, v227, v59
 v_add_f32 v60, v60, v92
 v_add_f32 v240, v240, v124
 v_add_f32 v61, v61, v93
 v_add_f32 v241, v241, v125
 v_add_f32 v62, v62, v94
 v_add_f32 v242, v242, v126
 v_add_f32 v63, v63, v95
 v_add_f32 v243, v243, v127
 v_add_f32 v240, v240, v60
 v_add_f32 v241, v241, v61
 v_add_f32 v242, v242, v62
 v_add_f32 v243, v243, v63
 s_nop 1
 v_permlane16_swap_b32 v224, v240
 v_permlane16_swap_b32 v225, v241
 v_permlane16_swap_b32 v226, v242
 v_permlane16_swap_b32 v227, v243
 s_nop 1
 v_lshlrev_b32 v13, 16, v28
 v_and_b32 v15, s60, v28
 v_add_f32 v224, v224, v13
 v_add_f32 v225, v225, v15
 v_cvt_pk_bf16_f32 v28, v224, v225
 v_lshlrev_b32 v13, 16, v29
 v_and_b32 v15, s60, v29
 v_add_f32 v226, v226, v13
 v_add_f32 v227, v227, v15
 v_cvt_pk_bf16_f32 v29, v226, v227
 v_lshlrev_b32 v13, 16, v30
 v_and_b32 v15, s60, v30
 v_add_f32 v240, v240, v13
 v_add_f32 v241, v241, v15
 v_cvt_pk_bf16_f32 v30, v240, v241
 v_lshlrev_b32 v13, 16, v31
 v_and_b32 v15, s60, v31
 v_add_f32 v242, v242, v13
 v_add_f32 v243, v243, v15
 v_cvt_pk_bf16_f32 v31, v242, v243
 buffer_store_dwordx4 v[28:31], v12, s[36:39], 0 offen offset:192
L_fused_kernel_end:
 s_endpgm
.section .rodata,"a"
.p2align 6
.amdhsa_kernel ln_kernel
  .amdhsa_next_free_vgpr 80
  .amdhsa_next_free_sgpr 102
  .amdhsa_accum_offset 80
  .amdhsa_group_segment_fixed_size 0
  .amdhsa_kernarg_size 96
  .amdhsa_user_sgpr_count 2
  .amdhsa_user_sgpr_kernarg_segment_ptr 1
  .amdhsa_system_sgpr_workgroup_id_x 1
.end_amdhsa_kernel
.p2align 6
.amdhsa_kernel gemm1_kernel
  .amdhsa_next_free_vgpr 512
  .amdhsa_next_free_sgpr 102
  .amdhsa_accum_offset 256
  .amdhsa_group_segment_fixed_size 0
  .amdhsa_kernarg_size 96
  .amdhsa_user_sgpr_count 2
  .amdhsa_user_sgpr_kernarg_segment_ptr 1
  .amdhsa_system_sgpr_workgroup_id_x 1
.end_amdhsa_kernel
.p2align 6
.amdhsa_kernel fused_kernel
  .amdhsa_next_free_vgpr 256
  .amdhsa_next_free_sgpr 102
  .amdhsa_accum_offset 256
  .amdhsa_group_segment_fixed_size 0
  .amdhsa_kernarg_size 96
  .amdhsa_user_sgpr_count 2
  .amdhsa_user_sgpr_kernarg_segment_ptr 1
  .amdhsa_system_sgpr_workgroup_id_x 1
.end_amdhsa_kernel
```
